```python
import torch

def _softmax(x, axis=-1):
    return torch.softmax(x, dim=axis)
def _gelu(x):
    return torch.nn.functional.gelu(x, approximate="tanh")
def _silu(x):
    return torch.nn.functional.silu(x)
def _sigmoid(x):
    return torch.sigmoid(x)
def _layernorm(x, axis=-1, eps=1e-5):
    m = x.mean(dim=axis, keepdim=True)
    v = x.var(dim=axis, keepdim=True, unbiased=False)
    return (x - m) / torch.sqrt(v + eps)
def _scatter_add(tgt, idx, src, axis=0):
    return tgt.clone().index_add_(axis, idx, src)
def _segment_sum(src, seg, n):
    out = torch.zeros((n,) + src.shape[1:], dtype=src.dtype)
    return out.index_add_(0, seg, src)
def _pad(x, pw):
    flat = tuple(v for pair in reversed(pw) for v in pair)
    return torch.nn.functional.pad(x, flat)

kernel_name = 'parallel_sum__mha_block__glu_gated_swiglu__prompt'

def setup_inputs():

    _w = (lambda a: (lambda t: t.to(torch.bfloat16) if t.is_floating_point() else t)(torch.as_tensor(a)))
    def _A_setup():
        B, S, D, H = 1, 2048, 576, 32
        return {
            "x": _w((lambda *s: torch.randn(*s, dtype=torch.bfloat16) * 0.05)(B, S, D)),
            "wqkv": _w((lambda *s: torch.randn(*s, dtype=torch.bfloat16) * 0.05)(D, 3 * D)),
            "wo": _w((lambda *s: torch.randn(*s, dtype=torch.bfloat16) * 0.05)(D, D)),
        }
    _A_in = _A_setup()

    def _B_setup():
        B, S, D, F = 1, 2048, 576, 4608
        return {
            "x": _w((lambda *s: torch.randn(*s, dtype=torch.bfloat16) * 0.05)(B, S, D)),
            "w1": _w((lambda *s: torch.randn(*s, dtype=torch.bfloat16) * 0.4)(D, F) * (2.0 / D) ** 0.5),
            "w3": _w((lambda *s: torch.randn(*s, dtype=torch.bfloat16) * 0.4)(D, F) * (2.0 / D) ** 0.5),
            "w2": _w((lambda *s: torch.randn(*s, dtype=torch.bfloat16) * 0.4)(F, D) * (2.0 / F) ** 0.5),
        }
    _B_in = _B_setup()

    return {
        "A_x": _A_in["x"],
        "A_wqkv": _A_in["wqkv"],
        "A_wo": _A_in["wo"],
        "B_x": _B_in["x"],
        "B_w1": _B_in["w1"],
        "B_w3": _B_in["w3"],
        "B_w2": _B_in["w2"],
    }

def reference(A_x, A_wqkv, A_wo, B_x, B_w1, B_w3, B_w2):
    def _A_ref(x, wqkv, wo):
        B, S, D = x.shape
        H = 32
        Dh = D // H
        qkv = (lambda x, *d: x.permute(*d))((x @ wqkv).reshape(B, S, 3, H, Dh), 2, 0, 3, 1, 4)
        q, k, v = qkv[0], qkv[1], qkv[2]
        scores = torch.einsum("bhqd,bhkd->bhqk", q, k) * (Dh ** -0.5)
        p = _softmax(scores, axis=-1)
        o = torch.einsum("bhqk,bhkd->bhqd", p, v)
        return (lambda x, *d: x.permute(*d))(o, 0, 2, 1, 3).reshape(B, S, D) @ wo

    def _B_ref(x, w1, w3, w2):
        gate = torch.einsum("bsd,df->bsf", x, w1)
        up = torch.einsum("bsd,df->bsf", x, w3)
        h = _silu(gate) * up
        out = torch.einsum("bsf,fd->bsd", h, w2)
        return out

    x = A_x
    xn = _layernorm(x, axis=-1)
    return x + _A_ref(xn, A_wqkv, A_wo) + _B_ref(xn, B_w1, B_w3, B_w2)
```

```asm
; @launch kernel=ln_kernel grid=(256,1,1) block=(64,1,1) lds=0
; @launch kernel=g1_kernel grid=(256,1,1) block=(512,1,1) lds=163840
; @launch kernel=at_kernel grid=(256,1,1) block=(512,1,1) lds=159744
; @launch kernel=g2_kernel grid=(256,1,1) block=(512,1,1) lds=163840
; @launch kernel=rd_kernel grid=(576,1,1) block=(256,1,1) lds=0
.amdgcn_target "amdgcn-amd-amdhsa--gfx950"
.text
.globl ln_kernel
.p2align 8
.type ln_kernel,@function
ln_kernel:
s_cmp_ge_u32 s2, 256
s_cbranch_scc1 ln_end
s_load_dwordx4 s[4:7], s[0:1], 0
s_load_dwordx2 s[12:13], s[0:1], 72
s_load_dwordx4 s[8:11], s[0:1], 32
s_lshl_b32 s3, s2, 6
v_add_u32 v2, s3, v0
v_mul_u32_u24 v1, 144, v2
s_waitcnt lgkmcnt(0)
s_mov_b32 s20, s4
s_and_b32 s21, s5, 0xffff
s_mov_b32 s22, 2359296
s_mov_b32 s23, 0x00020000
s_add_u32 s40, s12, 58720256
s_addc_u32 s41, s13, 0
s_mov_b32 s24, s40
s_and_b32 s25, s41, 0xffff
s_mov_b32 s26, 2359296
s_mov_b32 s27, 0x00020000
buffer_load_dwordx4 v[16:19], v1, s[20:23], 0 offen offset:0
buffer_load_dwordx4 v[20:23], v1, s[20:23], 0 offen offset:16
buffer_load_dwordx4 v[24:27], v1, s[20:23], 0 offen offset:32
buffer_load_dwordx4 v[28:31], v1, s[20:23], 0 offen offset:48
buffer_load_dwordx4 v[32:35], v1, s[20:23], 0 offen offset:64
buffer_load_dwordx4 v[36:39], v1, s[20:23], 0 offen offset:80
buffer_load_dwordx4 v[40:43], v1, s[20:23], 0 offen offset:96
buffer_load_dwordx4 v[44:47], v1, s[20:23], 0 offen offset:112
buffer_load_dwordx4 v[48:51], v1, s[20:23], 0 offen offset:128
s_mov_b32 s44, s6
s_and_b32 s45, s7, 0xffff
s_mov_b32 s46, 1990656
s_mov_b32 s47, 0x00020000
s_mov_b32 s48, s8
s_and_b32 s49, s9, 0xffff
s_mov_b32 s50, 5308416
s_mov_b32 s51, 0x00020000
s_mov_b32 s52, s10
s_and_b32 s53, s11, 0xffff
s_mov_b32 s54, 5308416
s_mov_b32 s55, 0x00020000
s_lshr_b32 s31, s2, 3
s_lshl_b32 s31, s31, 6
v_add_u32 v56, s31, v0
s_and_b32 s32, s2, 7
s_lshl_b32 s33, s32, 9
s_lshl_b32 s34, s32, 8
s_add_u32 s34, s34, 256
v_mul_u32_u24 v57, 7282, v56
v_lshrrev_b32 v57, 22, v57
v_mul_u32_u24 v58, 576, v57
v_sub_u32 v58, v56, v58
v_mul_u32_u24 v56, 3456, v58
v_lshl_add_u32 v56, v57, 7, v56
v_min_u32 v57, 2, v57
v_mul_u32_u24 v58, 9216, v58
v_lshl_add_u32 v58, v57, 7, v58
buffer_load_dword v59, v56, s[44:47], s33 offen
buffer_load_dword v60, v58, s[48:51], s34 offen
buffer_load_dword v61, v58, s[52:55], s34 offen
v_lshrrev_b32 v3, 3, v2
v_and_b32 v4, 7, v2
v_lshrrev_b32 v5, 5, v3
v_mul_u32_u24 v5, 36864, v5
v_and_b32 v6, 31, v3
v_lshl_add_u32 v5, v6, 4, v5
v_and_b32 v6, 3, v4
v_mul_u32_u24 v6, 9216, v6
v_add_u32 v5, v5, v6
v_lshrrev_b32 v6, 2, v4
v_lshl_add_u32 v5, v6, 9, v5
s_mov_b32 s30, 0x3f803f80
v_mov_b32 v8, 0
v_mov_b32 v9, 0
v_mov_b32 v10, 0
v_mov_b32 v11, 0
s_waitcnt vmcnt(11)
v_dot2c_f32_bf16 v8, s30, v16
v_dot2c_f32_bf16 v10, v16, v16
v_dot2c_f32_bf16 v9, s30, v17
v_dot2c_f32_bf16 v11, v17, v17
v_dot2c_f32_bf16 v8, s30, v18
v_dot2c_f32_bf16 v10, v18, v18
v_dot2c_f32_bf16 v9, s30, v19
v_dot2c_f32_bf16 v11, v19, v19
s_waitcnt vmcnt(10)
v_dot2c_f32_bf16 v8, s30, v20
v_dot2c_f32_bf16 v10, v20, v20
v_dot2c_f32_bf16 v9, s30, v21
v_dot2c_f32_bf16 v11, v21, v21
v_dot2c_f32_bf16 v8, s30, v22
v_dot2c_f32_bf16 v10, v22, v22
v_dot2c_f32_bf16 v9, s30, v23
v_dot2c_f32_bf16 v11, v23, v23
s_waitcnt vmcnt(9)
v_dot2c_f32_bf16 v8, s30, v24
v_dot2c_f32_bf16 v10, v24, v24
v_dot2c_f32_bf16 v9, s30, v25
v_dot2c_f32_bf16 v11, v25, v25
v_dot2c_f32_bf16 v8, s30, v26
v_dot2c_f32_bf16 v10, v26, v26
v_dot2c_f32_bf16 v9, s30, v27
v_dot2c_f32_bf16 v11, v27, v27
s_waitcnt vmcnt(8)
v_dot2c_f32_bf16 v8, s30, v28
v_dot2c_f32_bf16 v10, v28, v28
v_dot2c_f32_bf16 v9, s30, v29
v_dot2c_f32_bf16 v11, v29, v29
v_dot2c_f32_bf16 v8, s30, v30
v_dot2c_f32_bf16 v10, v30, v30
v_dot2c_f32_bf16 v9, s30, v31
v_dot2c_f32_bf16 v11, v31, v31
s_waitcnt vmcnt(7)
v_dot2c_f32_bf16 v8, s30, v32
v_dot2c_f32_bf16 v10, v32, v32
v_dot2c_f32_bf16 v9, s30, v33
v_dot2c_f32_bf16 v11, v33, v33
v_dot2c_f32_bf16 v8, s30, v34
v_dot2c_f32_bf16 v10, v34, v34
v_dot2c_f32_bf16 v9, s30, v35
v_dot2c_f32_bf16 v11, v35, v35
s_waitcnt vmcnt(6)
v_dot2c_f32_bf16 v8, s30, v36
v_dot2c_f32_bf16 v10, v36, v36
v_dot2c_f32_bf16 v9, s30, v37
v_dot2c_f32_bf16 v11, v37, v37
v_dot2c_f32_bf16 v8, s30, v38
v_dot2c_f32_bf16 v10, v38, v38
v_dot2c_f32_bf16 v9, s30, v39
v_dot2c_f32_bf16 v11, v39, v39
s_waitcnt vmcnt(5)
v_dot2c_f32_bf16 v8, s30, v40
v_dot2c_f32_bf16 v10, v40, v40
v_dot2c_f32_bf16 v9, s30, v41
v_dot2c_f32_bf16 v11, v41, v41
v_dot2c_f32_bf16 v8, s30, v42
v_dot2c_f32_bf16 v10, v42, v42
v_dot2c_f32_bf16 v9, s30, v43
v_dot2c_f32_bf16 v11, v43, v43
s_waitcnt vmcnt(4)
v_dot2c_f32_bf16 v8, s30, v44
v_dot2c_f32_bf16 v10, v44, v44
v_dot2c_f32_bf16 v9, s30, v45
v_dot2c_f32_bf16 v11, v45, v45
v_dot2c_f32_bf16 v8, s30, v46
v_dot2c_f32_bf16 v10, v46, v46
v_dot2c_f32_bf16 v9, s30, v47
v_dot2c_f32_bf16 v11, v47, v47
s_waitcnt vmcnt(3)
v_dot2c_f32_bf16 v8, s30, v48
v_dot2c_f32_bf16 v10, v48, v48
v_dot2c_f32_bf16 v9, s30, v49
v_dot2c_f32_bf16 v11, v49, v49
v_dot2c_f32_bf16 v8, s30, v50
v_dot2c_f32_bf16 v10, v50, v50
v_dot2c_f32_bf16 v9, s30, v51
v_dot2c_f32_bf16 v11, v51, v51
s_nop 1
v_add_f32 v8, v8, v9
v_add_f32 v10, v10, v11
ds_swizzle_b32 v9, v8 offset:1055
ds_swizzle_b32 v11, v10 offset:1055
s_waitcnt lgkmcnt(0)
v_add_f32 v8, v8, v9
v_add_f32 v10, v10, v11
ds_swizzle_b32 v9, v8 offset:2079
ds_swizzle_b32 v11, v10 offset:2079
s_waitcnt lgkmcnt(0)
v_add_f32 v8, v8, v9
v_add_f32 v10, v10, v11
ds_swizzle_b32 v9, v8 offset:4127
ds_swizzle_b32 v11, v10 offset:4127
s_waitcnt lgkmcnt(0)
v_add_f32 v8, v8, v9
v_add_f32 v10, v10, v11
v_mul_f32 v8, 0x3ae38e39, v8
v_mov_b32 v13, 0x3727c5ac
v_fmac_f32 v13, 0x3ae38e39, v10
v_fma_f32 v13, -v8, v8, v13
v_rsq_f32 v12, v13
s_nop 0
v_mul_f32 v14, v8, v12
v_sub_f32 v14, 0, v14
v_mov_b32 v13, v12
v_mov_b32 v15, v14
v_lshlrev_b32 v52, 16, v16
v_and_b32 v53, 0xffff0000, v16
v_pk_fma_f32 v[52:53], v[52:53], v[12:13], v[14:15]
v_cvt_pk_bf16_f32 v16, v52, v53
v_lshlrev_b32 v54, 16, v17
v_and_b32 v55, 0xffff0000, v17
v_pk_fma_f32 v[54:55], v[54:55], v[12:13], v[14:15]
v_cvt_pk_bf16_f32 v17, v54, v55
v_lshlrev_b32 v52, 16, v18
v_and_b32 v53, 0xffff0000, v18
v_pk_fma_f32 v[52:53], v[52:53], v[12:13], v[14:15]
v_cvt_pk_bf16_f32 v18, v52, v53
v_lshlrev_b32 v54, 16, v19
v_and_b32 v55, 0xffff0000, v19
v_pk_fma_f32 v[54:55], v[54:55], v[12:13], v[14:15]
v_cvt_pk_bf16_f32 v19, v54, v55
s_movk_i32 s40, 0
buffer_store_dwordx4 v[16:19], v5, s[24:27], s40 offen
v_lshlrev_b32 v52, 16, v20
v_and_b32 v53, 0xffff0000, v20
v_pk_fma_f32 v[52:53], v[52:53], v[12:13], v[14:15]
v_cvt_pk_bf16_f32 v20, v52, v53
v_lshlrev_b32 v54, 16, v21
v_and_b32 v55, 0xffff0000, v21
v_pk_fma_f32 v[54:55], v[54:55], v[12:13], v[14:15]
v_cvt_pk_bf16_f32 v21, v54, v55
v_lshlrev_b32 v52, 16, v22
v_and_b32 v53, 0xffff0000, v22
v_pk_fma_f32 v[52:53], v[52:53], v[12:13], v[14:15]
v_cvt_pk_bf16_f32 v22, v52, v53
v_lshlrev_b32 v54, 16, v23
v_and_b32 v55, 0xffff0000, v23
v_pk_fma_f32 v[54:55], v[54:55], v[12:13], v[14:15]
v_cvt_pk_bf16_f32 v23, v54, v55
s_movk_i32 s40, 1024
buffer_store_dwordx4 v[20:23], v5, s[24:27], s40 offen
v_lshlrev_b32 v52, 16, v24
v_and_b32 v53, 0xffff0000, v24
v_pk_fma_f32 v[52:53], v[52:53], v[12:13], v[14:15]
v_cvt_pk_bf16_f32 v24, v52, v53
v_lshlrev_b32 v54, 16, v25
v_and_b32 v55, 0xffff0000, v25
v_pk_fma_f32 v[54:55], v[54:55], v[12:13], v[14:15]
v_cvt_pk_bf16_f32 v25, v54, v55
v_lshlrev_b32 v52, 16, v26
v_and_b32 v53, 0xffff0000, v26
v_pk_fma_f32 v[52:53], v[52:53], v[12:13], v[14:15]
v_cvt_pk_bf16_f32 v26, v52, v53
v_lshlrev_b32 v54, 16, v27
v_and_b32 v55, 0xffff0000, v27
v_pk_fma_f32 v[54:55], v[54:55], v[12:13], v[14:15]
v_cvt_pk_bf16_f32 v27, v54, v55
s_movk_i32 s40, 2048
buffer_store_dwordx4 v[24:27], v5, s[24:27], s40 offen
v_lshlrev_b32 v52, 16, v28
v_and_b32 v53, 0xffff0000, v28
v_pk_fma_f32 v[52:53], v[52:53], v[12:13], v[14:15]
v_cvt_pk_bf16_f32 v28, v52, v53
v_lshlrev_b32 v54, 16, v29
v_and_b32 v55, 0xffff0000, v29
v_pk_fma_f32 v[54:55], v[54:55], v[12:13], v[14:15]
v_cvt_pk_bf16_f32 v29, v54, v55
v_lshlrev_b32 v52, 16, v30
v_and_b32 v53, 0xffff0000, v30
v_pk_fma_f32 v[52:53], v[52:53], v[12:13], v[14:15]
v_cvt_pk_bf16_f32 v30, v52, v53
v_lshlrev_b32 v54, 16, v31
v_and_b32 v55, 0xffff0000, v31
v_pk_fma_f32 v[54:55], v[54:55], v[12:13], v[14:15]
v_cvt_pk_bf16_f32 v31, v54, v55
s_movk_i32 s40, 3072
buffer_store_dwordx4 v[28:31], v5, s[24:27], s40 offen
v_lshlrev_b32 v52, 16, v32
v_and_b32 v53, 0xffff0000, v32
v_pk_fma_f32 v[52:53], v[52:53], v[12:13], v[14:15]
v_cvt_pk_bf16_f32 v32, v52, v53
v_lshlrev_b32 v54, 16, v33
v_and_b32 v55, 0xffff0000, v33
v_pk_fma_f32 v[54:55], v[54:55], v[12:13], v[14:15]
v_cvt_pk_bf16_f32 v33, v54, v55
v_lshlrev_b32 v52, 16, v34
v_and_b32 v53, 0xffff0000, v34
v_pk_fma_f32 v[52:53], v[52:53], v[12:13], v[14:15]
v_cvt_pk_bf16_f32 v34, v52, v53
v_lshlrev_b32 v54, 16, v35
v_and_b32 v55, 0xffff0000, v35
v_pk_fma_f32 v[54:55], v[54:55], v[12:13], v[14:15]
v_cvt_pk_bf16_f32 v35, v54, v55
s_movk_i32 s40, 4096
buffer_store_dwordx4 v[32:35], v5, s[24:27], s40 offen
v_lshlrev_b32 v52, 16, v36
v_and_b32 v53, 0xffff0000, v36
v_pk_fma_f32 v[52:53], v[52:53], v[12:13], v[14:15]
v_cvt_pk_bf16_f32 v36, v52, v53
v_lshlrev_b32 v54, 16, v37
v_and_b32 v55, 0xffff0000, v37
v_pk_fma_f32 v[54:55], v[54:55], v[12:13], v[14:15]
v_cvt_pk_bf16_f32 v37, v54, v55
v_lshlrev_b32 v52, 16, v38
v_and_b32 v53, 0xffff0000, v38
v_pk_fma_f32 v[52:53], v[52:53], v[12:13], v[14:15]
v_cvt_pk_bf16_f32 v38, v52, v53
v_lshlrev_b32 v54, 16, v39
v_and_b32 v55, 0xffff0000, v39
v_pk_fma_f32 v[54:55], v[54:55], v[12:13], v[14:15]
v_cvt_pk_bf16_f32 v39, v54, v55
s_movk_i32 s40, 5120
buffer_store_dwordx4 v[36:39], v5, s[24:27], s40 offen
v_lshlrev_b32 v52, 16, v40
v_and_b32 v53, 0xffff0000, v40
v_pk_fma_f32 v[52:53], v[52:53], v[12:13], v[14:15]
v_cvt_pk_bf16_f32 v40, v52, v53
v_lshlrev_b32 v54, 16, v41
v_and_b32 v55, 0xffff0000, v41
v_pk_fma_f32 v[54:55], v[54:55], v[12:13], v[14:15]
v_cvt_pk_bf16_f32 v41, v54, v55
v_lshlrev_b32 v52, 16, v42
v_and_b32 v53, 0xffff0000, v42
v_pk_fma_f32 v[52:53], v[52:53], v[12:13], v[14:15]
v_cvt_pk_bf16_f32 v42, v52, v53
v_lshlrev_b32 v54, 16, v43
v_and_b32 v55, 0xffff0000, v43
v_pk_fma_f32 v[54:55], v[54:55], v[12:13], v[14:15]
v_cvt_pk_bf16_f32 v43, v54, v55
s_movk_i32 s40, 6144
buffer_store_dwordx4 v[40:43], v5, s[24:27], s40 offen
v_lshlrev_b32 v52, 16, v44
v_and_b32 v53, 0xffff0000, v44
v_pk_fma_f32 v[52:53], v[52:53], v[12:13], v[14:15]
v_cvt_pk_bf16_f32 v44, v52, v53
v_lshlrev_b32 v54, 16, v45
v_and_b32 v55, 0xffff0000, v45
v_pk_fma_f32 v[54:55], v[54:55], v[12:13], v[14:15]
v_cvt_pk_bf16_f32 v45, v54, v55
v_lshlrev_b32 v52, 16, v46
v_and_b32 v53, 0xffff0000, v46
v_pk_fma_f32 v[52:53], v[52:53], v[12:13], v[14:15]
v_cvt_pk_bf16_f32 v46, v52, v53
v_lshlrev_b32 v54, 16, v47
v_and_b32 v55, 0xffff0000, v47
v_pk_fma_f32 v[54:55], v[54:55], v[12:13], v[14:15]
v_cvt_pk_bf16_f32 v47, v54, v55
s_movk_i32 s40, 7168
buffer_store_dwordx4 v[44:47], v5, s[24:27], s40 offen
v_lshlrev_b32 v52, 16, v48
v_and_b32 v53, 0xffff0000, v48
v_pk_fma_f32 v[52:53], v[52:53], v[12:13], v[14:15]
v_cvt_pk_bf16_f32 v48, v52, v53
v_lshlrev_b32 v54, 16, v49
v_and_b32 v55, 0xffff0000, v49
v_pk_fma_f32 v[54:55], v[54:55], v[12:13], v[14:15]
v_cvt_pk_bf16_f32 v49, v54, v55
v_lshlrev_b32 v52, 16, v50
v_and_b32 v53, 0xffff0000, v50
v_pk_fma_f32 v[52:53], v[52:53], v[12:13], v[14:15]
v_cvt_pk_bf16_f32 v50, v52, v53
v_lshlrev_b32 v54, 16, v51
v_and_b32 v55, 0xffff0000, v51
v_pk_fma_f32 v[54:55], v[54:55], v[12:13], v[14:15]
v_cvt_pk_bf16_f32 v51, v54, v55
s_movk_i32 s40, 8192
buffer_store_dwordx4 v[48:51], v5, s[24:27], s40 offen
ln_end:
s_endpgm
.section .rodata,"a"
.p2align 6
.amdhsa_kernel ln_kernel
  .amdhsa_next_free_vgpr 72
  .amdhsa_next_free_sgpr 102
  .amdhsa_accum_offset 72
  .amdhsa_group_segment_fixed_size 0
  .amdhsa_kernarg_size 80
  .amdhsa_user_sgpr_count 2
  .amdhsa_user_sgpr_kernarg_segment_ptr 1
  .amdhsa_system_sgpr_workgroup_id_x 1
.end_amdhsa_kernel
.text

.globl g1_kernel
.p2align 8
.type g1_kernel,@function
g1_kernel:
s_cmp_ge_u32 s2, 256
s_cbranch_scc1 g1_end
s_load_dwordx4 s[4:7], s[0:1], 0
s_load_dwordx4 s[8:11], s[0:1], 32
s_load_dwordx2 s[12:13], s[0:1], 72
s_and_b32 s14, s2, 7
s_lshr_b32 s15, s2, 3
s_and_b32 s16, s15, 7
s_lshr_b32 s15, s15, 3
s_lshl_b32 s14, s14, 2
s_add_u32 s17, s14, s15
v_lshrrev_b32 v1, 6, v0
s_nop 0
v_readfirstlane_b32 s18, v1
v_and_b32 v2, 63, v0
s_waitcnt lgkmcnt(0)
s_add_u32 s40, s12, 58720256
s_addc_u32 s41, s13, 0
s_mov_b32 s20, s40
s_and_b32 s21, s41, 0xffff
s_mov_b32 s22, 2359296
s_mov_b32 s23, 0x00020000
s_mov_b32 s24, s6
s_and_b32 s25, s7, 0xffff
s_mov_b32 s26, 1990656
s_mov_b32 s27, 0x00020000
s_mov_b32 s28, s8
s_and_b32 s29, s9, 0xffff
s_mov_b32 s30, 5308416
s_mov_b32 s31, 0x00020000
s_mov_b32 s32, s10
s_and_b32 s33, s11, 0xffff
s_mov_b32 s34, 5308416
s_mov_b32 s35, 0x00020000
s_add_u32 s40, s12, 0
s_addc_u32 s41, s13, 0
s_mov_b32 s36, s40
s_and_b32 s37, s41, 0xffff
s_mov_b32 s38, 7077888
s_mov_b32 s39, 0x00020000
s_add_u32 s40, s12, 8388608
s_addc_u32 s41, s13, 0
s_mov_b32 s44, s40
s_and_b32 s45, s41, 0xffff
s_mov_b32 s46, 21233664
s_mov_b32 s47, 0x00020000
v_and_b32 v3, 31, v2
v_lshrrev_b32 v4, 5, v2
s_lshl_b32 s19, s16, 8
s_lshl_b32 s40, s18, 5
s_add_u32 s19, s19, s40
v_add_u32 v5, s19, v3
v_lshrrev_b32 v10, 2, v2
v_and_b32 v11, 3, v2
v_lshlrev_b32 v11, 4, v11
v_mul_u32_u24 v208, 9216, v10
v_add_u32 v208, v208, v11
v_mul_u32_u24 v209, 3456, v10
v_add_u32 v209, v209, v11
v_mul_u32_u24 v210, 18432, v4
v_bfe_u32 v10, v2, 2, 2
v_lshlrev_b32 v10, 6, v10
v_add_u32 v210, v210, v10
v_bfe_u32 v10, v2, 4, 1
v_lshlrev_b32 v10, 5, v10
v_add_u32 v210, v210, v10
v_and_b32 v10, 3, v2
v_lshlrev_b32 v10, 3, v10
v_add_u32 v210, v210, v10
s_movk_i32 s42, 10368
v_mul_lo_u32 v211, v5, s42
v_lshlrev_b32 v10, 3, v4
v_add_u32 v211, v211, v10
v_add_u32 v211, 1152, v211
v_mul_u32_u24 v212, 36, v5
s_lshl_b32 s40, s18, 11
s_add_u32 s40, s40, 147456
v_lshlrev_b32 v7, 6, v3
v_lshl_add_u32 v7, v4, 3, v7
v_add_u32 v7, s40, v7
v_lshrrev_b32 v10, 4, v2
v_and_b32 v11, 15, v2
v_lshlrev_b32 v12, 6, v10
v_lshl_add_u32 v12, v11, 2, v12
v_add_u32 v12, s40, v12
v_add_u32 v13, s19, v10
v_mul_u32_u24 v13, 36, v13
v_lshlrev_b32 v214, 1, v11
s_lshr_b32 s50, s18, 2
s_and_b32 s51, s18, 3
s_mul_i32 s51, s51, 144
s_mul_i32 s52, s18, 9216
s_mov_b32 s53, s17
s_sub_u32 s80, s17, 10
s_and_b32 s81, s80, 1
s_lshr_b32 s80, s80, 1
s_add_u32 s80, s80, 160
s_cmp_lt_u32 s17, 10
s_cselect_b32 s80, 255, s80
s_mov_b32 s63, 0
s_mov_b32 s65, 73728
s_add_u32 s64, s52, s63
s_cmp_lt_u32 s53, 27
s_cbranch_scc1 g1_sq1
s_cmp_eq_u32 s50, 0
s_cselect_b32 s56, s28, s32
s_cselect_b32 s57, s29, s33
s_mov_b32 s58, s30
s_mov_b32 s59, s31
s_mul_i32 s54, s51, 9216
s_sub_u32 s55, s53, 27
s_lshl_b32 s55, s55, 6
s_add_u32 s54, s54, s55
s_add_u32 m0, s64, 0
s_add_u32 s61, s54, 0
buffer_load_dwordx4 v208, s[56:59], s61 offen lds
s_add_u32 m0, s64, 1024
s_add_u32 s61, s54, 147456
buffer_load_dwordx4 v208, s[56:59], s61 offen lds
s_add_u32 m0, s64, 2048
s_add_u32 s61, s54, 294912
buffer_load_dwordx4 v208, s[56:59], s61 offen lds
s_add_u32 m0, s64, 3072
s_add_u32 s61, s54, 442368
buffer_load_dwordx4 v208, s[56:59], s61 offen lds
s_add_u32 m0, s64, 4096
s_add_u32 s61, s54, 589824
buffer_load_dwordx4 v208, s[56:59], s61 offen lds
s_add_u32 m0, s64, 5120
s_add_u32 s61, s54, 737280
buffer_load_dwordx4 v208, s[56:59], s61 offen lds
s_add_u32 m0, s64, 6144
s_add_u32 s61, s54, 884736
buffer_load_dwordx4 v208, s[56:59], s61 offen lds
s_add_u32 m0, s64, 7168
s_add_u32 s61, s54, 1032192
buffer_load_dwordx4 v208, s[56:59], s61 offen lds
s_add_u32 m0, s64, 8192
s_add_u32 s61, s54, 1179648
buffer_load_dwordx4 v208, s[56:59], s61 offen lds
s_branch g1_sd1
g1_sq1:
s_mul_i32 s54, s51, 3456
s_lshl_b32 s55, s53, 7
s_add_u32 s54, s54, s55
s_lshl_b32 s55, s50, 6
s_add_u32 s54, s54, s55
s_add_u32 m0, s64, 0
s_add_u32 s61, s54, 0
buffer_load_dwordx4 v209, s[24:27], s61 offen lds
s_add_u32 m0, s64, 1024
s_add_u32 s61, s54, 55296
buffer_load_dwordx4 v209, s[24:27], s61 offen lds
s_add_u32 m0, s64, 2048
s_add_u32 s61, s54, 110592
buffer_load_dwordx4 v209, s[24:27], s61 offen lds
s_add_u32 m0, s64, 3072
s_add_u32 s61, s54, 165888
buffer_load_dwordx4 v209, s[24:27], s61 offen lds
s_add_u32 m0, s64, 4096
s_add_u32 s61, s54, 221184
buffer_load_dwordx4 v209, s[24:27], s61 offen lds
s_add_u32 m0, s64, 5120
s_add_u32 s61, s54, 276480
buffer_load_dwordx4 v209, s[24:27], s61 offen lds
s_add_u32 m0, s64, 6144
s_add_u32 s61, s54, 331776
buffer_load_dwordx4 v209, s[24:27], s61 offen lds
s_add_u32 m0, s64, 7168
s_add_u32 s61, s54, 387072
buffer_load_dwordx4 v209, s[24:27], s61 offen lds
s_add_u32 m0, s64, 8192
s_add_u32 s61, s54, 442368
buffer_load_dwordx4 v209, s[24:27], s61 offen lds
g1_sd1:
s_lshr_b32 s40, s19, 5
s_mul_i32 s40, s40, 36864
v_lshlrev_b32 v6, 4, v2
buffer_load_dwordx4 v[64:67], v6, s[20:23], s40 offen offset:0
buffer_load_dwordx4 v[68:71], v6, s[20:23], s40 offen offset:1024
buffer_load_dwordx4 v[72:75], v6, s[20:23], s40 offen offset:2048
buffer_load_dwordx4 v[76:79], v6, s[20:23], s40 offen offset:3072
s_add_u32 s40, s40, 4096
buffer_load_dwordx4 v[80:83], v6, s[20:23], s40 offen offset:0
buffer_load_dwordx4 v[84:87], v6, s[20:23], s40 offen offset:1024
buffer_load_dwordx4 v[88:91], v6, s[20:23], s40 offen offset:2048
buffer_load_dwordx4 v[92:95], v6, s[20:23], s40 offen offset:3072
s_lshl_b32 s72, s2, 3
s_add_u32 s72, s72, s18
s_cmp_lt_u32 s72, 648
s_cselect_b32 s76, s28, s32
s_cselect_b32 s77, s29, s33
s_cselect_b32 s73, 0, 648
s_mov_b32 s78, s30
s_mov_b32 s79, s31
s_cmp_lt_u32 s72, 1296
s_cselect_b32 s76, s76, s24
s_cselect_b32 s77, s77, s25
s_cselect_b32 s78, s78, s26
s_cselect_b32 s73, s73, 1296
s_sub_u32 s73, s72, s73
s_lshl_b32 s73, s73, 13
v_lshlrev_b32 v9, 7, v2
buffer_load_dword v10, v9, s[76:79], s73 offen
v_add_u32 v213, s63, v210
s_waitcnt vmcnt(9)
s_barrier
s_add_u32 s62, s53, 32
s_cmp_ge_u32 s62, 160
s_cselect_b32 s62, s80, s62
s_cmp_ge_u32 s53, 160
s_cselect_b32 s62, 255, s62
s_min_u32 s69, s62, 170
s_sub_u32 s69, s69, 27
s_add_u32 s64, s52, s65
s_cmp_eq_u32 s50, 0
s_cselect_b32 s56, s28, s32
s_cselect_b32 s57, s29, s33
s_mov_b32 s58, s30
s_mov_b32 s59, s31
s_mul_i32 s54, s51, 9216
s_lshl_b32 s55, s69, 6
s_add_u32 s61, s54, s55
s_cmp_gt_u32 s62, 170
s_cselect_b32 s58, 0, s58
ds_read_b64_tr_b16 v[48:49], v213 offset:0
ds_read_b64_tr_b16 v[50:51], v213 offset:256
ds_read_b64_tr_b16 v[52:53], v213 offset:36864
ds_read_b64_tr_b16 v[54:55], v213 offset:37120
ds_read_b64_tr_b16 v[56:57], v213 offset:512
ds_read_b64_tr_b16 v[58:59], v213 offset:768
ds_read_b64_tr_b16 v[60:61], v213 offset:37376
ds_read_b64_tr_b16 v[62:63], v213 offset:37632
ds_read_b64_tr_b16 v[248:249], v213 offset:1024
ds_read_b64_tr_b16 v[250:251], v213 offset:1280
ds_read_b64_tr_b16 v[252:253], v213 offset:37888
ds_read_b64_tr_b16 v[254:255], v213 offset:38144
s_waitcnt vmcnt(8) lgkmcnt(8)
s_add_u32 s40, s40, 4096
buffer_load_dwordx4 v[96:99], v6, s[20:23], s40 offen offset:0
v_mfma_f32_32x32x16_bf16 v[16:31], v[48:51], v[64:67], 0
v_mfma_f32_32x32x16_bf16 v[32:47], v[52:55], v[64:67], 0
ds_read_b64_tr_b16 v[48:49], v213 offset:1536
ds_read_b64_tr_b16 v[50:51], v213 offset:1792
ds_read_b64_tr_b16 v[52:53], v213 offset:38400
ds_read_b64_tr_b16 v[54:55], v213 offset:38656
s_waitcnt vmcnt(8) lgkmcnt(8)
s_add_u32 m0, s64, 0
s_nop 0
buffer_load_dwordx4 v208, s[56:59], s61 offen lds
s_add_u32 s61, s61, 147456
buffer_load_dwordx4 v[100:103], v6, s[20:23], s40 offen offset:1024
v_mfma_f32_32x32x16_bf16 v[16:31], v[56:59], v[68:71], v[16:31]
v_mfma_f32_32x32x16_bf16 v[32:47], v[60:63], v[68:71], v[32:47]
ds_read_b64_tr_b16 v[56:57], v213 offset:2048
ds_read_b64_tr_b16 v[58:59], v213 offset:2304
ds_read_b64_tr_b16 v[60:61], v213 offset:38912
ds_read_b64_tr_b16 v[62:63], v213 offset:39168
s_waitcnt vmcnt(9) lgkmcnt(8)
buffer_load_dwordx4 v[104:107], v6, s[20:23], s40 offen offset:2048
v_mfma_f32_32x32x16_bf16 v[16:31], v[248:251], v[72:75], v[16:31]
v_mfma_f32_32x32x16_bf16 v[32:47], v[252:255], v[72:75], v[32:47]
ds_read_b64_tr_b16 v[248:249], v213 offset:2560
ds_read_b64_tr_b16 v[250:251], v213 offset:2816
ds_read_b64_tr_b16 v[252:253], v213 offset:39424
ds_read_b64_tr_b16 v[254:255], v213 offset:39680
s_waitcnt vmcnt(9) lgkmcnt(8)
buffer_load_dwordx4 v[108:111], v6, s[20:23], s40 offen offset:3072
v_mfma_f32_32x32x16_bf16 v[16:31], v[48:51], v[76:79], v[16:31]
v_mfma_f32_32x32x16_bf16 v[32:47], v[52:55], v[76:79], v[32:47]
ds_read_b64_tr_b16 v[48:49], v213 offset:3072
ds_read_b64_tr_b16 v[50:51], v213 offset:3328
ds_read_b64_tr_b16 v[52:53], v213 offset:39936
ds_read_b64_tr_b16 v[54:55], v213 offset:40192
s_waitcnt vmcnt(9) lgkmcnt(8)
s_add_u32 m0, s64, 1024
s_nop 0
buffer_load_dwordx4 v208, s[56:59], s61 offen lds
s_add_u32 s61, s61, 147456
s_add_u32 s40, s40, 4096
buffer_load_dwordx4 v[112:115], v6, s[20:23], s40 offen offset:0
v_mfma_f32_32x32x16_bf16 v[16:31], v[56:59], v[80:83], v[16:31]
v_mfma_f32_32x32x16_bf16 v[32:47], v[60:63], v[80:83], v[32:47]
ds_read_b64_tr_b16 v[56:57], v213 offset:3584
ds_read_b64_tr_b16 v[58:59], v213 offset:3840
ds_read_b64_tr_b16 v[60:61], v213 offset:40448
ds_read_b64_tr_b16 v[62:63], v213 offset:40704
s_waitcnt vmcnt(10) lgkmcnt(8)
buffer_load_dwordx4 v[116:119], v6, s[20:23], s40 offen offset:1024
v_mfma_f32_32x32x16_bf16 v[16:31], v[248:251], v[84:87], v[16:31]
v_mfma_f32_32x32x16_bf16 v[32:47], v[252:255], v[84:87], v[32:47]
ds_read_b64_tr_b16 v[248:249], v213 offset:4096
ds_read_b64_tr_b16 v[250:251], v213 offset:4352
ds_read_b64_tr_b16 v[252:253], v213 offset:40960
ds_read_b64_tr_b16 v[254:255], v213 offset:41216
s_waitcnt vmcnt(10) lgkmcnt(8)
buffer_load_dwordx4 v[120:123], v6, s[20:23], s40 offen offset:2048
v_mfma_f32_32x32x16_bf16 v[16:31], v[48:51], v[88:91], v[16:31]
v_mfma_f32_32x32x16_bf16 v[32:47], v[52:55], v[88:91], v[32:47]
ds_read_b64_tr_b16 v[48:49], v213 offset:4608
ds_read_b64_tr_b16 v[50:51], v213 offset:4864
ds_read_b64_tr_b16 v[52:53], v213 offset:41472
ds_read_b64_tr_b16 v[54:55], v213 offset:41728
s_waitcnt vmcnt(10) lgkmcnt(8)
s_add_u32 m0, s64, 2048
s_nop 0
buffer_load_dwordx4 v208, s[56:59], s61 offen lds
s_add_u32 s61, s61, 147456
buffer_load_dwordx4 v[124:127], v6, s[20:23], s40 offen offset:3072
v_mfma_f32_32x32x16_bf16 v[16:31], v[56:59], v[92:95], v[16:31]
v_mfma_f32_32x32x16_bf16 v[32:47], v[60:63], v[92:95], v[32:47]
ds_read_b64_tr_b16 v[56:57], v213 offset:5120
ds_read_b64_tr_b16 v[58:59], v213 offset:5376
ds_read_b64_tr_b16 v[60:61], v213 offset:41984
ds_read_b64_tr_b16 v[62:63], v213 offset:42240
s_waitcnt vmcnt(10) lgkmcnt(8)
s_add_u32 s40, s40, 4096
buffer_load_dwordx4 v[128:131], v6, s[20:23], s40 offen offset:0
v_mfma_f32_32x32x16_bf16 v[16:31], v[248:251], v[96:99], v[16:31]
v_mfma_f32_32x32x16_bf16 v[32:47], v[252:255], v[96:99], v[32:47]
ds_read_b64_tr_b16 v[248:249], v213 offset:5632
ds_read_b64_tr_b16 v[250:251], v213 offset:5888
ds_read_b64_tr_b16 v[252:253], v213 offset:42496
ds_read_b64_tr_b16 v[254:255], v213 offset:42752
s_waitcnt vmcnt(9) lgkmcnt(8)
buffer_load_dwordx4 v[132:135], v6, s[20:23], s40 offen offset:1024
v_mfma_f32_32x32x16_bf16 v[16:31], v[48:51], v[100:103], v[16:31]
v_mfma_f32_32x32x16_bf16 v[32:47], v[52:55], v[100:103], v[32:47]
ds_read_b64_tr_b16 v[48:49], v213 offset:6144
ds_read_b64_tr_b16 v[50:51], v213 offset:6400
ds_read_b64_tr_b16 v[52:53], v213 offset:43008
ds_read_b64_tr_b16 v[54:55], v213 offset:43264
s_waitcnt vmcnt(9) lgkmcnt(8)
s_add_u32 m0, s64, 3072
s_nop 0
buffer_load_dwordx4 v208, s[56:59], s61 offen lds
s_add_u32 s61, s61, 147456
buffer_load_dwordx4 v[136:139], v6, s[20:23], s40 offen offset:2048
v_mfma_f32_32x32x16_bf16 v[16:31], v[56:59], v[104:107], v[16:31]
v_mfma_f32_32x32x16_bf16 v[32:47], v[60:63], v[104:107], v[32:47]
ds_read_b64_tr_b16 v[56:57], v213 offset:6656
ds_read_b64_tr_b16 v[58:59], v213 offset:6912
ds_read_b64_tr_b16 v[60:61], v213 offset:43520
ds_read_b64_tr_b16 v[62:63], v213 offset:43776
s_waitcnt vmcnt(10) lgkmcnt(8)
buffer_load_dwordx4 v[140:143], v6, s[20:23], s40 offen offset:3072
v_mfma_f32_32x32x16_bf16 v[16:31], v[248:251], v[108:111], v[16:31]
v_mfma_f32_32x32x16_bf16 v[32:47], v[252:255], v[108:111], v[32:47]
ds_read_b64_tr_b16 v[248:249], v213 offset:7168
ds_read_b64_tr_b16 v[250:251], v213 offset:7424
ds_read_b64_tr_b16 v[252:253], v213 offset:44032
ds_read_b64_tr_b16 v[254:255], v213 offset:44288
s_waitcnt vmcnt(9) lgkmcnt(8)
s_add_u32 s40, s40, 4096
buffer_load_dwordx4 v[144:147], v6, s[20:23], s40 offen offset:0
v_mfma_f32_32x32x16_bf16 v[16:31], v[48:51], v[112:115], v[16:31]
v_mfma_f32_32x32x16_bf16 v[32:47], v[52:55], v[112:115], v[32:47]
ds_read_b64_tr_b16 v[48:49], v213 offset:7680
ds_read_b64_tr_b16 v[50:51], v213 offset:7936
ds_read_b64_tr_b16 v[52:53], v213 offset:44544
ds_read_b64_tr_b16 v[54:55], v213 offset:44800
s_waitcnt vmcnt(9) lgkmcnt(8)
s_add_u32 m0, s64, 4096
s_nop 0
buffer_load_dwordx4 v208, s[56:59], s61 offen lds
s_add_u32 s61, s61, 147456
buffer_load_dwordx4 v[148:151], v6, s[20:23], s40 offen offset:1024
v_mfma_f32_32x32x16_bf16 v[16:31], v[56:59], v[116:119], v[16:31]
v_mfma_f32_32x32x16_bf16 v[32:47], v[60:63], v[116:119], v[32:47]
ds_read_b64_tr_b16 v[56:57], v213 offset:8192
ds_read_b64_tr_b16 v[58:59], v213 offset:8448
ds_read_b64_tr_b16 v[60:61], v213 offset:45056
ds_read_b64_tr_b16 v[62:63], v213 offset:45312
s_waitcnt vmcnt(10) lgkmcnt(8)
buffer_load_dwordx4 v[152:155], v6, s[20:23], s40 offen offset:2048
v_mfma_f32_32x32x16_bf16 v[16:31], v[248:251], v[120:123], v[16:31]
v_mfma_f32_32x32x16_bf16 v[32:47], v[252:255], v[120:123], v[32:47]
ds_read_b64_tr_b16 v[248:249], v213 offset:8704
ds_read_b64_tr_b16 v[250:251], v213 offset:8960
ds_read_b64_tr_b16 v[252:253], v213 offset:45568
ds_read_b64_tr_b16 v[254:255], v213 offset:45824
s_waitcnt vmcnt(9) lgkmcnt(8)
buffer_load_dwordx4 v[156:159], v6, s[20:23], s40 offen offset:3072
v_mfma_f32_32x32x16_bf16 v[16:31], v[48:51], v[124:127], v[16:31]
v_mfma_f32_32x32x16_bf16 v[32:47], v[52:55], v[124:127], v[32:47]
ds_read_b64_tr_b16 v[48:49], v213 offset:9216
ds_read_b64_tr_b16 v[50:51], v213 offset:9472
ds_read_b64_tr_b16 v[52:53], v213 offset:46080
ds_read_b64_tr_b16 v[54:55], v213 offset:46336
s_waitcnt vmcnt(9) lgkmcnt(8)
s_add_u32 m0, s64, 5120
s_nop 0
buffer_load_dwordx4 v208, s[56:59], s61 offen lds
s_add_u32 s61, s61, 147456
s_add_u32 s40, s40, 4096
buffer_load_dwordx4 v[160:163], v6, s[20:23], s40 offen offset:0
v_mfma_f32_32x32x16_bf16 v[16:31], v[56:59], v[128:131], v[16:31]
v_mfma_f32_32x32x16_bf16 v[32:47], v[60:63], v[128:131], v[32:47]
ds_read_b64_tr_b16 v[56:57], v213 offset:9728
ds_read_b64_tr_b16 v[58:59], v213 offset:9984
ds_read_b64_tr_b16 v[60:61], v213 offset:46592
ds_read_b64_tr_b16 v[62:63], v213 offset:46848
s_waitcnt vmcnt(10) lgkmcnt(8)
buffer_load_dwordx4 v[164:167], v6, s[20:23], s40 offen offset:1024
v_mfma_f32_32x32x16_bf16 v[16:31], v[248:251], v[132:135], v[16:31]
v_mfma_f32_32x32x16_bf16 v[32:47], v[252:255], v[132:135], v[32:47]
ds_read_b64_tr_b16 v[248:249], v213 offset:10240
ds_read_b64_tr_b16 v[250:251], v213 offset:10496
ds_read_b64_tr_b16 v[252:253], v213 offset:47104
ds_read_b64_tr_b16 v[254:255], v213 offset:47360
s_waitcnt vmcnt(9) lgkmcnt(8)
buffer_load_dwordx4 v[168:171], v6, s[20:23], s40 offen offset:2048
v_mfma_f32_32x32x16_bf16 v[16:31], v[48:51], v[136:139], v[16:31]
v_mfma_f32_32x32x16_bf16 v[32:47], v[52:55], v[136:139], v[32:47]
ds_read_b64_tr_b16 v[48:49], v213 offset:10752
ds_read_b64_tr_b16 v[50:51], v213 offset:11008
ds_read_b64_tr_b16 v[52:53], v213 offset:47616
ds_read_b64_tr_b16 v[54:55], v213 offset:47872
s_waitcnt vmcnt(9) lgkmcnt(8)
s_add_u32 m0, s64, 6144
s_nop 0
buffer_load_dwordx4 v208, s[56:59], s61 offen lds
s_add_u32 s61, s61, 147456
buffer_load_dwordx4 v[172:175], v6, s[20:23], s40 offen offset:3072
v_mfma_f32_32x32x16_bf16 v[16:31], v[56:59], v[140:143], v[16:31]
v_mfma_f32_32x32x16_bf16 v[32:47], v[60:63], v[140:143], v[32:47]
ds_read_b64_tr_b16 v[56:57], v213 offset:11264
ds_read_b64_tr_b16 v[58:59], v213 offset:11520
ds_read_b64_tr_b16 v[60:61], v213 offset:48128
ds_read_b64_tr_b16 v[62:63], v213 offset:48384
s_waitcnt vmcnt(10) lgkmcnt(8)
s_add_u32 s40, s40, 4096
buffer_load_dwordx4 v[176:179], v6, s[20:23], s40 offen offset:0
v_mfma_f32_32x32x16_bf16 v[16:31], v[248:251], v[144:147], v[16:31]
v_mfma_f32_32x32x16_bf16 v[32:47], v[252:255], v[144:147], v[32:47]
ds_read_b64_tr_b16 v[248:249], v213 offset:11776
ds_read_b64_tr_b16 v[250:251], v213 offset:12032
ds_read_b64_tr_b16 v[252:253], v213 offset:48640
ds_read_b64_tr_b16 v[254:255], v213 offset:48896
s_waitcnt vmcnt(9) lgkmcnt(8)
buffer_load_dwordx4 v[180:183], v6, s[20:23], s40 offen offset:1024
v_mfma_f32_32x32x16_bf16 v[16:31], v[48:51], v[148:151], v[16:31]
v_mfma_f32_32x32x16_bf16 v[32:47], v[52:55], v[148:151], v[32:47]
ds_read_b64_tr_b16 v[48:49], v213 offset:12288
ds_read_b64_tr_b16 v[50:51], v213 offset:12544
ds_read_b64_tr_b16 v[52:53], v213 offset:49152
ds_read_b64_tr_b16 v[54:55], v213 offset:49408
s_waitcnt vmcnt(9) lgkmcnt(8)
s_add_u32 m0, s64, 7168
s_nop 0
buffer_load_dwordx4 v208, s[56:59], s61 offen lds
s_add_u32 s61, s61, 147456
buffer_load_dwordx4 v[184:187], v6, s[20:23], s40 offen offset:2048
v_mfma_f32_32x32x16_bf16 v[16:31], v[56:59], v[152:155], v[16:31]
v_mfma_f32_32x32x16_bf16 v[32:47], v[60:63], v[152:155], v[32:47]
ds_read_b64_tr_b16 v[56:57], v213 offset:12800
ds_read_b64_tr_b16 v[58:59], v213 offset:13056
ds_read_b64_tr_b16 v[60:61], v213 offset:49664
ds_read_b64_tr_b16 v[62:63], v213 offset:49920
s_waitcnt vmcnt(10) lgkmcnt(8)
buffer_load_dwordx4 v[188:191], v6, s[20:23], s40 offen offset:3072
v_mfma_f32_32x32x16_bf16 v[16:31], v[248:251], v[156:159], v[16:31]
v_mfma_f32_32x32x16_bf16 v[32:47], v[252:255], v[156:159], v[32:47]
ds_read_b64_tr_b16 v[248:249], v213 offset:13312
ds_read_b64_tr_b16 v[250:251], v213 offset:13568
ds_read_b64_tr_b16 v[252:253], v213 offset:50176
ds_read_b64_tr_b16 v[254:255], v213 offset:50432
s_waitcnt vmcnt(9) lgkmcnt(8)
s_add_u32 s40, s40, 4096
buffer_load_dwordx4 v[192:195], v6, s[20:23], s40 offen offset:0
v_mfma_f32_32x32x16_bf16 v[16:31], v[48:51], v[160:163], v[16:31]
v_mfma_f32_32x32x16_bf16 v[32:47], v[52:55], v[160:163], v[32:47]
ds_read_b64_tr_b16 v[48:49], v213 offset:13824
ds_read_b64_tr_b16 v[50:51], v213 offset:14080
ds_read_b64_tr_b16 v[52:53], v213 offset:50688
ds_read_b64_tr_b16 v[54:55], v213 offset:50944
s_waitcnt vmcnt(9) lgkmcnt(8)
s_add_u32 m0, s64, 8192
s_nop 0
buffer_load_dwordx4 v208, s[56:59], s61 offen lds
s_add_u32 s61, s61, 147456
buffer_load_dwordx4 v[196:199], v6, s[20:23], s40 offen offset:1024
v_mfma_f32_32x32x16_bf16 v[16:31], v[56:59], v[164:167], v[16:31]
v_mfma_f32_32x32x16_bf16 v[32:47], v[60:63], v[164:167], v[32:47]
ds_read_b64_tr_b16 v[56:57], v213 offset:14336
ds_read_b64_tr_b16 v[58:59], v213 offset:14592
ds_read_b64_tr_b16 v[60:61], v213 offset:51200
ds_read_b64_tr_b16 v[62:63], v213 offset:51456
s_waitcnt vmcnt(10) lgkmcnt(8)
buffer_load_dwordx4 v[200:203], v6, s[20:23], s40 offen offset:2048
v_mfma_f32_32x32x16_bf16 v[16:31], v[248:251], v[168:171], v[16:31]
v_mfma_f32_32x32x16_bf16 v[32:47], v[252:255], v[168:171], v[32:47]
ds_read_b64_tr_b16 v[248:249], v213 offset:14848
ds_read_b64_tr_b16 v[250:251], v213 offset:15104
ds_read_b64_tr_b16 v[252:253], v213 offset:51712
ds_read_b64_tr_b16 v[254:255], v213 offset:51968
s_waitcnt vmcnt(9) lgkmcnt(8)
buffer_load_dwordx4 v[204:207], v6, s[20:23], s40 offen offset:3072
v_mfma_f32_32x32x16_bf16 v[16:31], v[48:51], v[172:175], v[16:31]
v_mfma_f32_32x32x16_bf16 v[32:47], v[52:55], v[172:175], v[32:47]
ds_read_b64_tr_b16 v[48:49], v213 offset:15360
ds_read_b64_tr_b16 v[50:51], v213 offset:15616
ds_read_b64_tr_b16 v[52:53], v213 offset:52224
ds_read_b64_tr_b16 v[54:55], v213 offset:52480
s_waitcnt vmcnt(9) lgkmcnt(8)
v_mfma_f32_32x32x16_bf16 v[16:31], v[56:59], v[176:179], v[16:31]
v_mfma_f32_32x32x16_bf16 v[32:47], v[60:63], v[176:179], v[32:47]
ds_read_b64_tr_b16 v[56:57], v213 offset:15872
ds_read_b64_tr_b16 v[58:59], v213 offset:16128
ds_read_b64_tr_b16 v[60:61], v213 offset:52736
ds_read_b64_tr_b16 v[62:63], v213 offset:52992
s_waitcnt vmcnt(8) lgkmcnt(8)
v_mfma_f32_32x32x16_bf16 v[16:31], v[248:251], v[180:183], v[16:31]
v_mfma_f32_32x32x16_bf16 v[32:47], v[252:255], v[180:183], v[32:47]
ds_read_b64_tr_b16 v[248:249], v213 offset:16384
ds_read_b64_tr_b16 v[250:251], v213 offset:16640
ds_read_b64_tr_b16 v[252:253], v213 offset:53248
ds_read_b64_tr_b16 v[254:255], v213 offset:53504
s_waitcnt vmcnt(6) lgkmcnt(8)
v_mfma_f32_32x32x16_bf16 v[16:31], v[48:51], v[184:187], v[16:31]
v_mfma_f32_32x32x16_bf16 v[32:47], v[52:55], v[184:187], v[32:47]
ds_read_b64_tr_b16 v[48:49], v213 offset:16896
ds_read_b64_tr_b16 v[50:51], v213 offset:17152
ds_read_b64_tr_b16 v[52:53], v213 offset:53760
ds_read_b64_tr_b16 v[54:55], v213 offset:54016
s_waitcnt vmcnt(5) lgkmcnt(8)
v_mfma_f32_32x32x16_bf16 v[16:31], v[56:59], v[188:191], v[16:31]
v_mfma_f32_32x32x16_bf16 v[32:47], v[60:63], v[188:191], v[32:47]
ds_read_b64_tr_b16 v[56:57], v213 offset:17408
ds_read_b64_tr_b16 v[58:59], v213 offset:17664
ds_read_b64_tr_b16 v[60:61], v213 offset:54272
ds_read_b64_tr_b16 v[62:63], v213 offset:54528
s_waitcnt vmcnt(4) lgkmcnt(8)
v_mfma_f32_32x32x16_bf16 v[16:31], v[248:251], v[192:195], v[16:31]
v_mfma_f32_32x32x16_bf16 v[32:47], v[252:255], v[192:195], v[32:47]
ds_read_b64_tr_b16 v[248:249], v213 offset:17920
ds_read_b64_tr_b16 v[250:251], v213 offset:18176
ds_read_b64_tr_b16 v[252:253], v213 offset:54784
ds_read_b64_tr_b16 v[254:255], v213 offset:55040
s_waitcnt vmcnt(2) lgkmcnt(8)
v_mfma_f32_32x32x16_bf16 v[16:31], v[48:51], v[196:199], v[16:31]
v_mfma_f32_32x32x16_bf16 v[32:47], v[52:55], v[196:199], v[32:47]
s_waitcnt vmcnt(1) lgkmcnt(4)
v_mfma_f32_32x32x16_bf16 v[16:31], v[56:59], v[200:203], v[16:31]
v_mfma_f32_32x32x16_bf16 v[32:47], v[60:63], v[200:203], v[32:47]
s_waitcnt vmcnt(0) lgkmcnt(0)
v_mfma_f32_32x32x16_bf16 v[16:31], v[248:251], v[204:207], v[16:31]
v_mfma_f32_32x32x16_bf16 v[32:47], v[252:255], v[204:207], v[32:47]
s_mov_b32 s66, s63
s_mov_b32 s63, s65
s_mov_b32 s65, s66
s_mov_b32 s68, s53
s_mov_b32 s53, s62
s_cmp_ge_u32 s53, 171
s_cbranch_scc1 g1_fin0
v_add_u32 v213, s63, v210
s_waitcnt vmcnt(0)
s_barrier
s_add_u32 s62, s53, 32
s_cmp_ge_u32 s62, 160
s_cselect_b32 s62, s80, s62
s_cmp_ge_u32 s53, 160
s_cselect_b32 s62, 255, s62
s_min_u32 s69, s62, 170
s_sub_u32 s69, s69, 27
s_add_u32 s64, s52, s65
s_cmp_eq_u32 s50, 0
s_cselect_b32 s56, s28, s32
s_cselect_b32 s57, s29, s33
s_mov_b32 s58, s30
s_mov_b32 s59, s31
s_mul_i32 s54, s51, 9216
s_lshl_b32 s55, s69, 6
s_add_u32 s61, s54, s55
s_cmp_gt_u32 s62, 170
s_cselect_b32 s58, 0, s58
s_cmp_lt_u32 s68, 27
s_cbranch_scc1 g1_b2q
ds_read_b64_tr_b16 v[48:49], v213 offset:0
ds_read_b64_tr_b16 v[50:51], v213 offset:256
ds_read_b64_tr_b16 v[52:53], v213 offset:36864
ds_read_b64_tr_b16 v[54:55], v213 offset:37120
ds_read_b64_tr_b16 v[56:57], v213 offset:512
ds_read_b64_tr_b16 v[58:59], v213 offset:768
ds_read_b64_tr_b16 v[60:61], v213 offset:37376
ds_read_b64_tr_b16 v[62:63], v213 offset:37632
ds_read_b64_tr_b16 v[248:249], v213 offset:1024
ds_read_b64_tr_b16 v[250:251], v213 offset:1280
ds_read_b64_tr_b16 v[252:253], v213 offset:37888
ds_read_b64_tr_b16 v[254:255], v213 offset:38144
s_waitcnt lgkmcnt(8)
v_mfma_f32_32x32x16_bf16 v[216:231], v[48:51], v[64:67], 0
v_mfma_f32_32x32x16_bf16 v[232:247], v[52:55], v[64:67], 0
ds_read_b64_tr_b16 v[48:49], v213 offset:1536
ds_read_b64_tr_b16 v[50:51], v213 offset:1792
ds_read_b64_tr_b16 v[52:53], v213 offset:38400
ds_read_b64_tr_b16 v[54:55], v213 offset:38656
s_waitcnt lgkmcnt(8)
s_add_u32 m0, s64, 0
s_nop 0
buffer_load_dwordx4 v208, s[56:59], s61 offen lds
s_add_u32 s61, s61, 147456
v_mfma_f32_32x32x16_bf16 v[216:231], v[56:59], v[68:71], v[216:231]
v_mfma_f32_32x32x16_bf16 v[232:247], v[60:63], v[68:71], v[232:247]
ds_read_b64_tr_b16 v[56:57], v213 offset:2048
ds_read_b64_tr_b16 v[58:59], v213 offset:2304
ds_read_b64_tr_b16 v[60:61], v213 offset:38912
ds_read_b64_tr_b16 v[62:63], v213 offset:39168
s_waitcnt lgkmcnt(8)
v_mfma_f32_32x32x16_bf16 v[216:231], v[248:251], v[72:75], v[216:231]
v_mfma_f32_32x32x16_bf16 v[232:247], v[252:255], v[72:75], v[232:247]
ds_read_b64_tr_b16 v[248:249], v213 offset:2560
ds_read_b64_tr_b16 v[250:251], v213 offset:2816
ds_read_b64_tr_b16 v[252:253], v213 offset:39424
ds_read_b64_tr_b16 v[254:255], v213 offset:39680
s_waitcnt lgkmcnt(8)
v_mfma_f32_32x32x16_bf16 v[216:231], v[48:51], v[76:79], v[216:231]
v_mul_f32 v8, 0xbfb8aa3b, v16
v_exp_f32 v8, v8
v_mfma_f32_32x32x16_bf16 v[232:247], v[52:55], v[76:79], v[232:247]
v_mul_f32 v16, v16, v32
v_add_f32 v8, 1.0, v8
ds_read_b64_tr_b16 v[48:49], v213 offset:3072
ds_read_b64_tr_b16 v[50:51], v213 offset:3328
ds_read_b64_tr_b16 v[52:53], v213 offset:39936
ds_read_b64_tr_b16 v[54:55], v213 offset:40192
s_waitcnt lgkmcnt(8)
s_add_u32 m0, s64, 1024
s_nop 0
buffer_load_dwordx4 v208, s[56:59], s61 offen lds
s_add_u32 s61, s61, 147456
v_mfma_f32_32x32x16_bf16 v[216:231], v[56:59], v[80:83], v[216:231]
v_rcp_f32 v8, v8
s_nop 0
v_mfma_f32_32x32x16_bf16 v[232:247], v[60:63], v[80:83], v[232:247]
v_mul_f32 v16, v16, v8
v_mul_f32 v9, 0xbfb8aa3b, v17
ds_read_b64_tr_b16 v[56:57], v213 offset:3584
ds_read_b64_tr_b16 v[58:59], v213 offset:3840
ds_read_b64_tr_b16 v[60:61], v213 offset:40448
ds_read_b64_tr_b16 v[62:63], v213 offset:40704
s_waitcnt lgkmcnt(8)
v_mfma_f32_32x32x16_bf16 v[216:231], v[248:251], v[84:87], v[216:231]
v_exp_f32 v9, v9
v_mul_f32 v17, v17, v33
v_mfma_f32_32x32x16_bf16 v[232:247], v[252:255], v[84:87], v[232:247]
v_add_f32 v9, 1.0, v9
v_rcp_f32 v9, v9
ds_read_b64_tr_b16 v[248:249], v213 offset:4096
ds_read_b64_tr_b16 v[250:251], v213 offset:4352
ds_read_b64_tr_b16 v[252:253], v213 offset:40960
ds_read_b64_tr_b16 v[254:255], v213 offset:41216
s_waitcnt lgkmcnt(8)
v_mfma_f32_32x32x16_bf16 v[216:231], v[48:51], v[88:91], v[216:231]
s_nop 0
v_mul_f32 v17, v17, v9
v_mfma_f32_32x32x16_bf16 v[232:247], v[52:55], v[88:91], v[232:247]
v_mul_f32 v10, 0xbfb8aa3b, v18
v_exp_f32 v10, v10
ds_read_b64_tr_b16 v[48:49], v213 offset:4608
ds_read_b64_tr_b16 v[50:51], v213 offset:4864
ds_read_b64_tr_b16 v[52:53], v213 offset:41472
ds_read_b64_tr_b16 v[54:55], v213 offset:41728
s_waitcnt lgkmcnt(8)
s_add_u32 m0, s64, 2048
s_nop 0
buffer_load_dwordx4 v208, s[56:59], s61 offen lds
s_add_u32 s61, s61, 147456
v_mfma_f32_32x32x16_bf16 v[216:231], v[56:59], v[92:95], v[216:231]
v_mul_f32 v18, v18, v34
v_add_f32 v10, 1.0, v10
v_mfma_f32_32x32x16_bf16 v[232:247], v[60:63], v[92:95], v[232:247]
v_rcp_f32 v10, v10
s_nop 0
ds_read_b64_tr_b16 v[56:57], v213 offset:5120
ds_read_b64_tr_b16 v[58:59], v213 offset:5376
ds_read_b64_tr_b16 v[60:61], v213 offset:41984
ds_read_b64_tr_b16 v[62:63], v213 offset:42240
s_waitcnt lgkmcnt(8)
v_mfma_f32_32x32x16_bf16 v[216:231], v[248:251], v[96:99], v[216:231]
v_mul_f32 v18, v18, v10
v_mul_f32 v11, 0xbfb8aa3b, v19
v_mfma_f32_32x32x16_bf16 v[232:247], v[252:255], v[96:99], v[232:247]
v_exp_f32 v11, v11
v_mul_f32 v19, v19, v35
ds_read_b64_tr_b16 v[248:249], v213 offset:5632
ds_read_b64_tr_b16 v[250:251], v213 offset:5888
ds_read_b64_tr_b16 v[252:253], v213 offset:42496
ds_read_b64_tr_b16 v[254:255], v213 offset:42752
s_waitcnt lgkmcnt(8)
v_mfma_f32_32x32x16_bf16 v[216:231], v[48:51], v[100:103], v[216:231]
v_add_f32 v11, 1.0, v11
v_rcp_f32 v11, v11
v_mfma_f32_32x32x16_bf16 v[232:247], v[52:55], v[100:103], v[232:247]
s_nop 0
v_mul_f32 v19, v19, v11
ds_read_b64_tr_b16 v[48:49], v213 offset:6144
ds_read_b64_tr_b16 v[50:51], v213 offset:6400
ds_read_b64_tr_b16 v[52:53], v213 offset:43008
ds_read_b64_tr_b16 v[54:55], v213 offset:43264
s_waitcnt lgkmcnt(8)
s_add_u32 m0, s64, 3072
s_nop 0
buffer_load_dwordx4 v208, s[56:59], s61 offen lds
s_add_u32 s61, s61, 147456
v_mfma_f32_32x32x16_bf16 v[216:231], v[56:59], v[104:107], v[216:231]
v_mul_f32 v8, 0xbfb8aa3b, v20
v_exp_f32 v8, v8
v_mfma_f32_32x32x16_bf16 v[232:247], v[60:63], v[104:107], v[232:247]
v_mul_f32 v20, v20, v36
v_add_f32 v8, 1.0, v8
ds_read_b64_tr_b16 v[56:57], v213 offset:6656
ds_read_b64_tr_b16 v[58:59], v213 offset:6912
ds_read_b64_tr_b16 v[60:61], v213 offset:43520
ds_read_b64_tr_b16 v[62:63], v213 offset:43776
s_waitcnt lgkmcnt(8)
v_mfma_f32_32x32x16_bf16 v[216:231], v[248:251], v[108:111], v[216:231]
v_rcp_f32 v8, v8
s_nop 0
v_mfma_f32_32x32x16_bf16 v[232:247], v[252:255], v[108:111], v[232:247]
v_mul_f32 v20, v20, v8
v_mul_f32 v9, 0xbfb8aa3b, v21
ds_read_b64_tr_b16 v[248:249], v213 offset:7168
ds_read_b64_tr_b16 v[250:251], v213 offset:7424
ds_read_b64_tr_b16 v[252:253], v213 offset:44032
ds_read_b64_tr_b16 v[254:255], v213 offset:44288
s_waitcnt lgkmcnt(8)
v_mfma_f32_32x32x16_bf16 v[216:231], v[48:51], v[112:115], v[216:231]
v_exp_f32 v9, v9
v_mul_f32 v21, v21, v37
v_mfma_f32_32x32x16_bf16 v[232:247], v[52:55], v[112:115], v[232:247]
v_add_f32 v9, 1.0, v9
v_rcp_f32 v9, v9
ds_read_b64_tr_b16 v[48:49], v213 offset:7680
ds_read_b64_tr_b16 v[50:51], v213 offset:7936
ds_read_b64_tr_b16 v[52:53], v213 offset:44544
ds_read_b64_tr_b16 v[54:55], v213 offset:44800
s_waitcnt lgkmcnt(8)
s_add_u32 m0, s64, 4096
s_nop 0
buffer_load_dwordx4 v208, s[56:59], s61 offen lds
s_add_u32 s61, s61, 147456
v_mfma_f32_32x32x16_bf16 v[216:231], v[56:59], v[116:119], v[216:231]
s_nop 0
v_mul_f32 v21, v21, v9
v_mfma_f32_32x32x16_bf16 v[232:247], v[60:63], v[116:119], v[232:247]
v_mul_f32 v10, 0xbfb8aa3b, v22
v_exp_f32 v10, v10
ds_read_b64_tr_b16 v[56:57], v213 offset:8192
ds_read_b64_tr_b16 v[58:59], v213 offset:8448
ds_read_b64_tr_b16 v[60:61], v213 offset:45056
ds_read_b64_tr_b16 v[62:63], v213 offset:45312
s_waitcnt lgkmcnt(8)
v_mfma_f32_32x32x16_bf16 v[216:231], v[248:251], v[120:123], v[216:231]
v_mul_f32 v22, v22, v38
v_add_f32 v10, 1.0, v10
v_mfma_f32_32x32x16_bf16 v[232:247], v[252:255], v[120:123], v[232:247]
v_rcp_f32 v10, v10
s_nop 0
ds_read_b64_tr_b16 v[248:249], v213 offset:8704
ds_read_b64_tr_b16 v[250:251], v213 offset:8960
ds_read_b64_tr_b16 v[252:253], v213 offset:45568
ds_read_b64_tr_b16 v[254:255], v213 offset:45824
s_waitcnt lgkmcnt(8)
v_mfma_f32_32x32x16_bf16 v[216:231], v[48:51], v[124:127], v[216:231]
v_mul_f32 v22, v22, v10
v_mul_f32 v11, 0xbfb8aa3b, v23
v_mfma_f32_32x32x16_bf16 v[232:247], v[52:55], v[124:127], v[232:247]
v_exp_f32 v11, v11
v_mul_f32 v23, v23, v39
ds_read_b64_tr_b16 v[48:49], v213 offset:9216
ds_read_b64_tr_b16 v[50:51], v213 offset:9472
ds_read_b64_tr_b16 v[52:53], v213 offset:46080
ds_read_b64_tr_b16 v[54:55], v213 offset:46336
s_waitcnt lgkmcnt(8)
s_add_u32 m0, s64, 5120
s_nop 0
buffer_load_dwordx4 v208, s[56:59], s61 offen lds
s_add_u32 s61, s61, 147456
v_mfma_f32_32x32x16_bf16 v[216:231], v[56:59], v[128:131], v[216:231]
v_add_f32 v11, 1.0, v11
v_rcp_f32 v11, v11
v_mfma_f32_32x32x16_bf16 v[232:247], v[60:63], v[128:131], v[232:247]
s_nop 0
v_mul_f32 v23, v23, v11
ds_read_b64_tr_b16 v[56:57], v213 offset:9728
ds_read_b64_tr_b16 v[58:59], v213 offset:9984
ds_read_b64_tr_b16 v[60:61], v213 offset:46592
ds_read_b64_tr_b16 v[62:63], v213 offset:46848
s_waitcnt lgkmcnt(8)
v_mfma_f32_32x32x16_bf16 v[216:231], v[248:251], v[132:135], v[216:231]
v_mul_f32 v8, 0xbfb8aa3b, v24
v_exp_f32 v8, v8
v_mfma_f32_32x32x16_bf16 v[232:247], v[252:255], v[132:135], v[232:247]
v_mul_f32 v24, v24, v40
v_add_f32 v8, 1.0, v8
ds_read_b64_tr_b16 v[248:249], v213 offset:10240
ds_read_b64_tr_b16 v[250:251], v213 offset:10496
ds_read_b64_tr_b16 v[252:253], v213 offset:47104
ds_read_b64_tr_b16 v[254:255], v213 offset:47360
s_waitcnt lgkmcnt(8)
v_mfma_f32_32x32x16_bf16 v[216:231], v[48:51], v[136:139], v[216:231]
v_rcp_f32 v8, v8
s_nop 0
v_mfma_f32_32x32x16_bf16 v[232:247], v[52:55], v[136:139], v[232:247]
v_mul_f32 v24, v24, v8
v_mul_f32 v9, 0xbfb8aa3b, v25
ds_read_b64_tr_b16 v[48:49], v213 offset:10752
ds_read_b64_tr_b16 v[50:51], v213 offset:11008
ds_read_b64_tr_b16 v[52:53], v213 offset:47616
ds_read_b64_tr_b16 v[54:55], v213 offset:47872
s_waitcnt lgkmcnt(8)
s_add_u32 m0, s64, 6144
s_nop 0
buffer_load_dwordx4 v208, s[56:59], s61 offen lds
s_add_u32 s61, s61, 147456
v_mfma_f32_32x32x16_bf16 v[216:231], v[56:59], v[140:143], v[216:231]
v_exp_f32 v9, v9
v_mul_f32 v25, v25, v41
v_mfma_f32_32x32x16_bf16 v[232:247], v[60:63], v[140:143], v[232:247]
v_add_f32 v9, 1.0, v9
v_rcp_f32 v9, v9
ds_read_b64_tr_b16 v[56:57], v213 offset:11264
ds_read_b64_tr_b16 v[58:59], v213 offset:11520
ds_read_b64_tr_b16 v[60:61], v213 offset:48128
ds_read_b64_tr_b16 v[62:63], v213 offset:48384
s_waitcnt lgkmcnt(8)
v_mfma_f32_32x32x16_bf16 v[216:231], v[248:251], v[144:147], v[216:231]
s_nop 0
v_mul_f32 v25, v25, v9
v_mfma_f32_32x32x16_bf16 v[232:247], v[252:255], v[144:147], v[232:247]
v_mul_f32 v10, 0xbfb8aa3b, v26
v_exp_f32 v10, v10
ds_read_b64_tr_b16 v[248:249], v213 offset:11776
ds_read_b64_tr_b16 v[250:251], v213 offset:12032
ds_read_b64_tr_b16 v[252:253], v213 offset:48640
ds_read_b64_tr_b16 v[254:255], v213 offset:48896
s_waitcnt lgkmcnt(8)
v_mfma_f32_32x32x16_bf16 v[216:231], v[48:51], v[148:151], v[216:231]
v_mul_f32 v26, v26, v42
v_add_f32 v10, 1.0, v10
v_mfma_f32_32x32x16_bf16 v[232:247], v[52:55], v[148:151], v[232:247]
v_rcp_f32 v10, v10
s_nop 0
ds_read_b64_tr_b16 v[48:49], v213 offset:12288
ds_read_b64_tr_b16 v[50:51], v213 offset:12544
ds_read_b64_tr_b16 v[52:53], v213 offset:49152
ds_read_b64_tr_b16 v[54:55], v213 offset:49408
s_waitcnt lgkmcnt(8)
s_add_u32 m0, s64, 7168
s_nop 0
buffer_load_dwordx4 v208, s[56:59], s61 offen lds
s_add_u32 s61, s61, 147456
v_mfma_f32_32x32x16_bf16 v[216:231], v[56:59], v[152:155], v[216:231]
v_mul_f32 v26, v26, v10
v_mul_f32 v11, 0xbfb8aa3b, v27
v_mfma_f32_32x32x16_bf16 v[232:247], v[60:63], v[152:155], v[232:247]
v_exp_f32 v11, v11
v_mul_f32 v27, v27, v43
ds_read_b64_tr_b16 v[56:57], v213 offset:12800
ds_read_b64_tr_b16 v[58:59], v213 offset:13056
ds_read_b64_tr_b16 v[60:61], v213 offset:49664
ds_read_b64_tr_b16 v[62:63], v213 offset:49920
s_waitcnt lgkmcnt(8)
v_mfma_f32_32x32x16_bf16 v[216:231], v[248:251], v[156:159], v[216:231]
v_add_f32 v11, 1.0, v11
v_rcp_f32 v11, v11
v_mfma_f32_32x32x16_bf16 v[232:247], v[252:255], v[156:159], v[232:247]
s_nop 0
v_mul_f32 v27, v27, v11
ds_read_b64_tr_b16 v[248:249], v213 offset:13312
ds_read_b64_tr_b16 v[250:251], v213 offset:13568
ds_read_b64_tr_b16 v[252:253], v213 offset:50176
ds_read_b64_tr_b16 v[254:255], v213 offset:50432
s_waitcnt lgkmcnt(8)
v_mfma_f32_32x32x16_bf16 v[216:231], v[48:51], v[160:163], v[216:231]
v_mul_f32 v8, 0xbfb8aa3b, v28
v_exp_f32 v8, v8
v_mfma_f32_32x32x16_bf16 v[232:247], v[52:55], v[160:163], v[232:247]
v_mul_f32 v28, v28, v44
v_add_f32 v8, 1.0, v8
ds_read_b64_tr_b16 v[48:49], v213 offset:13824
ds_read_b64_tr_b16 v[50:51], v213 offset:14080
ds_read_b64_tr_b16 v[52:53], v213 offset:50688
ds_read_b64_tr_b16 v[54:55], v213 offset:50944
s_waitcnt lgkmcnt(8)
s_add_u32 m0, s64, 8192
s_nop 0
buffer_load_dwordx4 v208, s[56:59], s61 offen lds
s_add_u32 s61, s61, 147456
v_mfma_f32_32x32x16_bf16 v[216:231], v[56:59], v[164:167], v[216:231]
v_rcp_f32 v8, v8
s_nop 0
v_mfma_f32_32x32x16_bf16 v[232:247], v[60:63], v[164:167], v[232:247]
v_mul_f32 v28, v28, v8
v_mul_f32 v9, 0xbfb8aa3b, v29
ds_read_b64_tr_b16 v[56:57], v213 offset:14336
ds_read_b64_tr_b16 v[58:59], v213 offset:14592
ds_read_b64_tr_b16 v[60:61], v213 offset:51200
ds_read_b64_tr_b16 v[62:63], v213 offset:51456
s_waitcnt lgkmcnt(8)
v_mfma_f32_32x32x16_bf16 v[216:231], v[248:251], v[168:171], v[216:231]
v_exp_f32 v9, v9
v_mul_f32 v29, v29, v45
v_mfma_f32_32x32x16_bf16 v[232:247], v[252:255], v[168:171], v[232:247]
v_add_f32 v9, 1.0, v9
v_rcp_f32 v9, v9
ds_read_b64_tr_b16 v[248:249], v213 offset:14848
ds_read_b64_tr_b16 v[250:251], v213 offset:15104
ds_read_b64_tr_b16 v[252:253], v213 offset:51712
ds_read_b64_tr_b16 v[254:255], v213 offset:51968
s_waitcnt lgkmcnt(8)
v_mfma_f32_32x32x16_bf16 v[216:231], v[48:51], v[172:175], v[216:231]
s_nop 0
v_mul_f32 v29, v29, v9
v_mfma_f32_32x32x16_bf16 v[232:247], v[52:55], v[172:175], v[232:247]
v_mul_f32 v10, 0xbfb8aa3b, v30
v_exp_f32 v10, v10
ds_read_b64_tr_b16 v[48:49], v213 offset:15360
ds_read_b64_tr_b16 v[50:51], v213 offset:15616
ds_read_b64_tr_b16 v[52:53], v213 offset:52224
ds_read_b64_tr_b16 v[54:55], v213 offset:52480
s_waitcnt lgkmcnt(8)
v_mfma_f32_32x32x16_bf16 v[216:231], v[56:59], v[176:179], v[216:231]
v_mul_f32 v30, v30, v46
v_add_f32 v10, 1.0, v10
v_mfma_f32_32x32x16_bf16 v[232:247], v[60:63], v[176:179], v[232:247]
v_rcp_f32 v10, v10
s_nop 0
ds_read_b64_tr_b16 v[56:57], v213 offset:15872
ds_read_b64_tr_b16 v[58:59], v213 offset:16128
ds_read_b64_tr_b16 v[60:61], v213 offset:52736
ds_read_b64_tr_b16 v[62:63], v213 offset:52992
s_waitcnt lgkmcnt(8)
v_mfma_f32_32x32x16_bf16 v[216:231], v[248:251], v[180:183], v[216:231]
v_mul_f32 v30, v30, v10
v_mul_f32 v11, 0xbfb8aa3b, v31
v_mfma_f32_32x32x16_bf16 v[232:247], v[252:255], v[180:183], v[232:247]
v_exp_f32 v11, v11
v_mul_f32 v31, v31, v47
ds_read_b64_tr_b16 v[248:249], v213 offset:16384
ds_read_b64_tr_b16 v[250:251], v213 offset:16640
ds_read_b64_tr_b16 v[252:253], v213 offset:53248
ds_read_b64_tr_b16 v[254:255], v213 offset:53504
s_waitcnt lgkmcnt(8)
v_mfma_f32_32x32x16_bf16 v[216:231], v[48:51], v[184:187], v[216:231]
v_add_f32 v11, 1.0, v11
v_rcp_f32 v11, v11
v_mfma_f32_32x32x16_bf16 v[232:247], v[52:55], v[184:187], v[232:247]
s_nop 0
v_mul_f32 v31, v31, v11
ds_read_b64_tr_b16 v[48:49], v213 offset:16896
ds_read_b64_tr_b16 v[50:51], v213 offset:17152
ds_read_b64_tr_b16 v[52:53], v213 offset:53760
ds_read_b64_tr_b16 v[54:55], v213 offset:54016
s_waitcnt lgkmcnt(8)
v_mfma_f32_32x32x16_bf16 v[216:231], v[56:59], v[188:191], v[216:231]
v_cvt_pk_bf16_f32 v32, v16, v17
v_cvt_pk_bf16_f32 v33, v18, v19
v_mfma_f32_32x32x16_bf16 v[232:247], v[60:63], v[188:191], v[232:247]
v_cvt_pk_bf16_f32 v34, v20, v21
v_cvt_pk_bf16_f32 v35, v22, v23
ds_read_b64_tr_b16 v[56:57], v213 offset:17408
ds_read_b64_tr_b16 v[58:59], v213 offset:17664
ds_read_b64_tr_b16 v[60:61], v213 offset:54272
ds_read_b64_tr_b16 v[62:63], v213 offset:54528
s_waitcnt lgkmcnt(8)
v_mfma_f32_32x32x16_bf16 v[216:231], v[248:251], v[192:195], v[216:231]
v_cvt_pk_bf16_f32 v36, v24, v25
v_cvt_pk_bf16_f32 v37, v26, v27
v_mfma_f32_32x32x16_bf16 v[232:247], v[252:255], v[192:195], v[232:247]
v_cvt_pk_bf16_f32 v38, v28, v29
v_cvt_pk_bf16_f32 v39, v30, v31
ds_read_b64_tr_b16 v[248:249], v213 offset:17920
ds_read_b64_tr_b16 v[250:251], v213 offset:18176
ds_read_b64_tr_b16 v[252:253], v213 offset:54784
ds_read_b64_tr_b16 v[254:255], v213 offset:55040
s_waitcnt lgkmcnt(8)
v_mfma_f32_32x32x16_bf16 v[216:231], v[48:51], v[196:199], v[216:231]
s_sub_u32 s67, s68, 27
s_lshl_b32 s67, s67, 6
v_mfma_f32_32x32x16_bf16 v[232:247], v[52:55], v[196:199], v[232:247]
buffer_store_dwordx2 v[32:33], v211, s[44:47], s67 offen offset:0
buffer_store_dwordx2 v[34:35], v211, s[44:47], s67 offen offset:16
s_waitcnt lgkmcnt(4)
v_mfma_f32_32x32x16_bf16 v[216:231], v[56:59], v[200:203], v[216:231]
buffer_store_dwordx2 v[36:37], v211, s[44:47], s67 offen offset:32
buffer_store_dwordx2 v[38:39], v211, s[44:47], s67 offen offset:48
v_mfma_f32_32x32x16_bf16 v[232:247], v[60:63], v[200:203], v[232:247]
s_waitcnt lgkmcnt(0)
v_mfma_f32_32x32x16_bf16 v[216:231], v[248:251], v[204:207], v[216:231]
v_mfma_f32_32x32x16_bf16 v[232:247], v[252:255], v[204:207], v[232:247]
s_branch g1_b2d
g1_b2q:
ds_read_b64_tr_b16 v[48:49], v213 offset:0
ds_read_b64_tr_b16 v[50:51], v213 offset:256
ds_read_b64_tr_b16 v[52:53], v213 offset:36864
ds_read_b64_tr_b16 v[54:55], v213 offset:37120
ds_read_b64_tr_b16 v[56:57], v213 offset:512
ds_read_b64_tr_b16 v[58:59], v213 offset:768
ds_read_b64_tr_b16 v[60:61], v213 offset:37376
ds_read_b64_tr_b16 v[62:63], v213 offset:37632
ds_read_b64_tr_b16 v[248:249], v213 offset:1024
ds_read_b64_tr_b16 v[250:251], v213 offset:1280
ds_read_b64_tr_b16 v[252:253], v213 offset:37888
ds_read_b64_tr_b16 v[254:255], v213 offset:38144
s_waitcnt lgkmcnt(8)
v_mfma_f32_32x32x16_bf16 v[216:231], v[48:51], v[64:67], 0
v_mfma_f32_32x32x16_bf16 v[232:247], v[52:55], v[64:67], 0
ds_read_b64_tr_b16 v[48:49], v213 offset:1536
ds_read_b64_tr_b16 v[50:51], v213 offset:1792
ds_read_b64_tr_b16 v[52:53], v213 offset:38400
ds_read_b64_tr_b16 v[54:55], v213 offset:38656
s_waitcnt lgkmcnt(8)
s_add_u32 m0, s64, 0
s_nop 0
buffer_load_dwordx4 v208, s[56:59], s61 offen lds
s_add_u32 s61, s61, 147456
v_mfma_f32_32x32x16_bf16 v[216:231], v[56:59], v[68:71], v[216:231]
v_mfma_f32_32x32x16_bf16 v[232:247], v[60:63], v[68:71], v[232:247]
ds_read_b64_tr_b16 v[56:57], v213 offset:2048
ds_read_b64_tr_b16 v[58:59], v213 offset:2304
ds_read_b64_tr_b16 v[60:61], v213 offset:38912
ds_read_b64_tr_b16 v[62:63], v213 offset:39168
s_waitcnt lgkmcnt(8)
v_mfma_f32_32x32x16_bf16 v[216:231], v[248:251], v[72:75], v[216:231]
v_mfma_f32_32x32x16_bf16 v[232:247], v[252:255], v[72:75], v[232:247]
ds_read_b64_tr_b16 v[248:249], v213 offset:2560
ds_read_b64_tr_b16 v[250:251], v213 offset:2816
ds_read_b64_tr_b16 v[252:253], v213 offset:39424
ds_read_b64_tr_b16 v[254:255], v213 offset:39680
s_waitcnt lgkmcnt(8)
v_mfma_f32_32x32x16_bf16 v[216:231], v[48:51], v[76:79], v[216:231]
s_lshl_b32 s72, s68, 1
s_add_u32 s72, s72, 0
v_mfma_f32_32x32x16_bf16 v[232:247], v[52:55], v[76:79], v[232:247]
s_cmp_lt_u32 s72, 18
s_cselect_b32 s73, 0x3eae1a93, 1.0
ds_read_b64_tr_b16 v[48:49], v213 offset:3072
ds_read_b64_tr_b16 v[50:51], v213 offset:3328
ds_read_b64_tr_b16 v[52:53], v213 offset:39936
ds_read_b64_tr_b16 v[54:55], v213 offset:40192
s_waitcnt lgkmcnt(8)
s_add_u32 m0, s64, 1024
s_nop 0
buffer_load_dwordx4 v208, s[56:59], s61 offen lds
s_add_u32 s61, s61, 147456
v_mfma_f32_32x32x16_bf16 v[216:231], v[56:59], v[80:83], v[216:231]
v_mul_f32 v16, s73, v16
v_mul_f32 v17, s73, v17
v_mfma_f32_32x32x16_bf16 v[232:247], v[60:63], v[80:83], v[232:247]
v_mul_f32 v18, s73, v18
v_mul_f32 v19, s73, v19
ds_read_b64_tr_b16 v[56:57], v213 offset:3584
ds_read_b64_tr_b16 v[58:59], v213 offset:3840
ds_read_b64_tr_b16 v[60:61], v213 offset:40448
ds_read_b64_tr_b16 v[62:63], v213 offset:40704
s_waitcnt lgkmcnt(8)
v_mfma_f32_32x32x16_bf16 v[216:231], v[248:251], v[84:87], v[216:231]
v_mul_f32 v20, s73, v20
v_mul_f32 v21, s73, v21
v_mfma_f32_32x32x16_bf16 v[232:247], v[252:255], v[84:87], v[232:247]
v_mul_f32 v22, s73, v22
v_mul_f32 v23, s73, v23
ds_read_b64_tr_b16 v[248:249], v213 offset:4096
ds_read_b64_tr_b16 v[250:251], v213 offset:4352
ds_read_b64_tr_b16 v[252:253], v213 offset:40960
ds_read_b64_tr_b16 v[254:255], v213 offset:41216
s_waitcnt lgkmcnt(8)
v_mfma_f32_32x32x16_bf16 v[216:231], v[48:51], v[88:91], v[216:231]
v_mul_f32 v24, s73, v24
v_mul_f32 v25, s73, v25
v_mfma_f32_32x32x16_bf16 v[232:247], v[52:55], v[88:91], v[232:247]
v_mul_f32 v26, s73, v26
v_mul_f32 v27, s73, v27
ds_read_b64_tr_b16 v[48:49], v213 offset:4608
ds_read_b64_tr_b16 v[50:51], v213 offset:4864
ds_read_b64_tr_b16 v[52:53], v213 offset:41472
ds_read_b64_tr_b16 v[54:55], v213 offset:41728
s_waitcnt lgkmcnt(8)
s_add_u32 m0, s64, 2048
s_nop 0
buffer_load_dwordx4 v208, s[56:59], s61 offen lds
s_add_u32 s61, s61, 147456
v_mfma_f32_32x32x16_bf16 v[216:231], v[56:59], v[92:95], v[216:231]
v_mul_f32 v28, s73, v28
v_mul_f32 v29, s73, v29
v_mfma_f32_32x32x16_bf16 v[232:247], v[60:63], v[92:95], v[232:247]
v_mul_f32 v30, s73, v30
v_mul_f32 v31, s73, v31
ds_read_b64_tr_b16 v[56:57], v213 offset:5120
ds_read_b64_tr_b16 v[58:59], v213 offset:5376
ds_read_b64_tr_b16 v[60:61], v213 offset:41984
ds_read_b64_tr_b16 v[62:63], v213 offset:42240
s_waitcnt lgkmcnt(8)
v_mfma_f32_32x32x16_bf16 v[216:231], v[248:251], v[96:99], v[216:231]
v_cvt_pk_bf16_f32 v16, v16, v17
v_cvt_pk_bf16_f32 v17, v18, v19
v_mfma_f32_32x32x16_bf16 v[232:247], v[252:255], v[96:99], v[232:247]
v_cvt_pk_bf16_f32 v18, v20, v21
v_cvt_pk_bf16_f32 v19, v22, v23
ds_read_b64_tr_b16 v[248:249], v213 offset:5632
ds_read_b64_tr_b16 v[250:251], v213 offset:5888
ds_read_b64_tr_b16 v[252:253], v213 offset:42496
ds_read_b64_tr_b16 v[254:255], v213 offset:42752
s_waitcnt lgkmcnt(8)
v_mfma_f32_32x32x16_bf16 v[216:231], v[48:51], v[100:103], v[216:231]
v_cvt_pk_bf16_f32 v20, v24, v25
v_cvt_pk_bf16_f32 v21, v26, v27
v_mfma_f32_32x32x16_bf16 v[232:247], v[52:55], v[100:103], v[232:247]
v_cvt_pk_bf16_f32 v22, v28, v29
v_cvt_pk_bf16_f32 v23, v30, v31
ds_read_b64_tr_b16 v[48:49], v213 offset:6144
ds_read_b64_tr_b16 v[50:51], v213 offset:6400
ds_read_b64_tr_b16 v[52:53], v213 offset:43008
ds_read_b64_tr_b16 v[54:55], v213 offset:43264
s_waitcnt lgkmcnt(8)
s_add_u32 m0, s64, 3072
s_nop 0
buffer_load_dwordx4 v208, s[56:59], s61 offen lds
s_add_u32 s61, s61, 147456
v_mfma_f32_32x32x16_bf16 v[216:231], v[56:59], v[104:107], v[216:231]
ds_write_b64 v7, v[16:17] offset:0
ds_write_b64 v7, v[18:19] offset:16
v_mfma_f32_32x32x16_bf16 v[232:247], v[60:63], v[104:107], v[232:247]
ds_write_b64 v7, v[20:21] offset:32
ds_write_b64 v7, v[22:23] offset:48
ds_read_b64_tr_b16 v[56:57], v213 offset:6656
ds_read_b64_tr_b16 v[58:59], v213 offset:6912
ds_read_b64_tr_b16 v[60:61], v213 offset:43520
ds_read_b64_tr_b16 v[62:63], v213 offset:43776
s_waitcnt lgkmcnt(8)
v_mfma_f32_32x32x16_bf16 v[216:231], v[248:251], v[108:111], v[216:231]
ds_read_b32 v24, v12 offset:0
ds_read_b32 v25, v12 offset:256
v_mfma_f32_32x32x16_bf16 v[232:247], v[252:255], v[108:111], v[232:247]
ds_read_b32 v26, v12 offset:512
ds_read_b32 v27, v12 offset:768
ds_read_b64_tr_b16 v[248:249], v213 offset:7168
ds_read_b64_tr_b16 v[250:251], v213 offset:7424
ds_read_b64_tr_b16 v[252:253], v213 offset:44032
ds_read_b64_tr_b16 v[254:255], v213 offset:44288
s_waitcnt lgkmcnt(8)
v_mfma_f32_32x32x16_bf16 v[216:231], v[48:51], v[112:115], v[216:231]
ds_read_b32 v28, v12 offset:1024
ds_read_b32 v29, v12 offset:1280
v_mfma_f32_32x32x16_bf16 v[232:247], v[52:55], v[112:115], v[232:247]
ds_read_b32 v30, v12 offset:1536
ds_read_b32 v31, v12 offset:1792
ds_read_b64_tr_b16 v[48:49], v213 offset:7680
ds_read_b64_tr_b16 v[50:51], v213 offset:7936
ds_read_b64_tr_b16 v[52:53], v213 offset:44544
ds_read_b64_tr_b16 v[54:55], v213 offset:44800
s_waitcnt lgkmcnt(8)
s_add_u32 m0, s64, 4096
s_nop 0
buffer_load_dwordx4 v208, s[56:59], s61 offen lds
s_add_u32 s61, s61, 147456
v_mfma_f32_32x32x16_bf16 v[216:231], v[56:59], v[116:119], v[216:231]
s_mul_i32 s74, s72, 3641
s_lshr_b32 s74, s74, 16
v_mfma_f32_32x32x16_bf16 v[232:247], v[60:63], v[116:119], v[232:247]
s_mul_i32 s75, s74, 18
s_sub_u32 s75, s72, s75
ds_read_b64_tr_b16 v[56:57], v213 offset:8192
ds_read_b64_tr_b16 v[58:59], v213 offset:8448
ds_read_b64_tr_b16 v[60:61], v213 offset:45056
ds_read_b64_tr_b16 v[62:63], v213 offset:45312
s_waitcnt lgkmcnt(8)
v_mfma_f32_32x32x16_bf16 v[216:231], v[248:251], v[120:123], v[216:231]
s_lshl_b32 s75, s75, 5
s_mul_i32 s74, s74, 2359296
v_mfma_f32_32x32x16_bf16 v[232:247], v[252:255], v[120:123], v[232:247]
v_add_u32 v9, s75, v214
v_mul_u32_u24 v10, 3641, v9
ds_read_b64_tr_b16 v[248:249], v213 offset:8704
ds_read_b64_tr_b16 v[250:251], v213 offset:8960
ds_read_b64_tr_b16 v[252:253], v213 offset:45568
ds_read_b64_tr_b16 v[254:255], v213 offset:45824
s_waitcnt lgkmcnt(8)
v_mfma_f32_32x32x16_bf16 v[216:231], v[48:51], v[124:127], v[216:231]
v_lshrrev_b32 v10, 16, v10
v_mul_u32_u24 v11, 18, v10
v_mfma_f32_32x32x16_bf16 v[232:247], v[52:55], v[124:127], v[232:247]
v_sub_u32 v11, v9, v11
v_mul_u32_u24 v10, 73728, v10
ds_read_b64_tr_b16 v[48:49], v213 offset:9216
ds_read_b64_tr_b16 v[50:51], v213 offset:9472
ds_read_b64_tr_b16 v[52:53], v213 offset:46080
ds_read_b64_tr_b16 v[54:55], v213 offset:46336
s_waitcnt lgkmcnt(8)
s_add_u32 m0, s64, 5120
s_nop 0
buffer_load_dwordx4 v208, s[56:59], s61 offen lds
s_add_u32 s61, s61, 147456
v_mfma_f32_32x32x16_bf16 v[216:231], v[56:59], v[128:131], v[216:231]
v_lshl_add_u32 v10, v11, 1, v10
v_add_u32 v10, v10, v13
v_mfma_f32_32x32x16_bf16 v[232:247], v[60:63], v[128:131], v[232:247]
s_waitcnt lgkmcnt(0)
buffer_store_dword v24, v10, s[36:39], s74 offen offset:0
ds_read_b64_tr_b16 v[56:57], v213 offset:9728
ds_read_b64_tr_b16 v[58:59], v213 offset:9984
ds_read_b64_tr_b16 v[60:61], v213 offset:46592
ds_read_b64_tr_b16 v[62:63], v213 offset:46848
s_waitcnt lgkmcnt(8)
v_mfma_f32_32x32x16_bf16 v[216:231], v[248:251], v[132:135], v[216:231]
buffer_store_dword v25, v10, s[36:39], s74 offen offset:144
buffer_store_dword v26, v10, s[36:39], s74 offen offset:288
v_mfma_f32_32x32x16_bf16 v[232:247], v[252:255], v[132:135], v[232:247]
buffer_store_dword v27, v10, s[36:39], s74 offen offset:432
buffer_store_dword v28, v10, s[36:39], s74 offen offset:576
ds_read_b64_tr_b16 v[248:249], v213 offset:10240
ds_read_b64_tr_b16 v[250:251], v213 offset:10496
ds_read_b64_tr_b16 v[252:253], v213 offset:47104
ds_read_b64_tr_b16 v[254:255], v213 offset:47360
s_waitcnt lgkmcnt(8)
v_mfma_f32_32x32x16_bf16 v[216:231], v[48:51], v[136:139], v[216:231]
buffer_store_dword v29, v10, s[36:39], s74 offen offset:720
buffer_store_dword v30, v10, s[36:39], s74 offen offset:864
v_mfma_f32_32x32x16_bf16 v[232:247], v[52:55], v[136:139], v[232:247]
buffer_store_dword v31, v10, s[36:39], s74 offen offset:1008
s_lshl_b32 s72, s68, 1
ds_read_b64_tr_b16 v[48:49], v213 offset:10752
ds_read_b64_tr_b16 v[50:51], v213 offset:11008
ds_read_b64_tr_b16 v[52:53], v213 offset:47616
ds_read_b64_tr_b16 v[54:55], v213 offset:47872
s_waitcnt lgkmcnt(8)
s_add_u32 m0, s64, 6144
s_nop 0
buffer_load_dwordx4 v208, s[56:59], s61 offen lds
s_add_u32 s61, s61, 147456
v_mfma_f32_32x32x16_bf16 v[216:231], v[56:59], v[140:143], v[216:231]
s_add_u32 s72, s72, 1
s_cmp_lt_u32 s72, 18
v_mfma_f32_32x32x16_bf16 v[232:247], v[60:63], v[140:143], v[232:247]
s_cselect_b32 s73, 0x3eae1a93, 1.0
v_mul_f32 v32, s73, v32
ds_read_b64_tr_b16 v[56:57], v213 offset:11264
ds_read_b64_tr_b16 v[58:59], v213 offset:11520
ds_read_b64_tr_b16 v[60:61], v213 offset:48128
ds_read_b64_tr_b16 v[62:63], v213 offset:48384
s_waitcnt lgkmcnt(8)
v_mfma_f32_32x32x16_bf16 v[216:231], v[248:251], v[144:147], v[216:231]
v_mul_f32 v33, s73, v33
v_mul_f32 v34, s73, v34
v_mfma_f32_32x32x16_bf16 v[232:247], v[252:255], v[144:147], v[232:247]
v_mul_f32 v35, s73, v35
v_mul_f32 v36, s73, v36
ds_read_b64_tr_b16 v[248:249], v213 offset:11776
ds_read_b64_tr_b16 v[250:251], v213 offset:12032
ds_read_b64_tr_b16 v[252:253], v213 offset:48640
ds_read_b64_tr_b16 v[254:255], v213 offset:48896
s_waitcnt lgkmcnt(8)
v_mfma_f32_32x32x16_bf16 v[216:231], v[48:51], v[148:151], v[216:231]
v_mul_f32 v37, s73, v37
v_mul_f32 v38, s73, v38
v_mfma_f32_32x32x16_bf16 v[232:247], v[52:55], v[148:151], v[232:247]
v_mul_f32 v39, s73, v39
v_mul_f32 v40, s73, v40
ds_read_b64_tr_b16 v[48:49], v213 offset:12288
ds_read_b64_tr_b16 v[50:51], v213 offset:12544
ds_read_b64_tr_b16 v[52:53], v213 offset:49152
ds_read_b64_tr_b16 v[54:55], v213 offset:49408
s_waitcnt lgkmcnt(8)
s_add_u32 m0, s64, 7168
s_nop 0
buffer_load_dwordx4 v208, s[56:59], s61 offen lds
s_add_u32 s61, s61, 147456
v_mfma_f32_32x32x16_bf16 v[216:231], v[56:59], v[152:155], v[216:231]
v_mul_f32 v41, s73, v41
v_mul_f32 v42, s73, v42
v_mfma_f32_32x32x16_bf16 v[232:247], v[60:63], v[152:155], v[232:247]
v_mul_f32 v43, s73, v43
v_mul_f32 v44, s73, v44
ds_read_b64_tr_b16 v[56:57], v213 offset:12800
ds_read_b64_tr_b16 v[58:59], v213 offset:13056
ds_read_b64_tr_b16 v[60:61], v213 offset:49664
ds_read_b64_tr_b16 v[62:63], v213 offset:49920
s_waitcnt lgkmcnt(8)
v_mfma_f32_32x32x16_bf16 v[216:231], v[248:251], v[156:159], v[216:231]
v_mul_f32 v45, s73, v45
v_mul_f32 v46, s73, v46
v_mfma_f32_32x32x16_bf16 v[232:247], v[252:255], v[156:159], v[232:247]
v_mul_f32 v47, s73, v47
v_cvt_pk_bf16_f32 v32, v32, v33
ds_read_b64_tr_b16 v[248:249], v213 offset:13312
ds_read_b64_tr_b16 v[250:251], v213 offset:13568
ds_read_b64_tr_b16 v[252:253], v213 offset:50176
ds_read_b64_tr_b16 v[254:255], v213 offset:50432
s_waitcnt lgkmcnt(8)
v_mfma_f32_32x32x16_bf16 v[216:231], v[48:51], v[160:163], v[216:231]
v_cvt_pk_bf16_f32 v33, v34, v35
v_cvt_pk_bf16_f32 v34, v36, v37
v_mfma_f32_32x32x16_bf16 v[232:247], v[52:55], v[160:163], v[232:247]
v_cvt_pk_bf16_f32 v35, v38, v39
v_cvt_pk_bf16_f32 v36, v40, v41
ds_read_b64_tr_b16 v[48:49], v213 offset:13824
ds_read_b64_tr_b16 v[50:51], v213 offset:14080
ds_read_b64_tr_b16 v[52:53], v213 offset:50688
ds_read_b64_tr_b16 v[54:55], v213 offset:50944
s_waitcnt lgkmcnt(8)
s_add_u32 m0, s64, 8192
s_nop 0
buffer_load_dwordx4 v208, s[56:59], s61 offen lds
s_add_u32 s61, s61, 147456
v_mfma_f32_32x32x16_bf16 v[216:231], v[56:59], v[164:167], v[216:231]
v_cvt_pk_bf16_f32 v37, v42, v43
v_cvt_pk_bf16_f32 v38, v44, v45
v_mfma_f32_32x32x16_bf16 v[232:247], v[60:63], v[164:167], v[232:247]
v_cvt_pk_bf16_f32 v39, v46, v47
ds_write_b64 v7, v[32:33] offset:0
ds_read_b64_tr_b16 v[56:57], v213 offset:14336
ds_read_b64_tr_b16 v[58:59], v213 offset:14592
ds_read_b64_tr_b16 v[60:61], v213 offset:51200
ds_read_b64_tr_b16 v[62:63], v213 offset:51456
s_waitcnt lgkmcnt(8)
v_mfma_f32_32x32x16_bf16 v[216:231], v[248:251], v[168:171], v[216:231]
ds_write_b64 v7, v[34:35] offset:16
ds_write_b64 v7, v[36:37] offset:32
v_mfma_f32_32x32x16_bf16 v[232:247], v[252:255], v[168:171], v[232:247]
ds_write_b64 v7, v[38:39] offset:48
ds_read_b32 v40, v12 offset:0
ds_read_b64_tr_b16 v[248:249], v213 offset:14848
ds_read_b64_tr_b16 v[250:251], v213 offset:15104
ds_read_b64_tr_b16 v[252:253], v213 offset:51712
ds_read_b64_tr_b16 v[254:255], v213 offset:51968
s_waitcnt lgkmcnt(8)
v_mfma_f32_32x32x16_bf16 v[216:231], v[48:51], v[172:175], v[216:231]
ds_read_b32 v41, v12 offset:256
ds_read_b32 v42, v12 offset:512
v_mfma_f32_32x32x16_bf16 v[232:247], v[52:55], v[172:175], v[232:247]
ds_read_b32 v43, v12 offset:768
ds_read_b32 v44, v12 offset:1024
ds_read_b64_tr_b16 v[48:49], v213 offset:15360
ds_read_b64_tr_b16 v[50:51], v213 offset:15616
ds_read_b64_tr_b16 v[52:53], v213 offset:52224
ds_read_b64_tr_b16 v[54:55], v213 offset:52480
s_waitcnt lgkmcnt(8)
v_mfma_f32_32x32x16_bf16 v[216:231], v[56:59], v[176:179], v[216:231]
ds_read_b32 v45, v12 offset:1280
ds_read_b32 v46, v12 offset:1536
v_mfma_f32_32x32x16_bf16 v[232:247], v[60:63], v[176:179], v[232:247]
ds_read_b32 v47, v12 offset:1792
s_mul_i32 s74, s72, 3641
ds_read_b64_tr_b16 v[56:57], v213 offset:15872
ds_read_b64_tr_b16 v[58:59], v213 offset:16128
ds_read_b64_tr_b16 v[60:61], v213 offset:52736
ds_read_b64_tr_b16 v[62:63], v213 offset:52992
s_waitcnt lgkmcnt(8)
v_mfma_f32_32x32x16_bf16 v[216:231], v[248:251], v[180:183], v[216:231]
s_lshr_b32 s74, s74, 16
s_mul_i32 s75, s74, 18
v_mfma_f32_32x32x16_bf16 v[232:247], v[252:255], v[180:183], v[232:247]
s_sub_u32 s75, s72, s75
s_lshl_b32 s75, s75, 5
ds_read_b64_tr_b16 v[248:249], v213 offset:16384
ds_read_b64_tr_b16 v[250:251], v213 offset:16640
ds_read_b64_tr_b16 v[252:253], v213 offset:53248
ds_read_b64_tr_b16 v[254:255], v213 offset:53504
s_waitcnt lgkmcnt(8)
v_mfma_f32_32x32x16_bf16 v[216:231], v[48:51], v[184:187], v[216:231]
s_mul_i32 s74, s74, 2359296
v_add_u32 v9, s75, v214
v_mfma_f32_32x32x16_bf16 v[232:247], v[52:55], v[184:187], v[232:247]
v_mul_u32_u24 v10, 3641, v9
v_lshrrev_b32 v10, 16, v10
ds_read_b64_tr_b16 v[48:49], v213 offset:16896
ds_read_b64_tr_b16 v[50:51], v213 offset:17152
ds_read_b64_tr_b16 v[52:53], v213 offset:53760
ds_read_b64_tr_b16 v[54:55], v213 offset:54016
s_waitcnt lgkmcnt(8)
v_mfma_f32_32x32x16_bf16 v[216:231], v[56:59], v[188:191], v[216:231]
v_mul_u32_u24 v11, 18, v10
v_sub_u32 v11, v9, v11
v_mfma_f32_32x32x16_bf16 v[232:247], v[60:63], v[188:191], v[232:247]
v_mul_u32_u24 v10, 73728, v10
v_lshl_add_u32 v10, v11, 1, v10
ds_read_b64_tr_b16 v[56:57], v213 offset:17408
ds_read_b64_tr_b16 v[58:59], v213 offset:17664
ds_read_b64_tr_b16 v[60:61], v213 offset:54272
ds_read_b64_tr_b16 v[62:63], v213 offset:54528
s_waitcnt lgkmcnt(8)
v_mfma_f32_32x32x16_bf16 v[216:231], v[248:251], v[192:195], v[216:231]
v_add_u32 v10, v10, v13
s_waitcnt lgkmcnt(0)
v_mfma_f32_32x32x16_bf16 v[232:247], v[252:255], v[192:195], v[232:247]
buffer_store_dword v40, v10, s[36:39], s74 offen offset:0
buffer_store_dword v41, v10, s[36:39], s74 offen offset:144
ds_read_b64_tr_b16 v[248:249], v213 offset:17920
ds_read_b64_tr_b16 v[250:251], v213 offset:18176
ds_read_b64_tr_b16 v[252:253], v213 offset:54784
ds_read_b64_tr_b16 v[254:255], v213 offset:55040
s_waitcnt lgkmcnt(8)
v_mfma_f32_32x32x16_bf16 v[216:231], v[48:51], v[196:199], v[216:231]
buffer_store_dword v42, v10, s[36:39], s74 offen offset:288
buffer_store_dword v43, v10, s[36:39], s74 offen offset:432
v_mfma_f32_32x32x16_bf16 v[232:247], v[52:55], v[196:199], v[232:247]
buffer_store_dword v44, v10, s[36:39], s74 offen offset:576
buffer_store_dword v45, v10, s[36:39], s74 offen offset:720
s_waitcnt lgkmcnt(4)
v_mfma_f32_32x32x16_bf16 v[216:231], v[56:59], v[200:203], v[216:231]
buffer_store_dword v46, v10, s[36:39], s74 offen offset:864
buffer_store_dword v47, v10, s[36:39], s74 offen offset:1008
v_mfma_f32_32x32x16_bf16 v[232:247], v[60:63], v[200:203], v[232:247]
s_waitcnt lgkmcnt(0)
v_mfma_f32_32x32x16_bf16 v[216:231], v[248:251], v[204:207], v[216:231]
v_mfma_f32_32x32x16_bf16 v[232:247], v[252:255], v[204:207], v[232:247]
g1_b2d:
s_mov_b32 s66, s63
s_mov_b32 s63, s65
s_mov_b32 s65, s66
s_mov_b32 s68, s53
s_mov_b32 s53, s62
s_cmp_ge_u32 s53, 171
s_cbranch_scc1 g1_fin1
g1_loop:
v_add_u32 v213, s63, v210
s_waitcnt vmcnt(4)
s_barrier
s_add_u32 s62, s53, 32
s_cmp_ge_u32 s62, 160
s_cselect_b32 s62, s80, s62
s_cmp_ge_u32 s53, 160
s_cselect_b32 s62, 255, s62
s_min_u32 s69, s62, 170
s_sub_u32 s69, s69, 27
s_add_u32 s64, s52, s65
s_cmp_eq_u32 s50, 0
s_cselect_b32 s56, s28, s32
s_cselect_b32 s57, s29, s33
s_mov_b32 s58, s30
s_mov_b32 s59, s31
s_mul_i32 s54, s51, 9216
s_lshl_b32 s55, s69, 6
s_add_u32 s61, s54, s55
s_cmp_gt_u32 s62, 170
s_cselect_b32 s58, 0, s58
ds_read_b64_tr_b16 v[48:49], v213 offset:0
ds_read_b64_tr_b16 v[50:51], v213 offset:256
ds_read_b64_tr_b16 v[52:53], v213 offset:36864
ds_read_b64_tr_b16 v[54:55], v213 offset:37120
ds_read_b64_tr_b16 v[56:57], v213 offset:512
ds_read_b64_tr_b16 v[58:59], v213 offset:768
ds_read_b64_tr_b16 v[60:61], v213 offset:37376
ds_read_b64_tr_b16 v[62:63], v213 offset:37632
ds_read_b64_tr_b16 v[248:249], v213 offset:1024
ds_read_b64_tr_b16 v[250:251], v213 offset:1280
ds_read_b64_tr_b16 v[252:253], v213 offset:37888
ds_read_b64_tr_b16 v[254:255], v213 offset:38144
s_waitcnt lgkmcnt(8)
v_mfma_f32_32x32x16_bf16 v[16:31], v[48:51], v[64:67], 0
v_mfma_f32_32x32x16_bf16 v[32:47], v[52:55], v[64:67], 0
ds_read_b64_tr_b16 v[48:49], v213 offset:1536
ds_read_b64_tr_b16 v[50:51], v213 offset:1792
ds_read_b64_tr_b16 v[52:53], v213 offset:38400
ds_read_b64_tr_b16 v[54:55], v213 offset:38656
s_waitcnt lgkmcnt(8)
s_add_u32 m0, s64, 0
s_nop 0
buffer_load_dwordx4 v208, s[56:59], s61 offen lds
s_add_u32 s61, s61, 147456
v_mfma_f32_32x32x16_bf16 v[16:31], v[56:59], v[68:71], v[16:31]
v_mfma_f32_32x32x16_bf16 v[32:47], v[60:63], v[68:71], v[32:47]
ds_read_b64_tr_b16 v[56:57], v213 offset:2048
ds_read_b64_tr_b16 v[58:59], v213 offset:2304
ds_read_b64_tr_b16 v[60:61], v213 offset:38912
ds_read_b64_tr_b16 v[62:63], v213 offset:39168
s_waitcnt lgkmcnt(8)
v_mfma_f32_32x32x16_bf16 v[16:31], v[248:251], v[72:75], v[16:31]
v_mfma_f32_32x32x16_bf16 v[32:47], v[252:255], v[72:75], v[32:47]
ds_read_b64_tr_b16 v[248:249], v213 offset:2560
ds_read_b64_tr_b16 v[250:251], v213 offset:2816
ds_read_b64_tr_b16 v[252:253], v213 offset:39424
ds_read_b64_tr_b16 v[254:255], v213 offset:39680
s_waitcnt lgkmcnt(8)
v_mfma_f32_32x32x16_bf16 v[16:31], v[48:51], v[76:79], v[16:31]
v_mul_f32 v8, 0xbfb8aa3b, v216
v_exp_f32 v8, v8
v_mfma_f32_32x32x16_bf16 v[32:47], v[52:55], v[76:79], v[32:47]
v_mul_f32 v216, v216, v232
v_add_f32 v8, 1.0, v8
ds_read_b64_tr_b16 v[48:49], v213 offset:3072
ds_read_b64_tr_b16 v[50:51], v213 offset:3328
ds_read_b64_tr_b16 v[52:53], v213 offset:39936
ds_read_b64_tr_b16 v[54:55], v213 offset:40192
s_waitcnt lgkmcnt(8)
s_add_u32 m0, s64, 1024
s_nop 0
buffer_load_dwordx4 v208, s[56:59], s61 offen lds
s_add_u32 s61, s61, 147456
v_mfma_f32_32x32x16_bf16 v[16:31], v[56:59], v[80:83], v[16:31]
v_rcp_f32 v8, v8
s_nop 0
v_mfma_f32_32x32x16_bf16 v[32:47], v[60:63], v[80:83], v[32:47]
v_mul_f32 v216, v216, v8
v_mul_f32 v9, 0xbfb8aa3b, v217
ds_read_b64_tr_b16 v[56:57], v213 offset:3584
ds_read_b64_tr_b16 v[58:59], v213 offset:3840
ds_read_b64_tr_b16 v[60:61], v213 offset:40448
ds_read_b64_tr_b16 v[62:63], v213 offset:40704
s_waitcnt lgkmcnt(8)
v_mfma_f32_32x32x16_bf16 v[16:31], v[248:251], v[84:87], v[16:31]
v_exp_f32 v9, v9
v_mul_f32 v217, v217, v233
v_mfma_f32_32x32x16_bf16 v[32:47], v[252:255], v[84:87], v[32:47]
v_add_f32 v9, 1.0, v9
v_rcp_f32 v9, v9
ds_read_b64_tr_b16 v[248:249], v213 offset:4096
ds_read_b64_tr_b16 v[250:251], v213 offset:4352
ds_read_b64_tr_b16 v[252:253], v213 offset:40960
ds_read_b64_tr_b16 v[254:255], v213 offset:41216
s_waitcnt lgkmcnt(8)
v_mfma_f32_32x32x16_bf16 v[16:31], v[48:51], v[88:91], v[16:31]
s_nop 0
v_mul_f32 v217, v217, v9
v_mfma_f32_32x32x16_bf16 v[32:47], v[52:55], v[88:91], v[32:47]
v_mul_f32 v10, 0xbfb8aa3b, v218
v_exp_f32 v10, v10
ds_read_b64_tr_b16 v[48:49], v213 offset:4608
ds_read_b64_tr_b16 v[50:51], v213 offset:4864
ds_read_b64_tr_b16 v[52:53], v213 offset:41472
ds_read_b64_tr_b16 v[54:55], v213 offset:41728
s_waitcnt lgkmcnt(8)
s_add_u32 m0, s64, 2048
s_nop 0
buffer_load_dwordx4 v208, s[56:59], s61 offen lds
s_add_u32 s61, s61, 147456
v_mfma_f32_32x32x16_bf16 v[16:31], v[56:59], v[92:95], v[16:31]
v_mul_f32 v218, v218, v234
v_add_f32 v10, 1.0, v10
v_mfma_f32_32x32x16_bf16 v[32:47], v[60:63], v[92:95], v[32:47]
v_rcp_f32 v10, v10
s_nop 0
ds_read_b64_tr_b16 v[56:57], v213 offset:5120
ds_read_b64_tr_b16 v[58:59], v213 offset:5376
ds_read_b64_tr_b16 v[60:61], v213 offset:41984
ds_read_b64_tr_b16 v[62:63], v213 offset:42240
s_waitcnt lgkmcnt(8)
v_mfma_f32_32x32x16_bf16 v[16:31], v[248:251], v[96:99], v[16:31]
v_mul_f32 v218, v218, v10
v_mul_f32 v11, 0xbfb8aa3b, v219
v_mfma_f32_32x32x16_bf16 v[32:47], v[252:255], v[96:99], v[32:47]
v_exp_f32 v11, v11
v_mul_f32 v219, v219, v235
ds_read_b64_tr_b16 v[248:249], v213 offset:5632
ds_read_b64_tr_b16 v[250:251], v213 offset:5888
ds_read_b64_tr_b16 v[252:253], v213 offset:42496
ds_read_b64_tr_b16 v[254:255], v213 offset:42752
s_waitcnt lgkmcnt(8)
v_mfma_f32_32x32x16_bf16 v[16:31], v[48:51], v[100:103], v[16:31]
v_add_f32 v11, 1.0, v11
v_rcp_f32 v11, v11
v_mfma_f32_32x32x16_bf16 v[32:47], v[52:55], v[100:103], v[32:47]
s_nop 0
v_mul_f32 v219, v219, v11
ds_read_b64_tr_b16 v[48:49], v213 offset:6144
ds_read_b64_tr_b16 v[50:51], v213 offset:6400
ds_read_b64_tr_b16 v[52:53], v213 offset:43008
ds_read_b64_tr_b16 v[54:55], v213 offset:43264
s_waitcnt lgkmcnt(8)
s_add_u32 m0, s64, 3072
s_nop 0
buffer_load_dwordx4 v208, s[56:59], s61 offen lds
s_add_u32 s61, s61, 147456
v_mfma_f32_32x32x16_bf16 v[16:31], v[56:59], v[104:107], v[16:31]
v_mul_f32 v8, 0xbfb8aa3b, v220
v_exp_f32 v8, v8
v_mfma_f32_32x32x16_bf16 v[32:47], v[60:63], v[104:107], v[32:47]
v_mul_f32 v220, v220, v236
v_add_f32 v8, 1.0, v8
ds_read_b64_tr_b16 v[56:57], v213 offset:6656
ds_read_b64_tr_b16 v[58:59], v213 offset:6912
ds_read_b64_tr_b16 v[60:61], v213 offset:43520
ds_read_b64_tr_b16 v[62:63], v213 offset:43776
s_waitcnt lgkmcnt(8)
v_mfma_f32_32x32x16_bf16 v[16:31], v[248:251], v[108:111], v[16:31]
v_rcp_f32 v8, v8
s_nop 0
v_mfma_f32_32x32x16_bf16 v[32:47], v[252:255], v[108:111], v[32:47]
v_mul_f32 v220, v220, v8
v_mul_f32 v9, 0xbfb8aa3b, v221
ds_read_b64_tr_b16 v[248:249], v213 offset:7168
ds_read_b64_tr_b16 v[250:251], v213 offset:7424
ds_read_b64_tr_b16 v[252:253], v213 offset:44032
ds_read_b64_tr_b16 v[254:255], v213 offset:44288
s_waitcnt lgkmcnt(8)
v_mfma_f32_32x32x16_bf16 v[16:31], v[48:51], v[112:115], v[16:31]
v_exp_f32 v9, v9
v_mul_f32 v221, v221, v237
v_mfma_f32_32x32x16_bf16 v[32:47], v[52:55], v[112:115], v[32:47]
v_add_f32 v9, 1.0, v9
v_rcp_f32 v9, v9
ds_read_b64_tr_b16 v[48:49], v213 offset:7680
ds_read_b64_tr_b16 v[50:51], v213 offset:7936
ds_read_b64_tr_b16 v[52:53], v213 offset:44544
ds_read_b64_tr_b16 v[54:55], v213 offset:44800
s_waitcnt lgkmcnt(8)
s_add_u32 m0, s64, 4096
s_nop 0
buffer_load_dwordx4 v208, s[56:59], s61 offen lds
s_add_u32 s61, s61, 147456
v_mfma_f32_32x32x16_bf16 v[16:31], v[56:59], v[116:119], v[16:31]
s_nop 0
v_mul_f32 v221, v221, v9
v_mfma_f32_32x32x16_bf16 v[32:47], v[60:63], v[116:119], v[32:47]
v_mul_f32 v10, 0xbfb8aa3b, v222
v_exp_f32 v10, v10
ds_read_b64_tr_b16 v[56:57], v213 offset:8192
ds_read_b64_tr_b16 v[58:59], v213 offset:8448
ds_read_b64_tr_b16 v[60:61], v213 offset:45056
ds_read_b64_tr_b16 v[62:63], v213 offset:45312
s_waitcnt lgkmcnt(8)
v_mfma_f32_32x32x16_bf16 v[16:31], v[248:251], v[120:123], v[16:31]
v_mul_f32 v222, v222, v238
v_add_f32 v10, 1.0, v10
v_mfma_f32_32x32x16_bf16 v[32:47], v[252:255], v[120:123], v[32:47]
v_rcp_f32 v10, v10
s_nop 0
ds_read_b64_tr_b16 v[248:249], v213 offset:8704
ds_read_b64_tr_b16 v[250:251], v213 offset:8960
ds_read_b64_tr_b16 v[252:253], v213 offset:45568
ds_read_b64_tr_b16 v[254:255], v213 offset:45824
s_waitcnt lgkmcnt(8)
v_mfma_f32_32x32x16_bf16 v[16:31], v[48:51], v[124:127], v[16:31]
v_mul_f32 v222, v222, v10
v_mul_f32 v11, 0xbfb8aa3b, v223
v_mfma_f32_32x32x16_bf16 v[32:47], v[52:55], v[124:127], v[32:47]
v_exp_f32 v11, v11
v_mul_f32 v223, v223, v239
ds_read_b64_tr_b16 v[48:49], v213 offset:9216
ds_read_b64_tr_b16 v[50:51], v213 offset:9472
ds_read_b64_tr_b16 v[52:53], v213 offset:46080
ds_read_b64_tr_b16 v[54:55], v213 offset:46336
s_waitcnt lgkmcnt(8)
s_add_u32 m0, s64, 5120
s_nop 0
buffer_load_dwordx4 v208, s[56:59], s61 offen lds
s_add_u32 s61, s61, 147456
v_mfma_f32_32x32x16_bf16 v[16:31], v[56:59], v[128:131], v[16:31]
v_add_f32 v11, 1.0, v11
v_rcp_f32 v11, v11
v_mfma_f32_32x32x16_bf16 v[32:47], v[60:63], v[128:131], v[32:47]
s_nop 0
v_mul_f32 v223, v223, v11
ds_read_b64_tr_b16 v[56:57], v213 offset:9728
ds_read_b64_tr_b16 v[58:59], v213 offset:9984
ds_read_b64_tr_b16 v[60:61], v213 offset:46592
ds_read_b64_tr_b16 v[62:63], v213 offset:46848
s_waitcnt lgkmcnt(8)
v_mfma_f32_32x32x16_bf16 v[16:31], v[248:251], v[132:135], v[16:31]
v_mul_f32 v8, 0xbfb8aa3b, v224
v_exp_f32 v8, v8
v_mfma_f32_32x32x16_bf16 v[32:47], v[252:255], v[132:135], v[32:47]
v_mul_f32 v224, v224, v240
v_add_f32 v8, 1.0, v8
ds_read_b64_tr_b16 v[248:249], v213 offset:10240
ds_read_b64_tr_b16 v[250:251], v213 offset:10496
ds_read_b64_tr_b16 v[252:253], v213 offset:47104
ds_read_b64_tr_b16 v[254:255], v213 offset:47360
s_waitcnt lgkmcnt(8)
v_mfma_f32_32x32x16_bf16 v[16:31], v[48:51], v[136:139], v[16:31]
v_rcp_f32 v8, v8
s_nop 0
v_mfma_f32_32x32x16_bf16 v[32:47], v[52:55], v[136:139], v[32:47]
v_mul_f32 v224, v224, v8
v_mul_f32 v9, 0xbfb8aa3b, v225
ds_read_b64_tr_b16 v[48:49], v213 offset:10752
ds_read_b64_tr_b16 v[50:51], v213 offset:11008
ds_read_b64_tr_b16 v[52:53], v213 offset:47616
ds_read_b64_tr_b16 v[54:55], v213 offset:47872
s_waitcnt lgkmcnt(8)
s_add_u32 m0, s64, 6144
s_nop 0
buffer_load_dwordx4 v208, s[56:59], s61 offen lds
s_add_u32 s61, s61, 147456
v_mfma_f32_32x32x16_bf16 v[16:31], v[56:59], v[140:143], v[16:31]
v_exp_f32 v9, v9
v_mul_f32 v225, v225, v241
v_mfma_f32_32x32x16_bf16 v[32:47], v[60:63], v[140:143], v[32:47]
v_add_f32 v9, 1.0, v9
v_rcp_f32 v9, v9
ds_read_b64_tr_b16 v[56:57], v213 offset:11264
ds_read_b64_tr_b16 v[58:59], v213 offset:11520
ds_read_b64_tr_b16 v[60:61], v213 offset:48128
ds_read_b64_tr_b16 v[62:63], v213 offset:48384
s_waitcnt lgkmcnt(8)
v_mfma_f32_32x32x16_bf16 v[16:31], v[248:251], v[144:147], v[16:31]
s_nop 0
v_mul_f32 v225, v225, v9
v_mfma_f32_32x32x16_bf16 v[32:47], v[252:255], v[144:147], v[32:47]
v_mul_f32 v10, 0xbfb8aa3b, v226
v_exp_f32 v10, v10
ds_read_b64_tr_b16 v[248:249], v213 offset:11776
ds_read_b64_tr_b16 v[250:251], v213 offset:12032
ds_read_b64_tr_b16 v[252:253], v213 offset:48640
ds_read_b64_tr_b16 v[254:255], v213 offset:48896
s_waitcnt lgkmcnt(8)
v_mfma_f32_32x32x16_bf16 v[16:31], v[48:51], v[148:151], v[16:31]
v_mul_f32 v226, v226, v242
v_add_f32 v10, 1.0, v10
v_mfma_f32_32x32x16_bf16 v[32:47], v[52:55], v[148:151], v[32:47]
v_rcp_f32 v10, v10
s_nop 0
ds_read_b64_tr_b16 v[48:49], v213 offset:12288
ds_read_b64_tr_b16 v[50:51], v213 offset:12544
ds_read_b64_tr_b16 v[52:53], v213 offset:49152
ds_read_b64_tr_b16 v[54:55], v213 offset:49408
s_waitcnt lgkmcnt(8)
s_add_u32 m0, s64, 7168
s_nop 0
buffer_load_dwordx4 v208, s[56:59], s61 offen lds
s_add_u32 s61, s61, 147456
v_mfma_f32_32x32x16_bf16 v[16:31], v[56:59], v[152:155], v[16:31]
v_mul_f32 v226, v226, v10
v_mul_f32 v11, 0xbfb8aa3b, v227
v_mfma_f32_32x32x16_bf16 v[32:47], v[60:63], v[152:155], v[32:47]
v_exp_f32 v11, v11
v_mul_f32 v227, v227, v243
ds_read_b64_tr_b16 v[56:57], v213 offset:12800
ds_read_b64_tr_b16 v[58:59], v213 offset:13056
ds_read_b64_tr_b16 v[60:61], v213 offset:49664
ds_read_b64_tr_b16 v[62:63], v213 offset:49920
s_waitcnt lgkmcnt(8)
v_mfma_f32_32x32x16_bf16 v[16:31], v[248:251], v[156:159], v[16:31]
v_add_f32 v11, 1.0, v11
v_rcp_f32 v11, v11
v_mfma_f32_32x32x16_bf16 v[32:47], v[252:255], v[156:159], v[32:47]
s_nop 0
v_mul_f32 v227, v227, v11
ds_read_b64_tr_b16 v[248:249], v213 offset:13312
ds_read_b64_tr_b16 v[250:251], v213 offset:13568
ds_read_b64_tr_b16 v[252:253], v213 offset:50176
ds_read_b64_tr_b16 v[254:255], v213 offset:50432
s_waitcnt lgkmcnt(8)
v_mfma_f32_32x32x16_bf16 v[16:31], v[48:51], v[160:163], v[16:31]
v_mul_f32 v8, 0xbfb8aa3b, v228
v_exp_f32 v8, v8
v_mfma_f32_32x32x16_bf16 v[32:47], v[52:55], v[160:163], v[32:47]
v_mul_f32 v228, v228, v244
v_add_f32 v8, 1.0, v8
ds_read_b64_tr_b16 v[48:49], v213 offset:13824
ds_read_b64_tr_b16 v[50:51], v213 offset:14080
ds_read_b64_tr_b16 v[52:53], v213 offset:50688
ds_read_b64_tr_b16 v[54:55], v213 offset:50944
s_waitcnt lgkmcnt(8)
s_add_u32 m0, s64, 8192
s_nop 0
buffer_load_dwordx4 v208, s[56:59], s61 offen lds
s_add_u32 s61, s61, 147456
v_mfma_f32_32x32x16_bf16 v[16:31], v[56:59], v[164:167], v[16:31]
v_rcp_f32 v8, v8
s_nop 0
v_mfma_f32_32x32x16_bf16 v[32:47], v[60:63], v[164:167], v[32:47]
v_mul_f32 v228, v228, v8
v_mul_f32 v9, 0xbfb8aa3b, v229
ds_read_b64_tr_b16 v[56:57], v213 offset:14336
ds_read_b64_tr_b16 v[58:59], v213 offset:14592
ds_read_b64_tr_b16 v[60:61], v213 offset:51200
ds_read_b64_tr_b16 v[62:63], v213 offset:51456
s_waitcnt lgkmcnt(8)
v_mfma_f32_32x32x16_bf16 v[16:31], v[248:251], v[168:171], v[16:31]
v_exp_f32 v9, v9
v_mul_f32 v229, v229, v245
v_mfma_f32_32x32x16_bf16 v[32:47], v[252:255], v[168:171], v[32:47]
v_add_f32 v9, 1.0, v9
v_rcp_f32 v9, v9
ds_read_b64_tr_b16 v[248:249], v213 offset:14848
ds_read_b64_tr_b16 v[250:251], v213 offset:15104
ds_read_b64_tr_b16 v[252:253], v213 offset:51712
ds_read_b64_tr_b16 v[254:255], v213 offset:51968
s_waitcnt lgkmcnt(8)
v_mfma_f32_32x32x16_bf16 v[16:31], v[48:51], v[172:175], v[16:31]
s_nop 0
v_mul_f32 v229, v229, v9
v_mfma_f32_32x32x16_bf16 v[32:47], v[52:55], v[172:175], v[32:47]
v_mul_f32 v10, 0xbfb8aa3b, v230
v_exp_f32 v10, v10
ds_read_b64_tr_b16 v[48:49], v213 offset:15360
ds_read_b64_tr_b16 v[50:51], v213 offset:15616
ds_read_b64_tr_b16 v[52:53], v213 offset:52224
ds_read_b64_tr_b16 v[54:55], v213 offset:52480
s_waitcnt lgkmcnt(8)
v_mfma_f32_32x32x16_bf16 v[16:31], v[56:59], v[176:179], v[16:31]
v_mul_f32 v230, v230, v246
v_add_f32 v10, 1.0, v10
v_mfma_f32_32x32x16_bf16 v[32:47], v[60:63], v[176:179], v[32:47]
v_rcp_f32 v10, v10
s_nop 0
ds_read_b64_tr_b16 v[56:57], v213 offset:15872
ds_read_b64_tr_b16 v[58:59], v213 offset:16128
ds_read_b64_tr_b16 v[60:61], v213 offset:52736
ds_read_b64_tr_b16 v[62:63], v213 offset:52992
s_waitcnt lgkmcnt(8)
v_mfma_f32_32x32x16_bf16 v[16:31], v[248:251], v[180:183], v[16:31]
v_mul_f32 v230, v230, v10
v_mul_f32 v11, 0xbfb8aa3b, v231
v_mfma_f32_32x32x16_bf16 v[32:47], v[252:255], v[180:183], v[32:47]
v_exp_f32 v11, v11
v_mul_f32 v231, v231, v247
ds_read_b64_tr_b16 v[248:249], v213 offset:16384
ds_read_b64_tr_b16 v[250:251], v213 offset:16640
ds_read_b64_tr_b16 v[252:253], v213 offset:53248
ds_read_b64_tr_b16 v[254:255], v213 offset:53504
s_waitcnt lgkmcnt(8)
v_mfma_f32_32x32x16_bf16 v[16:31], v[48:51], v[184:187], v[16:31]
v_add_f32 v11, 1.0, v11
v_rcp_f32 v11, v11
v_mfma_f32_32x32x16_bf16 v[32:47], v[52:55], v[184:187], v[32:47]
s_nop 0
v_mul_f32 v231, v231, v11
ds_read_b64_tr_b16 v[48:49], v213 offset:16896
ds_read_b64_tr_b16 v[50:51], v213 offset:17152
ds_read_b64_tr_b16 v[52:53], v213 offset:53760
ds_read_b64_tr_b16 v[54:55], v213 offset:54016
s_waitcnt lgkmcnt(8)
v_mfma_f32_32x32x16_bf16 v[16:31], v[56:59], v[188:191], v[16:31]
v_cvt_pk_bf16_f32 v232, v216, v217
v_cvt_pk_bf16_f32 v233, v218, v219
v_mfma_f32_32x32x16_bf16 v[32:47], v[60:63], v[188:191], v[32:47]
v_cvt_pk_bf16_f32 v234, v220, v221
v_cvt_pk_bf16_f32 v235, v222, v223
ds_read_b64_tr_b16 v[56:57], v213 offset:17408
ds_read_b64_tr_b16 v[58:59], v213 offset:17664
ds_read_b64_tr_b16 v[60:61], v213 offset:54272
ds_read_b64_tr_b16 v[62:63], v213 offset:54528
s_waitcnt lgkmcnt(8)
v_mfma_f32_32x32x16_bf16 v[16:31], v[248:251], v[192:195], v[16:31]
v_cvt_pk_bf16_f32 v236, v224, v225
v_cvt_pk_bf16_f32 v237, v226, v227
v_mfma_f32_32x32x16_bf16 v[32:47], v[252:255], v[192:195], v[32:47]
v_cvt_pk_bf16_f32 v238, v228, v229
v_cvt_pk_bf16_f32 v239, v230, v231
ds_read_b64_tr_b16 v[248:249], v213 offset:17920
ds_read_b64_tr_b16 v[250:251], v213 offset:18176
ds_read_b64_tr_b16 v[252:253], v213 offset:54784
ds_read_b64_tr_b16 v[254:255], v213 offset:55040
s_waitcnt lgkmcnt(8)
v_mfma_f32_32x32x16_bf16 v[16:31], v[48:51], v[196:199], v[16:31]
s_sub_u32 s67, s68, 27
s_lshl_b32 s67, s67, 6
v_mfma_f32_32x32x16_bf16 v[32:47], v[52:55], v[196:199], v[32:47]
buffer_store_dwordx2 v[232:233], v211, s[44:47], s67 offen offset:0
buffer_store_dwordx2 v[234:235], v211, s[44:47], s67 offen offset:16
s_waitcnt lgkmcnt(4)
v_mfma_f32_32x32x16_bf16 v[16:31], v[56:59], v[200:203], v[16:31]
buffer_store_dwordx2 v[236:237], v211, s[44:47], s67 offen offset:32
buffer_store_dwordx2 v[238:239], v211, s[44:47], s67 offen offset:48
v_mfma_f32_32x32x16_bf16 v[32:47], v[60:63], v[200:203], v[32:47]
s_waitcnt lgkmcnt(0)
v_mfma_f32_32x32x16_bf16 v[16:31], v[248:251], v[204:207], v[16:31]
v_mfma_f32_32x32x16_bf16 v[32:47], v[252:255], v[204:207], v[32:47]
s_mov_b32 s66, s63
s_mov_b32 s63, s65
s_mov_b32 s65, s66
s_mov_b32 s68, s53
s_mov_b32 s53, s62
s_cmp_ge_u32 s53, 171
s_cbranch_scc1 g1_fin0
v_add_u32 v213, s63, v210
s_waitcnt vmcnt(4)
s_barrier
s_add_u32 s62, s53, 32
s_cmp_ge_u32 s62, 160
s_cselect_b32 s62, s80, s62
s_cmp_ge_u32 s53, 160
s_cselect_b32 s62, 255, s62
s_min_u32 s69, s62, 170
s_sub_u32 s69, s69, 27
s_add_u32 s64, s52, s65
s_cmp_eq_u32 s50, 0
s_cselect_b32 s56, s28, s32
s_cselect_b32 s57, s29, s33
s_mov_b32 s58, s30
s_mov_b32 s59, s31
s_mul_i32 s54, s51, 9216
s_lshl_b32 s55, s69, 6
s_add_u32 s61, s54, s55
s_cmp_gt_u32 s62, 170
s_cselect_b32 s58, 0, s58
s_cmp_lt_u32 s53, 160
s_cbranch_scc1 g1_act
s_cmp_eq_u32 s50, s81
s_cbranch_scc1 g1_act
v_mul_f32 v8, 0xbfb8aa3b, v16
v_exp_f32 v8, v8
v_mul_f32 v16, v16, v32
v_add_f32 v8, 1.0, v8
v_rcp_f32 v8, v8
s_nop 0
v_mul_f32 v16, v16, v8
v_mul_f32 v9, 0xbfb8aa3b, v17
v_exp_f32 v9, v9
v_mul_f32 v17, v17, v33
v_add_f32 v9, 1.0, v9
v_rcp_f32 v9, v9
s_nop 0
v_mul_f32 v17, v17, v9
v_mul_f32 v10, 0xbfb8aa3b, v18
v_exp_f32 v10, v10
v_mul_f32 v18, v18, v34
v_add_f32 v10, 1.0, v10
v_rcp_f32 v10, v10
s_nop 0
v_mul_f32 v18, v18, v10
v_mul_f32 v11, 0xbfb8aa3b, v19
v_exp_f32 v11, v11
v_mul_f32 v19, v19, v35
v_add_f32 v11, 1.0, v11
v_rcp_f32 v11, v11
s_nop 0
v_mul_f32 v19, v19, v11
v_mul_f32 v8, 0xbfb8aa3b, v20
v_exp_f32 v8, v8
v_mul_f32 v20, v20, v36
v_add_f32 v8, 1.0, v8
v_rcp_f32 v8, v8
s_nop 0
v_mul_f32 v20, v20, v8
v_mul_f32 v9, 0xbfb8aa3b, v21
v_exp_f32 v9, v9
v_mul_f32 v21, v21, v37
v_add_f32 v9, 1.0, v9
v_rcp_f32 v9, v9
s_nop 0
v_mul_f32 v21, v21, v9
v_mul_f32 v10, 0xbfb8aa3b, v22
v_exp_f32 v10, v10
v_mul_f32 v22, v22, v38
v_add_f32 v10, 1.0, v10
v_rcp_f32 v10, v10
s_nop 0
v_mul_f32 v22, v22, v10
v_mul_f32 v11, 0xbfb8aa3b, v23
v_exp_f32 v11, v11
v_mul_f32 v23, v23, v39
v_add_f32 v11, 1.0, v11
v_rcp_f32 v11, v11
s_nop 0
v_mul_f32 v23, v23, v11
v_mul_f32 v8, 0xbfb8aa3b, v24
v_exp_f32 v8, v8
v_mul_f32 v24, v24, v40
v_add_f32 v8, 1.0, v8
v_rcp_f32 v8, v8
s_nop 0
v_mul_f32 v24, v24, v8
v_mul_f32 v9, 0xbfb8aa3b, v25
v_exp_f32 v9, v9
v_mul_f32 v25, v25, v41
v_add_f32 v9, 1.0, v9
v_rcp_f32 v9, v9
s_nop 0
v_mul_f32 v25, v25, v9
v_mul_f32 v10, 0xbfb8aa3b, v26
v_exp_f32 v10, v10
v_mul_f32 v26, v26, v42
v_add_f32 v10, 1.0, v10
v_rcp_f32 v10, v10
s_nop 0
v_mul_f32 v26, v26, v10
v_mul_f32 v11, 0xbfb8aa3b, v27
v_exp_f32 v11, v11
v_mul_f32 v27, v27, v43
v_add_f32 v11, 1.0, v11
v_rcp_f32 v11, v11
s_nop 0
v_mul_f32 v27, v27, v11
v_mul_f32 v8, 0xbfb8aa3b, v28
v_exp_f32 v8, v8
v_mul_f32 v28, v28, v44
v_add_f32 v8, 1.0, v8
v_rcp_f32 v8, v8
s_nop 0
v_mul_f32 v28, v28, v8
v_mul_f32 v9, 0xbfb8aa3b, v29
v_exp_f32 v9, v9
v_mul_f32 v29, v29, v45
v_add_f32 v9, 1.0, v9
v_rcp_f32 v9, v9
s_nop 0
v_mul_f32 v29, v29, v9
v_mul_f32 v10, 0xbfb8aa3b, v30
v_exp_f32 v10, v10
v_mul_f32 v30, v30, v46
v_add_f32 v10, 1.0, v10
v_rcp_f32 v10, v10
s_nop 0
v_mul_f32 v30, v30, v10
v_mul_f32 v11, 0xbfb8aa3b, v31
v_exp_f32 v11, v11
v_mul_f32 v31, v31, v47
v_add_f32 v11, 1.0, v11
v_rcp_f32 v11, v11
s_nop 0
v_mul_f32 v31, v31, v11
v_cvt_pk_bf16_f32 v32, v16, v17
v_cvt_pk_bf16_f32 v33, v18, v19
v_cvt_pk_bf16_f32 v34, v20, v21
v_cvt_pk_bf16_f32 v35, v22, v23
v_cvt_pk_bf16_f32 v36, v24, v25
v_cvt_pk_bf16_f32 v37, v26, v27
v_cvt_pk_bf16_f32 v38, v28, v29
v_cvt_pk_bf16_f32 v39, v30, v31
s_sub_u32 s67, s68, 27
s_lshl_b32 s67, s67, 6
buffer_store_dwordx2 v[32:33], v211, s[44:47], s67 offen offset:0
buffer_store_dwordx2 v[34:35], v211, s[44:47], s67 offen offset:16
buffer_store_dwordx2 v[36:37], v211, s[44:47], s67 offen offset:32
buffer_store_dwordx2 v[38:39], v211, s[44:47], s67 offen offset:48
s_branch g1_done
g1_act:
ds_read_b64_tr_b16 v[48:49], v213 offset:0
ds_read_b64_tr_b16 v[50:51], v213 offset:256
ds_read_b64_tr_b16 v[52:53], v213 offset:36864
ds_read_b64_tr_b16 v[54:55], v213 offset:37120
ds_read_b64_tr_b16 v[56:57], v213 offset:512
ds_read_b64_tr_b16 v[58:59], v213 offset:768
ds_read_b64_tr_b16 v[60:61], v213 offset:37376
ds_read_b64_tr_b16 v[62:63], v213 offset:37632
ds_read_b64_tr_b16 v[248:249], v213 offset:1024
ds_read_b64_tr_b16 v[250:251], v213 offset:1280
ds_read_b64_tr_b16 v[252:253], v213 offset:37888
ds_read_b64_tr_b16 v[254:255], v213 offset:38144
s_waitcnt lgkmcnt(8)
v_mfma_f32_32x32x16_bf16 v[216:231], v[48:51], v[64:67], 0
v_mfma_f32_32x32x16_bf16 v[232:247], v[52:55], v[64:67], 0
ds_read_b64_tr_b16 v[48:49], v213 offset:1536
ds_read_b64_tr_b16 v[50:51], v213 offset:1792
ds_read_b64_tr_b16 v[52:53], v213 offset:38400
ds_read_b64_tr_b16 v[54:55], v213 offset:38656
s_waitcnt lgkmcnt(8)
s_add_u32 m0, s64, 0
s_nop 0
buffer_load_dwordx4 v208, s[56:59], s61 offen lds
s_add_u32 s61, s61, 147456
v_mfma_f32_32x32x16_bf16 v[216:231], v[56:59], v[68:71], v[216:231]
v_mfma_f32_32x32x16_bf16 v[232:247], v[60:63], v[68:71], v[232:247]
ds_read_b64_tr_b16 v[56:57], v213 offset:2048
ds_read_b64_tr_b16 v[58:59], v213 offset:2304
ds_read_b64_tr_b16 v[60:61], v213 offset:38912
ds_read_b64_tr_b16 v[62:63], v213 offset:39168
s_waitcnt lgkmcnt(8)
v_mfma_f32_32x32x16_bf16 v[216:231], v[248:251], v[72:75], v[216:231]
v_mfma_f32_32x32x16_bf16 v[232:247], v[252:255], v[72:75], v[232:247]
ds_read_b64_tr_b16 v[248:249], v213 offset:2560
ds_read_b64_tr_b16 v[250:251], v213 offset:2816
ds_read_b64_tr_b16 v[252:253], v213 offset:39424
ds_read_b64_tr_b16 v[254:255], v213 offset:39680
s_waitcnt lgkmcnt(8)
v_mfma_f32_32x32x16_bf16 v[216:231], v[48:51], v[76:79], v[216:231]
v_mul_f32 v8, 0xbfb8aa3b, v16
v_exp_f32 v8, v8
v_mfma_f32_32x32x16_bf16 v[232:247], v[52:55], v[76:79], v[232:247]
v_mul_f32 v16, v16, v32
v_add_f32 v8, 1.0, v8
ds_read_b64_tr_b16 v[48:49], v213 offset:3072
ds_read_b64_tr_b16 v[50:51], v213 offset:3328
ds_read_b64_tr_b16 v[52:53], v213 offset:39936
ds_read_b64_tr_b16 v[54:55], v213 offset:40192
s_waitcnt lgkmcnt(8)
s_add_u32 m0, s64, 1024
s_nop 0
buffer_load_dwordx4 v208, s[56:59], s61 offen lds
s_add_u32 s61, s61, 147456
v_mfma_f32_32x32x16_bf16 v[216:231], v[56:59], v[80:83], v[216:231]
v_rcp_f32 v8, v8
s_nop 0
v_mfma_f32_32x32x16_bf16 v[232:247], v[60:63], v[80:83], v[232:247]
v_mul_f32 v16, v16, v8
v_mul_f32 v9, 0xbfb8aa3b, v17
ds_read_b64_tr_b16 v[56:57], v213 offset:3584
ds_read_b64_tr_b16 v[58:59], v213 offset:3840
ds_read_b64_tr_b16 v[60:61], v213 offset:40448
ds_read_b64_tr_b16 v[62:63], v213 offset:40704
s_waitcnt lgkmcnt(8)
v_mfma_f32_32x32x16_bf16 v[216:231], v[248:251], v[84:87], v[216:231]
v_exp_f32 v9, v9
v_mul_f32 v17, v17, v33
v_mfma_f32_32x32x16_bf16 v[232:247], v[252:255], v[84:87], v[232:247]
v_add_f32 v9, 1.0, v9
v_rcp_f32 v9, v9
ds_read_b64_tr_b16 v[248:249], v213 offset:4096
ds_read_b64_tr_b16 v[250:251], v213 offset:4352
ds_read_b64_tr_b16 v[252:253], v213 offset:40960
ds_read_b64_tr_b16 v[254:255], v213 offset:41216
s_waitcnt lgkmcnt(8)
v_mfma_f32_32x32x16_bf16 v[216:231], v[48:51], v[88:91], v[216:231]
s_nop 0
v_mul_f32 v17, v17, v9
v_mfma_f32_32x32x16_bf16 v[232:247], v[52:55], v[88:91], v[232:247]
v_mul_f32 v10, 0xbfb8aa3b, v18
v_exp_f32 v10, v10
ds_read_b64_tr_b16 v[48:49], v213 offset:4608
ds_read_b64_tr_b16 v[50:51], v213 offset:4864
ds_read_b64_tr_b16 v[52:53], v213 offset:41472
ds_read_b64_tr_b16 v[54:55], v213 offset:41728
s_waitcnt lgkmcnt(8)
s_add_u32 m0, s64, 2048
s_nop 0
buffer_load_dwordx4 v208, s[56:59], s61 offen lds
s_add_u32 s61, s61, 147456
v_mfma_f32_32x32x16_bf16 v[216:231], v[56:59], v[92:95], v[216:231]
v_mul_f32 v18, v18, v34
v_add_f32 v10, 1.0, v10
v_mfma_f32_32x32x16_bf16 v[232:247], v[60:63], v[92:95], v[232:247]
v_rcp_f32 v10, v10
s_nop 0
ds_read_b64_tr_b16 v[56:57], v213 offset:5120
ds_read_b64_tr_b16 v[58:59], v213 offset:5376
ds_read_b64_tr_b16 v[60:61], v213 offset:41984
ds_read_b64_tr_b16 v[62:63], v213 offset:42240
s_waitcnt lgkmcnt(8)
v_mfma_f32_32x32x16_bf16 v[216:231], v[248:251], v[96:99], v[216:231]
v_mul_f32 v18, v18, v10
v_mul_f32 v11, 0xbfb8aa3b, v19
v_mfma_f32_32x32x16_bf16 v[232:247], v[252:255], v[96:99], v[232:247]
v_exp_f32 v11, v11
v_mul_f32 v19, v19, v35
ds_read_b64_tr_b16 v[248:249], v213 offset:5632
ds_read_b64_tr_b16 v[250:251], v213 offset:5888
ds_read_b64_tr_b16 v[252:253], v213 offset:42496
ds_read_b64_tr_b16 v[254:255], v213 offset:42752
s_waitcnt lgkmcnt(8)
v_mfma_f32_32x32x16_bf16 v[216:231], v[48:51], v[100:103], v[216:231]
v_add_f32 v11, 1.0, v11
v_rcp_f32 v11, v11
v_mfma_f32_32x32x16_bf16 v[232:247], v[52:55], v[100:103], v[232:247]
s_nop 0
v_mul_f32 v19, v19, v11
ds_read_b64_tr_b16 v[48:49], v213 offset:6144
ds_read_b64_tr_b16 v[50:51], v213 offset:6400
ds_read_b64_tr_b16 v[52:53], v213 offset:43008
ds_read_b64_tr_b16 v[54:55], v213 offset:43264
s_waitcnt lgkmcnt(8)
s_add_u32 m0, s64, 3072
s_nop 0
buffer_load_dwordx4 v208, s[56:59], s61 offen lds
s_add_u32 s61, s61, 147456
v_mfma_f32_32x32x16_bf16 v[216:231], v[56:59], v[104:107], v[216:231]
v_mul_f32 v8, 0xbfb8aa3b, v20
v_exp_f32 v8, v8
v_mfma_f32_32x32x16_bf16 v[232:247], v[60:63], v[104:107], v[232:247]
v_mul_f32 v20, v20, v36
v_add_f32 v8, 1.0, v8
ds_read_b64_tr_b16 v[56:57], v213 offset:6656
ds_read_b64_tr_b16 v[58:59], v213 offset:6912
ds_read_b64_tr_b16 v[60:61], v213 offset:43520
ds_read_b64_tr_b16 v[62:63], v213 offset:43776
s_waitcnt lgkmcnt(8)
v_mfma_f32_32x32x16_bf16 v[216:231], v[248:251], v[108:111], v[216:231]
v_rcp_f32 v8, v8
s_nop 0
v_mfma_f32_32x32x16_bf16 v[232:247], v[252:255], v[108:111], v[232:247]
v_mul_f32 v20, v20, v8
v_mul_f32 v9, 0xbfb8aa3b, v21
ds_read_b64_tr_b16 v[248:249], v213 offset:7168
ds_read_b64_tr_b16 v[250:251], v213 offset:7424
ds_read_b64_tr_b16 v[252:253], v213 offset:44032
ds_read_b64_tr_b16 v[254:255], v213 offset:44288
s_waitcnt lgkmcnt(8)
v_mfma_f32_32x32x16_bf16 v[216:231], v[48:51], v[112:115], v[216:231]
v_exp_f32 v9, v9
v_mul_f32 v21, v21, v37
v_mfma_f32_32x32x16_bf16 v[232:247], v[52:55], v[112:115], v[232:247]
v_add_f32 v9, 1.0, v9
v_rcp_f32 v9, v9
ds_read_b64_tr_b16 v[48:49], v213 offset:7680
ds_read_b64_tr_b16 v[50:51], v213 offset:7936
ds_read_b64_tr_b16 v[52:53], v213 offset:44544
ds_read_b64_tr_b16 v[54:55], v213 offset:44800
s_waitcnt lgkmcnt(8)
s_add_u32 m0, s64, 4096
s_nop 0
buffer_load_dwordx4 v208, s[56:59], s61 offen lds
s_add_u32 s61, s61, 147456
v_mfma_f32_32x32x16_bf16 v[216:231], v[56:59], v[116:119], v[216:231]
s_nop 0
v_mul_f32 v21, v21, v9
v_mfma_f32_32x32x16_bf16 v[232:247], v[60:63], v[116:119], v[232:247]
v_mul_f32 v10, 0xbfb8aa3b, v22
v_exp_f32 v10, v10
ds_read_b64_tr_b16 v[56:57], v213 offset:8192
ds_read_b64_tr_b16 v[58:59], v213 offset:8448
ds_read_b64_tr_b16 v[60:61], v213 offset:45056
ds_read_b64_tr_b16 v[62:63], v213 offset:45312
s_waitcnt lgkmcnt(8)
v_mfma_f32_32x32x16_bf16 v[216:231], v[248:251], v[120:123], v[216:231]
v_mul_f32 v22, v22, v38
v_add_f32 v10, 1.0, v10
v_mfma_f32_32x32x16_bf16 v[232:247], v[252:255], v[120:123], v[232:247]
v_rcp_f32 v10, v10
s_nop 0
ds_read_b64_tr_b16 v[248:249], v213 offset:8704
ds_read_b64_tr_b16 v[250:251], v213 offset:8960
ds_read_b64_tr_b16 v[252:253], v213 offset:45568
ds_read_b64_tr_b16 v[254:255], v213 offset:45824
s_waitcnt lgkmcnt(8)
v_mfma_f32_32x32x16_bf16 v[216:231], v[48:51], v[124:127], v[216:231]
v_mul_f32 v22, v22, v10
v_mul_f32 v11, 0xbfb8aa3b, v23
v_mfma_f32_32x32x16_bf16 v[232:247], v[52:55], v[124:127], v[232:247]
v_exp_f32 v11, v11
v_mul_f32 v23, v23, v39
ds_read_b64_tr_b16 v[48:49], v213 offset:9216
ds_read_b64_tr_b16 v[50:51], v213 offset:9472
ds_read_b64_tr_b16 v[52:53], v213 offset:46080
ds_read_b64_tr_b16 v[54:55], v213 offset:46336
s_waitcnt lgkmcnt(8)
s_add_u32 m0, s64, 5120
s_nop 0
buffer_load_dwordx4 v208, s[56:59], s61 offen lds
s_add_u32 s61, s61, 147456
v_mfma_f32_32x32x16_bf16 v[216:231], v[56:59], v[128:131], v[216:231]
v_add_f32 v11, 1.0, v11
v_rcp_f32 v11, v11
v_mfma_f32_32x32x16_bf16 v[232:247], v[60:63], v[128:131], v[232:247]
s_nop 0
v_mul_f32 v23, v23, v11
ds_read_b64_tr_b16 v[56:57], v213 offset:9728
ds_read_b64_tr_b16 v[58:59], v213 offset:9984
ds_read_b64_tr_b16 v[60:61], v213 offset:46592
ds_read_b64_tr_b16 v[62:63], v213 offset:46848
s_waitcnt lgkmcnt(8)
v_mfma_f32_32x32x16_bf16 v[216:231], v[248:251], v[132:135], v[216:231]
v_mul_f32 v8, 0xbfb8aa3b, v24
v_exp_f32 v8, v8
v_mfma_f32_32x32x16_bf16 v[232:247], v[252:255], v[132:135], v[232:247]
v_mul_f32 v24, v24, v40
v_add_f32 v8, 1.0, v8
ds_read_b64_tr_b16 v[248:249], v213 offset:10240
ds_read_b64_tr_b16 v[250:251], v213 offset:10496
ds_read_b64_tr_b16 v[252:253], v213 offset:47104
ds_read_b64_tr_b16 v[254:255], v213 offset:47360
s_waitcnt lgkmcnt(8)
v_mfma_f32_32x32x16_bf16 v[216:231], v[48:51], v[136:139], v[216:231]
v_rcp_f32 v8, v8
s_nop 0
v_mfma_f32_32x32x16_bf16 v[232:247], v[52:55], v[136:139], v[232:247]
v_mul_f32 v24, v24, v8
v_mul_f32 v9, 0xbfb8aa3b, v25
ds_read_b64_tr_b16 v[48:49], v213 offset:10752
ds_read_b64_tr_b16 v[50:51], v213 offset:11008
ds_read_b64_tr_b16 v[52:53], v213 offset:47616
ds_read_b64_tr_b16 v[54:55], v213 offset:47872
s_waitcnt lgkmcnt(8)
s_add_u32 m0, s64, 6144
s_nop 0
buffer_load_dwordx4 v208, s[56:59], s61 offen lds
s_add_u32 s61, s61, 147456
v_mfma_f32_32x32x16_bf16 v[216:231], v[56:59], v[140:143], v[216:231]
v_exp_f32 v9, v9
v_mul_f32 v25, v25, v41
v_mfma_f32_32x32x16_bf16 v[232:247], v[60:63], v[140:143], v[232:247]
v_add_f32 v9, 1.0, v9
v_rcp_f32 v9, v9
ds_read_b64_tr_b16 v[56:57], v213 offset:11264
ds_read_b64_tr_b16 v[58:59], v213 offset:11520
ds_read_b64_tr_b16 v[60:61], v213 offset:48128
ds_read_b64_tr_b16 v[62:63], v213 offset:48384
s_waitcnt lgkmcnt(8)
v_mfma_f32_32x32x16_bf16 v[216:231], v[248:251], v[144:147], v[216:231]
s_nop 0
v_mul_f32 v25, v25, v9
v_mfma_f32_32x32x16_bf16 v[232:247], v[252:255], v[144:147], v[232:247]
v_mul_f32 v10, 0xbfb8aa3b, v26
v_exp_f32 v10, v10
ds_read_b64_tr_b16 v[248:249], v213 offset:11776
ds_read_b64_tr_b16 v[250:251], v213 offset:12032
ds_read_b64_tr_b16 v[252:253], v213 offset:48640
ds_read_b64_tr_b16 v[254:255], v213 offset:48896
s_waitcnt lgkmcnt(8)
v_mfma_f32_32x32x16_bf16 v[216:231], v[48:51], v[148:151], v[216:231]
v_mul_f32 v26, v26, v42
v_add_f32 v10, 1.0, v10
v_mfma_f32_32x32x16_bf16 v[232:247], v[52:55], v[148:151], v[232:247]
v_rcp_f32 v10, v10
s_nop 0
ds_read_b64_tr_b16 v[48:49], v213 offset:12288
ds_read_b64_tr_b16 v[50:51], v213 offset:12544
ds_read_b64_tr_b16 v[52:53], v213 offset:49152
ds_read_b64_tr_b16 v[54:55], v213 offset:49408
s_waitcnt lgkmcnt(8)
s_add_u32 m0, s64, 7168
s_nop 0
buffer_load_dwordx4 v208, s[56:59], s61 offen lds
s_add_u32 s61, s61, 147456
v_mfma_f32_32x32x16_bf16 v[216:231], v[56:59], v[152:155], v[216:231]
v_mul_f32 v26, v26, v10
v_mul_f32 v11, 0xbfb8aa3b, v27
v_mfma_f32_32x32x16_bf16 v[232:247], v[60:63], v[152:155], v[232:247]
v_exp_f32 v11, v11
v_mul_f32 v27, v27, v43
ds_read_b64_tr_b16 v[56:57], v213 offset:12800
ds_read_b64_tr_b16 v[58:59], v213 offset:13056
ds_read_b64_tr_b16 v[60:61], v213 offset:49664
ds_read_b64_tr_b16 v[62:63], v213 offset:49920
s_waitcnt lgkmcnt(8)
v_mfma_f32_32x32x16_bf16 v[216:231], v[248:251], v[156:159], v[216:231]
v_add_f32 v11, 1.0, v11
v_rcp_f32 v11, v11
v_mfma_f32_32x32x16_bf16 v[232:247], v[252:255], v[156:159], v[232:247]
s_nop 0
v_mul_f32 v27, v27, v11
ds_read_b64_tr_b16 v[248:249], v213 offset:13312
ds_read_b64_tr_b16 v[250:251], v213 offset:13568
ds_read_b64_tr_b16 v[252:253], v213 offset:50176
ds_read_b64_tr_b16 v[254:255], v213 offset:50432
s_waitcnt lgkmcnt(8)
v_mfma_f32_32x32x16_bf16 v[216:231], v[48:51], v[160:163], v[216:231]
v_mul_f32 v8, 0xbfb8aa3b, v28
v_exp_f32 v8, v8
v_mfma_f32_32x32x16_bf16 v[232:247], v[52:55], v[160:163], v[232:247]
v_mul_f32 v28, v28, v44
v_add_f32 v8, 1.0, v8
ds_read_b64_tr_b16 v[48:49], v213 offset:13824
ds_read_b64_tr_b16 v[50:51], v213 offset:14080
ds_read_b64_tr_b16 v[52:53], v213 offset:50688
ds_read_b64_tr_b16 v[54:55], v213 offset:50944
s_waitcnt lgkmcnt(8)
s_add_u32 m0, s64, 8192
s_nop 0
buffer_load_dwordx4 v208, s[56:59], s61 offen lds
s_add_u32 s61, s61, 147456
v_mfma_f32_32x32x16_bf16 v[216:231], v[56:59], v[164:167], v[216:231]
v_rcp_f32 v8, v8
s_nop 0
v_mfma_f32_32x32x16_bf16 v[232:247], v[60:63], v[164:167], v[232:247]
v_mul_f32 v28, v28, v8
v_mul_f32 v9, 0xbfb8aa3b, v29
ds_read_b64_tr_b16 v[56:57], v213 offset:14336
ds_read_b64_tr_b16 v[58:59], v213 offset:14592
ds_read_b64_tr_b16 v[60:61], v213 offset:51200
ds_read_b64_tr_b16 v[62:63], v213 offset:51456
s_waitcnt lgkmcnt(8)
v_mfma_f32_32x32x16_bf16 v[216:231], v[248:251], v[168:171], v[216:231]
v_exp_f32 v9, v9
v_mul_f32 v29, v29, v45
v_mfma_f32_32x32x16_bf16 v[232:247], v[252:255], v[168:171], v[232:247]
v_add_f32 v9, 1.0, v9
v_rcp_f32 v9, v9
ds_read_b64_tr_b16 v[248:249], v213 offset:14848
ds_read_b64_tr_b16 v[250:251], v213 offset:15104
ds_read_b64_tr_b16 v[252:253], v213 offset:51712
ds_read_b64_tr_b16 v[254:255], v213 offset:51968
s_waitcnt lgkmcnt(8)
v_mfma_f32_32x32x16_bf16 v[216:231], v[48:51], v[172:175], v[216:231]
s_nop 0
v_mul_f32 v29, v29, v9
v_mfma_f32_32x32x16_bf16 v[232:247], v[52:55], v[172:175], v[232:247]
v_mul_f32 v10, 0xbfb8aa3b, v30
v_exp_f32 v10, v10
ds_read_b64_tr_b16 v[48:49], v213 offset:15360
ds_read_b64_tr_b16 v[50:51], v213 offset:15616
ds_read_b64_tr_b16 v[52:53], v213 offset:52224
ds_read_b64_tr_b16 v[54:55], v213 offset:52480
s_waitcnt lgkmcnt(8)
v_mfma_f32_32x32x16_bf16 v[216:231], v[56:59], v[176:179], v[216:231]
v_mul_f32 v30, v30, v46
v_add_f32 v10, 1.0, v10
v_mfma_f32_32x32x16_bf16 v[232:247], v[60:63], v[176:179], v[232:247]
v_rcp_f32 v10, v10
s_nop 0
ds_read_b64_tr_b16 v[56:57], v213 offset:15872
ds_read_b64_tr_b16 v[58:59], v213 offset:16128
ds_read_b64_tr_b16 v[60:61], v213 offset:52736
ds_read_b64_tr_b16 v[62:63], v213 offset:52992
s_waitcnt lgkmcnt(8)
v_mfma_f32_32x32x16_bf16 v[216:231], v[248:251], v[180:183], v[216:231]
v_mul_f32 v30, v30, v10
v_mul_f32 v11, 0xbfb8aa3b, v31
v_mfma_f32_32x32x16_bf16 v[232:247], v[252:255], v[180:183], v[232:247]
v_exp_f32 v11, v11
v_mul_f32 v31, v31, v47
ds_read_b64_tr_b16 v[248:249], v213 offset:16384
ds_read_b64_tr_b16 v[250:251], v213 offset:16640
ds_read_b64_tr_b16 v[252:253], v213 offset:53248
ds_read_b64_tr_b16 v[254:255], v213 offset:53504
s_waitcnt lgkmcnt(8)
v_mfma_f32_32x32x16_bf16 v[216:231], v[48:51], v[184:187], v[216:231]
v_add_f32 v11, 1.0, v11
v_rcp_f32 v11, v11
v_mfma_f32_32x32x16_bf16 v[232:247], v[52:55], v[184:187], v[232:247]
s_nop 0
v_mul_f32 v31, v31, v11
ds_read_b64_tr_b16 v[48:49], v213 offset:16896
ds_read_b64_tr_b16 v[50:51], v213 offset:17152
ds_read_b64_tr_b16 v[52:53], v213 offset:53760
ds_read_b64_tr_b16 v[54:55], v213 offset:54016
s_waitcnt lgkmcnt(8)
v_mfma_f32_32x32x16_bf16 v[216:231], v[56:59], v[188:191], v[216:231]
v_cvt_pk_bf16_f32 v32, v16, v17
v_cvt_pk_bf16_f32 v33, v18, v19
v_mfma_f32_32x32x16_bf16 v[232:247], v[60:63], v[188:191], v[232:247]
v_cvt_pk_bf16_f32 v34, v20, v21
v_cvt_pk_bf16_f32 v35, v22, v23
ds_read_b64_tr_b16 v[56:57], v213 offset:17408
ds_read_b64_tr_b16 v[58:59], v213 offset:17664
ds_read_b64_tr_b16 v[60:61], v213 offset:54272
ds_read_b64_tr_b16 v[62:63], v213 offset:54528
s_waitcnt lgkmcnt(8)
v_mfma_f32_32x32x16_bf16 v[216:231], v[248:251], v[192:195], v[216:231]
v_cvt_pk_bf16_f32 v36, v24, v25
v_cvt_pk_bf16_f32 v37, v26, v27
v_mfma_f32_32x32x16_bf16 v[232:247], v[252:255], v[192:195], v[232:247]
v_cvt_pk_bf16_f32 v38, v28, v29
v_cvt_pk_bf16_f32 v39, v30, v31
ds_read_b64_tr_b16 v[248:249], v213 offset:17920
ds_read_b64_tr_b16 v[250:251], v213 offset:18176
ds_read_b64_tr_b16 v[252:253], v213 offset:54784
ds_read_b64_tr_b16 v[254:255], v213 offset:55040
s_waitcnt lgkmcnt(8)
v_mfma_f32_32x32x16_bf16 v[216:231], v[48:51], v[196:199], v[216:231]
s_sub_u32 s67, s68, 27
s_lshl_b32 s67, s67, 6
v_mfma_f32_32x32x16_bf16 v[232:247], v[52:55], v[196:199], v[232:247]
buffer_store_dwordx2 v[32:33], v211, s[44:47], s67 offen offset:0
buffer_store_dwordx2 v[34:35], v211, s[44:47], s67 offen offset:16
s_waitcnt lgkmcnt(4)
v_mfma_f32_32x32x16_bf16 v[216:231], v[56:59], v[200:203], v[216:231]
buffer_store_dwordx2 v[36:37], v211, s[44:47], s67 offen offset:32
buffer_store_dwordx2 v[38:39], v211, s[44:47], s67 offen offset:48
v_mfma_f32_32x32x16_bf16 v[232:247], v[60:63], v[200:203], v[232:247]
s_waitcnt lgkmcnt(0)
v_mfma_f32_32x32x16_bf16 v[216:231], v[248:251], v[204:207], v[216:231]
v_mfma_f32_32x32x16_bf16 v[232:247], v[252:255], v[204:207], v[232:247]
s_mov_b32 s66, s63
s_mov_b32 s63, s65
s_mov_b32 s65, s66
s_mov_b32 s68, s53
s_mov_b32 s53, s62
s_cmp_ge_u32 s53, 171
s_cbranch_scc1 g1_fin1
s_branch g1_loop
g1_fin0:
s_nop 15
v_mul_f32 v8, 0xbfb8aa3b, v16
v_exp_f32 v8, v8
v_mul_f32 v16, v16, v32
v_add_f32 v8, 1.0, v8
v_rcp_f32 v8, v8
s_nop 0
v_mul_f32 v16, v16, v8
v_mul_f32 v9, 0xbfb8aa3b, v17
v_exp_f32 v9, v9
v_mul_f32 v17, v17, v33
v_add_f32 v9, 1.0, v9
v_rcp_f32 v9, v9
s_nop 0
v_mul_f32 v17, v17, v9
v_mul_f32 v10, 0xbfb8aa3b, v18
v_exp_f32 v10, v10
v_mul_f32 v18, v18, v34
v_add_f32 v10, 1.0, v10
v_rcp_f32 v10, v10
s_nop 0
v_mul_f32 v18, v18, v10
v_mul_f32 v11, 0xbfb8aa3b, v19
v_exp_f32 v11, v11
v_mul_f32 v19, v19, v35
v_add_f32 v11, 1.0, v11
v_rcp_f32 v11, v11
s_nop 0
v_mul_f32 v19, v19, v11
v_mul_f32 v8, 0xbfb8aa3b, v20
v_exp_f32 v8, v8
v_mul_f32 v20, v20, v36
v_add_f32 v8, 1.0, v8
v_rcp_f32 v8, v8
s_nop 0
v_mul_f32 v20, v20, v8
v_mul_f32 v9, 0xbfb8aa3b, v21
v_exp_f32 v9, v9
v_mul_f32 v21, v21, v37
v_add_f32 v9, 1.0, v9
v_rcp_f32 v9, v9
s_nop 0
v_mul_f32 v21, v21, v9
v_mul_f32 v10, 0xbfb8aa3b, v22
v_exp_f32 v10, v10
v_mul_f32 v22, v22, v38
v_add_f32 v10, 1.0, v10
v_rcp_f32 v10, v10
s_nop 0
v_mul_f32 v22, v22, v10
v_mul_f32 v11, 0xbfb8aa3b, v23
v_exp_f32 v11, v11
v_mul_f32 v23, v23, v39
v_add_f32 v11, 1.0, v11
v_rcp_f32 v11, v11
s_nop 0
v_mul_f32 v23, v23, v11
v_mul_f32 v8, 0xbfb8aa3b, v24
v_exp_f32 v8, v8
v_mul_f32 v24, v24, v40
v_add_f32 v8, 1.0, v8
v_rcp_f32 v8, v8
s_nop 0
v_mul_f32 v24, v24, v8
v_mul_f32 v9, 0xbfb8aa3b, v25
v_exp_f32 v9, v9
v_mul_f32 v25, v25, v41
v_add_f32 v9, 1.0, v9
v_rcp_f32 v9, v9
s_nop 0
v_mul_f32 v25, v25, v9
v_mul_f32 v10, 0xbfb8aa3b, v26
v_exp_f32 v10, v10
v_mul_f32 v26, v26, v42
v_add_f32 v10, 1.0, v10
v_rcp_f32 v10, v10
s_nop 0
v_mul_f32 v26, v26, v10
v_mul_f32 v11, 0xbfb8aa3b, v27
v_exp_f32 v11, v11
v_mul_f32 v27, v27, v43
v_add_f32 v11, 1.0, v11
v_rcp_f32 v11, v11
s_nop 0
v_mul_f32 v27, v27, v11
v_mul_f32 v8, 0xbfb8aa3b, v28
v_exp_f32 v8, v8
v_mul_f32 v28, v28, v44
v_add_f32 v8, 1.0, v8
v_rcp_f32 v8, v8
s_nop 0
v_mul_f32 v28, v28, v8
v_mul_f32 v9, 0xbfb8aa3b, v29
v_exp_f32 v9, v9
v_mul_f32 v29, v29, v45
v_add_f32 v9, 1.0, v9
v_rcp_f32 v9, v9
s_nop 0
v_mul_f32 v29, v29, v9
v_mul_f32 v10, 0xbfb8aa3b, v30
v_exp_f32 v10, v10
v_mul_f32 v30, v30, v46
v_add_f32 v10, 1.0, v10
v_rcp_f32 v10, v10
s_nop 0
v_mul_f32 v30, v30, v10
v_mul_f32 v11, 0xbfb8aa3b, v31
v_exp_f32 v11, v11
v_mul_f32 v31, v31, v47
v_add_f32 v11, 1.0, v11
v_rcp_f32 v11, v11
s_nop 0
v_mul_f32 v31, v31, v11
v_cvt_pk_bf16_f32 v32, v16, v17
v_cvt_pk_bf16_f32 v33, v18, v19
v_cvt_pk_bf16_f32 v34, v20, v21
v_cvt_pk_bf16_f32 v35, v22, v23
v_cvt_pk_bf16_f32 v36, v24, v25
v_cvt_pk_bf16_f32 v37, v26, v27
v_cvt_pk_bf16_f32 v38, v28, v29
v_cvt_pk_bf16_f32 v39, v30, v31
s_sub_u32 s67, s68, 27
s_lshl_b32 s67, s67, 6
buffer_store_dwordx2 v[32:33], v211, s[44:47], s67 offen offset:0
buffer_store_dwordx2 v[34:35], v211, s[44:47], s67 offen offset:16
buffer_store_dwordx2 v[36:37], v211, s[44:47], s67 offen offset:32
buffer_store_dwordx2 v[38:39], v211, s[44:47], s67 offen offset:48
s_branch g1_done
g1_fin1:
s_nop 15
v_mul_f32 v8, 0xbfb8aa3b, v216
v_exp_f32 v8, v8
v_mul_f32 v216, v216, v232
v_add_f32 v8, 1.0, v8
v_rcp_f32 v8, v8
s_nop 0
v_mul_f32 v216, v216, v8
v_mul_f32 v9, 0xbfb8aa3b, v217
v_exp_f32 v9, v9
v_mul_f32 v217, v217, v233
v_add_f32 v9, 1.0, v9
v_rcp_f32 v9, v9
s_nop 0
v_mul_f32 v217, v217, v9
v_mul_f32 v10, 0xbfb8aa3b, v218
v_exp_f32 v10, v10
v_mul_f32 v218, v218, v234
v_add_f32 v10, 1.0, v10
v_rcp_f32 v10, v10
s_nop 0
v_mul_f32 v218, v218, v10
v_mul_f32 v11, 0xbfb8aa3b, v219
v_exp_f32 v11, v11
v_mul_f32 v219, v219, v235
v_add_f32 v11, 1.0, v11
v_rcp_f32 v11, v11
s_nop 0
v_mul_f32 v219, v219, v11
v_mul_f32 v8, 0xbfb8aa3b, v220
v_exp_f32 v8, v8
v_mul_f32 v220, v220, v236
v_add_f32 v8, 1.0, v8
v_rcp_f32 v8, v8
s_nop 0
v_mul_f32 v220, v220, v8
v_mul_f32 v9, 0xbfb8aa3b, v221
v_exp_f32 v9, v9
v_mul_f32 v221, v221, v237
v_add_f32 v9, 1.0, v9
v_rcp_f32 v9, v9
s_nop 0
v_mul_f32 v221, v221, v9
v_mul_f32 v10, 0xbfb8aa3b, v222
v_exp_f32 v10, v10
v_mul_f32 v222, v222, v238
v_add_f32 v10, 1.0, v10
v_rcp_f32 v10, v10
s_nop 0
v_mul_f32 v222, v222, v10
v_mul_f32 v11, 0xbfb8aa3b, v223
v_exp_f32 v11, v11
v_mul_f32 v223, v223, v239
v_add_f32 v11, 1.0, v11
v_rcp_f32 v11, v11
s_nop 0
v_mul_f32 v223, v223, v11
v_mul_f32 v8, 0xbfb8aa3b, v224
v_exp_f32 v8, v8
v_mul_f32 v224, v224, v240
v_add_f32 v8, 1.0, v8
v_rcp_f32 v8, v8
s_nop 0
v_mul_f32 v224, v224, v8
v_mul_f32 v9, 0xbfb8aa3b, v225
v_exp_f32 v9, v9
v_mul_f32 v225, v225, v241
v_add_f32 v9, 1.0, v9
v_rcp_f32 v9, v9
s_nop 0
v_mul_f32 v225, v225, v9
v_mul_f32 v10, 0xbfb8aa3b, v226
v_exp_f32 v10, v10
v_mul_f32 v226, v226, v242
v_add_f32 v10, 1.0, v10
v_rcp_f32 v10, v10
s_nop 0
v_mul_f32 v226, v226, v10
v_mul_f32 v11, 0xbfb8aa3b, v227
v_exp_f32 v11, v11
v_mul_f32 v227, v227, v243
v_add_f32 v11, 1.0, v11
v_rcp_f32 v11, v11
s_nop 0
v_mul_f32 v227, v227, v11
v_mul_f32 v8, 0xbfb8aa3b, v228
v_exp_f32 v8, v8
v_mul_f32 v228, v228, v244
v_add_f32 v8, 1.0, v8
v_rcp_f32 v8, v8
s_nop 0
v_mul_f32 v228, v228, v8
v_mul_f32 v9, 0xbfb8aa3b, v229
v_exp_f32 v9, v9
v_mul_f32 v229, v229, v245
v_add_f32 v9, 1.0, v9
v_rcp_f32 v9, v9
s_nop 0
v_mul_f32 v229, v229, v9
v_mul_f32 v10, 0xbfb8aa3b, v230
v_exp_f32 v10, v10
v_mul_f32 v230, v230, v246
v_add_f32 v10, 1.0, v10
v_rcp_f32 v10, v10
s_nop 0
v_mul_f32 v230, v230, v10
v_mul_f32 v11, 0xbfb8aa3b, v231
v_exp_f32 v11, v11
v_mul_f32 v231, v231, v247
v_add_f32 v11, 1.0, v11
v_rcp_f32 v11, v11
s_nop 0
v_mul_f32 v231, v231, v11
v_cvt_pk_bf16_f32 v232, v216, v217
v_cvt_pk_bf16_f32 v233, v218, v219
v_cvt_pk_bf16_f32 v234, v220, v221
v_cvt_pk_bf16_f32 v235, v222, v223
v_cvt_pk_bf16_f32 v236, v224, v225
v_cvt_pk_bf16_f32 v237, v226, v227
v_cvt_pk_bf16_f32 v238, v228, v229
v_cvt_pk_bf16_f32 v239, v230, v231
s_sub_u32 s67, s68, 27
s_lshl_b32 s67, s67, 6
buffer_store_dwordx2 v[232:233], v211, s[44:47], s67 offen offset:0
buffer_store_dwordx2 v[234:235], v211, s[44:47], s67 offen offset:16
buffer_store_dwordx2 v[236:237], v211, s[44:47], s67 offen offset:32
buffer_store_dwordx2 v[238:239], v211, s[44:47], s67 offen offset:48
s_branch g1_done
g1_done:
s_waitcnt vmcnt(0)
g1_end:
s_endpgm
.section .rodata,"a"
.p2align 6
.amdhsa_kernel g1_kernel
  .amdhsa_next_free_vgpr 256
  .amdhsa_next_free_sgpr 102
  .amdhsa_accum_offset 256
  .amdhsa_group_segment_fixed_size 0
  .amdhsa_kernarg_size 80
  .amdhsa_user_sgpr_count 2
  .amdhsa_user_sgpr_kernarg_segment_ptr 1
  .amdhsa_system_sgpr_workgroup_id_x 1
.end_amdhsa_kernel
.text

.globl at_kernel
.p2align 8
.type at_kernel,@function
at_kernel:
s_cmp_ge_u32 s2, 256
s_cbranch_scc1 at_end
s_load_dwordx2 s[12:13], s[0:1], 72
s_load_dwordx2 s[4:5], s[0:1], 16
s_load_dwordx2 s[6:7], s[0:1], 48
s_and_b32 s16, s2, 31
s_lshr_b32 s17, s2, 5
v_lshrrev_b32 v1, 6, v0
s_nop 0
v_readfirstlane_b32 s18, v1
v_and_b32 v2, 63, v0
v_and_b32 v3, 31, v2
v_lshrrev_b32 v4, 5, v2
s_waitcnt lgkmcnt(0)
s_add_u32 s40, s12, 0
s_addc_u32 s41, s13, 0
s_mov_b32 s36, s40
s_and_b32 s37, s41, 0xffff
s_mov_b32 s38, 7077888
s_mov_b32 s39, 0x00020000
s_add_u32 s40, s12, 8388608
s_addc_u32 s41, s13, 0
s_mov_b32 s44, s40
s_and_b32 s45, s41, 0xffff
s_mov_b32 s46, 21233664
s_mov_b32 s47, 0x00020000
s_mul_i32 s19, s16, 73728
s_mul_i32 s22, s16, 36
s_mov_b32 s23, 2359296
s_mov_b32 s24, 4718592
v_add_u32 v5, 0, v0
v_mul_u32_u24 v6, 36, v5
v_add_u32 v6, s19, v6
buffer_load_dwordx4 v[32:35], v6, s[36:39], s23 offen
buffer_load_dwordx4 v[36:39], v6, s[36:39], s23 offen offset:16
buffer_load_dword v40, v6, s[36:39], s23 offen offset:32
v_mov_b32 v41, 0x3f803f80
v_add_u32 v5, 512, v0
v_mul_u32_u24 v6, 36, v5
v_add_u32 v6, s19, v6
buffer_load_dwordx4 v[44:47], v6, s[36:39], s23 offen
buffer_load_dwordx4 v[48:51], v6, s[36:39], s23 offen offset:16
buffer_load_dword v52, v6, s[36:39], s23 offen offset:32
v_mov_b32 v53, 0x3f803f80
v_add_u32 v5, 1024, v0
v_mul_u32_u24 v6, 36, v5
v_add_u32 v6, s19, v6
buffer_load_dwordx4 v[56:59], v6, s[36:39], s23 offen
buffer_load_dwordx4 v[60:63], v6, s[36:39], s23 offen offset:16
buffer_load_dword v64, v6, s[36:39], s23 offen offset:32
v_mov_b32 v65, 0x3f803f80
v_add_u32 v5, 1536, v0
v_mul_u32_u24 v6, 36, v5
v_add_u32 v6, s19, v6
buffer_load_dwordx4 v[68:71], v6, s[36:39], s23 offen
buffer_load_dwordx4 v[72:75], v6, s[36:39], s23 offen offset:16
buffer_load_dword v76, v6, s[36:39], s23 offen offset:32
v_mov_b32 v77, 0x3f803f80
v_add_u32 v5, 0, v0
v_mul_u32_u24 v6, 36, v5
v_add_u32 v6, s19, v6
buffer_load_dwordx4 v[140:143], v6, s[36:39], s24 offen
buffer_load_dwordx4 v[144:147], v6, s[36:39], s24 offen offset:16
buffer_load_dword v148, v6, s[36:39], s24 offen offset:32
v_add_u32 v5, 512, v0
v_mul_u32_u24 v6, 36, v5
v_add_u32 v6, s19, v6
buffer_load_dwordx4 v[152:155], v6, s[36:39], s24 offen
buffer_load_dwordx4 v[156:159], v6, s[36:39], s24 offen offset:16
buffer_load_dword v160, v6, s[36:39], s24 offen offset:32
v_add_u32 v5, 1024, v0
v_mul_u32_u24 v6, 36, v5
v_add_u32 v6, s19, v6
buffer_load_dwordx4 v[164:167], v6, s[36:39], s24 offen
buffer_load_dwordx4 v[168:171], v6, s[36:39], s24 offen offset:16
buffer_load_dword v172, v6, s[36:39], s24 offen offset:32
v_add_u32 v5, 1536, v0
v_mul_u32_u24 v6, 36, v5
v_add_u32 v6, s19, v6
buffer_load_dwordx4 v[176:179], v6, s[36:39], s24 offen
buffer_load_dwordx4 v[180:183], v6, s[36:39], s24 offen offset:16
buffer_load_dword v184, v6, s[36:39], s24 offen offset:32
v_add_u32 v5, 0, v0
v_lshlrev_b32 v7, 4, v5
v_lshlrev_b32 v8, 3, v5
v_add_u32 v8, 65536, v8
s_waitcnt vmcnt(21)
ds_write_b128 v7, v[32:35]
ds_write_b128 v7, v[36:39] offset:32768
ds_write_b64 v8, v[40:41]
v_add_u32 v5, 512, v0
v_lshlrev_b32 v7, 4, v5
v_lshlrev_b32 v8, 3, v5
v_add_u32 v8, 65536, v8
s_waitcnt vmcnt(18)
ds_write_b128 v7, v[44:47]
ds_write_b128 v7, v[48:51] offset:32768
ds_write_b64 v8, v[52:53]
v_add_u32 v5, 1024, v0
v_lshlrev_b32 v7, 4, v5
v_lshlrev_b32 v8, 3, v5
v_add_u32 v8, 65536, v8
s_waitcnt vmcnt(15)
ds_write_b128 v7, v[56:59]
ds_write_b128 v7, v[60:63] offset:32768
ds_write_b64 v8, v[64:65]
v_add_u32 v5, 1536, v0
v_lshlrev_b32 v7, 4, v5
v_lshlrev_b32 v8, 3, v5
v_add_u32 v8, 65536, v8
s_waitcnt vmcnt(12)
ds_write_b128 v7, v[68:71]
ds_write_b128 v7, v[72:75] offset:32768
ds_write_b64 v8, v[76:77]
s_waitcnt lgkmcnt(0)
s_lshl_b32 s20, s17, 8
s_lshl_b32 s21, s18, 5
s_add_u32 s20, s20, s21
v_add_u32 v5, s20, v3
v_mul_u32_u24 v6, 36, v5
v_add_u32 v6, s19, v6
v_lshl_add_u32 v7, v4, 4, v6
buffer_load_dwordx4 v[40:43], v7, s[36:39], 0 offen
buffer_load_dword v44, v6, s[36:39], 0 offen offset:32
v_mov_b32 v45, 0
v_lshlrev_b32 v10, 4, v3
v_lshl_add_u32 v10, v4, 15, v10
v_lshlrev_b32 v11, 3, v3
v_add_u32 v11, 65536, v11
v_min_u32 v12, 18, v3
v_lshlrev_b32 v12, 4, v12
v_mul_u32_u24 v13, 304, v4
v_add_u32 v12, v12, v13
v_add_u32 v12, 81920, v12
v_add_u32 v13, 38912, v12
s_waitcnt vmcnt(0) lgkmcnt(0)
v_cmp_eq_u32 vcc, 0, v4
s_nop 1
v_cndmask_b32 v44, 0, v44, vcc
s_barrier
s_mov_b32 s48, s4
s_and_b32 s49, s5, 0xffff
s_mov_b32 s50, 663552
s_mov_b32 s51, 0x00020000
s_mov_b32 s52, s6
s_and_b32 s53, s7, 0xffff
s_mov_b32 s54, 5308416
s_mov_b32 s55, 0x00020000
s_lshr_b32 s25, s2, 3
s_lshl_b32 s25, s25, 9
v_add_u32 v15, s25, v0
v_mul_u32_u24 v16, 7282, v15
v_lshrrev_b32 v16, 16, v16
v_mul_u32_u24 v17, 9, v16
v_sub_u32 v17, v15, v17
v_lshlrev_b32 v17, 7, v17
s_movk_i32 s25, 9792
v_cmp_gt_u32 vcc, s25, v15
v_mov_b32 v19, 0x100000
v_cndmask_b32 v16, v19, v16, vcc
s_and_b32 s25, s2, 7
s_mul_i32 s25, s25, 30
s_mul_i32 s26, s25, 1366
s_lshr_b32 s26, s26, 16
s_mov_b32 s27, s26
s_lshl_b32 s25, s26, 10
s_min_u32 s26, s26, 1
s_lshl_b32 s26, s26, 6
s_add_u32 s25, s25, s26
v_add_u32 v18, s25, v16
v_mul_u32_u24 v18, 1152, v18
v_add_u32 v18, v18, v17
v_subrev_u32 v19, 663552, v18
buffer_load_dword v188, v18, s[48:51], 0 offen
buffer_load_dword v189, v19, s[52:55], 0 offen
s_and_b32 s25, s2, 7
s_mul_i32 s25, s25, 30
s_add_u32 s25, s25, 29
s_min_u32 s25, s25, 239
s_mul_i32 s26, s25, 1366
s_lshr_b32 s26, s26, 16
s_cmp_eq_u32 s26, s27
s_cbranch_scc1 at_pfskip
s_lshl_b32 s25, s26, 10
s_min_u32 s26, s26, 1
s_lshl_b32 s26, s26, 6
s_add_u32 s25, s25, s26
v_add_u32 v18, s25, v16
v_mul_u32_u24 v18, 1152, v18
v_add_u32 v18, v18, v17
v_subrev_u32 v19, 663552, v18
buffer_load_dword v188, v18, s[48:51], 0 offen
buffer_load_dword v189, v19, s[52:55], 0 offen
at_pfskip:
v_lshrrev_b32 v16, 10, v15
s_and_b32 s25, s2, 7
s_mul_i32 s25, s25, 10
v_add_u32 v16, s25, v16
v_lshrrev_b32 v17, 4, v16
v_and_b32 v16, 15, v16
v_bfe_u32 v18, v15, 3, 7
v_lshl_add_u32 v18, v16, 7, v18
s_movk_i32 s25, 10368
v_mul_lo_u32 v18, v18, s25
v_lshlrev_b32 v19, 4, v17
v_add_u32 v19, 1, v19
v_cmp_eq_u32 vcc, 0, v17
v_cndmask_b32 v19, v19, 9, vcc
v_and_b32 v16, 7, v15
v_add_u32 v19, v19, v16
v_lshl_add_u32 v18, v19, 7, v18
s_movk_i32 s25, 10240
v_cmp_gt_u32 vcc, s25, v15
v_mov_b32 v19, 0x7fffff00
v_cndmask_b32 v18, v19, v18, vcc
buffer_load_dword v190, v18, s[44:47], 0 offen
v_cmp_eq_u32 vcc, 0, v4
v_mov_b32 v14, 0xff800000
ds_read_b128 v[48:51], v10 offset:0
ds_read_b64 v[52:53], v11 offset:0
ds_read_b128 v[56:59], v10 offset:512
ds_read_b64 v[60:61], v11 offset:256
s_waitcnt lgkmcnt(2)
v_mfma_f32_32x32x16_bf16 v[64:79], v[48:51], v[40:43], 0
v_add_u32 v149, 0, v0
v_lshrrev_b32 v150, 4, v149
v_mul_u32_u24 v150, 608, v150
v_mfma_f32_32x32x8_bf16 v[64:79], v[52:53], v[44:45], v[64:79]
v_bfe_u32 v151, v149, 2, 1
v_mul_u32_u24 v151, 304, v151
v_add_u32 v150, v150, v151
ds_read_b128 v[48:51], v10 offset:1024
ds_read_b64 v[52:53], v11 offset:512
s_waitcnt lgkmcnt(2)
v_mfma_f32_32x32x16_bf16 v[80:95], v[56:59], v[40:43], 0
v_max3_f32 v14, v14, v64, v65
v_max3_f32 v14, v14, v66, v67
v_max3_f32 v14, v14, v68, v69
v_max3_f32 v14, v14, v70, v71
v_bfe_u32 v151, v149, 3, 1
v_and_b32 v149, 3, v149
v_lshl_add_u32 v149, v151, 2, v149
v_mfma_f32_32x32x8_bf16 v[80:95], v[60:61], v[44:45], v[80:95]
v_max3_f32 v14, v14, v72, v73
v_max3_f32 v14, v14, v74, v75
v_max3_f32 v14, v14, v76, v77
v_max3_f32 v14, v14, v78, v79
v_lshl_add_u32 v150, v149, 1, v150
v_add_u32 v150, 81920, v150
v_mov_b32 v149, 0x3f80
ds_read_b128 v[56:59], v10 offset:1536
ds_read_b64 v[60:61], v11 offset:768
s_waitcnt lgkmcnt(2)
v_mfma_f32_32x32x16_bf16 v[64:79], v[48:51], v[40:43], 0
v_max3_f32 v14, v14, v80, v81
v_max3_f32 v14, v14, v82, v83
v_max3_f32 v14, v14, v84, v85
v_max3_f32 v14, v14, v86, v87
ds_write_b16 v150, v140 offset:0
ds_write_b16_d16_hi v150, v140 offset:16
ds_write_b16 v150, v141 offset:32
v_mfma_f32_32x32x8_bf16 v[64:79], v[52:53], v[44:45], v[64:79]
v_max3_f32 v14, v14, v88, v89
v_max3_f32 v14, v14, v90, v91
v_max3_f32 v14, v14, v92, v93
v_max3_f32 v14, v14, v94, v95
ds_write_b16_d16_hi v150, v141 offset:48
ds_write_b16 v150, v142 offset:64
ds_write_b16_d16_hi v150, v142 offset:80
ds_read_b128 v[48:51], v10 offset:2048
ds_read_b64 v[52:53], v11 offset:1024
s_waitcnt lgkmcnt(2)
v_mfma_f32_32x32x16_bf16 v[80:95], v[56:59], v[40:43], 0
v_max3_f32 v14, v14, v64, v65
v_max3_f32 v14, v14, v66, v67
v_max3_f32 v14, v14, v68, v69
v_max3_f32 v14, v14, v70, v71
ds_write_b16 v150, v143 offset:96
ds_write_b16_d16_hi v150, v143 offset:112
ds_write_b16 v150, v144 offset:128
v_mfma_f32_32x32x8_bf16 v[80:95], v[60:61], v[44:45], v[80:95]
v_max3_f32 v14, v14, v72, v73
v_max3_f32 v14, v14, v74, v75
v_max3_f32 v14, v14, v76, v77
v_max3_f32 v14, v14, v78, v79
ds_write_b16_d16_hi v150, v144 offset:144
ds_write_b16 v150, v145 offset:160
ds_write_b16_d16_hi v150, v145 offset:176
ds_read_b128 v[56:59], v10 offset:2560
ds_read_b64 v[60:61], v11 offset:1280
s_waitcnt lgkmcnt(2)
v_mfma_f32_32x32x16_bf16 v[64:79], v[48:51], v[40:43], 0
v_max3_f32 v14, v14, v80, v81
v_max3_f32 v14, v14, v82, v83
v_max3_f32 v14, v14, v84, v85
v_max3_f32 v14, v14, v86, v87
ds_write_b16 v150, v146 offset:192
ds_write_b16_d16_hi v150, v146 offset:208
ds_write_b16 v150, v147 offset:224
v_mfma_f32_32x32x8_bf16 v[64:79], v[52:53], v[44:45], v[64:79]
v_max3_f32 v14, v14, v88, v89
v_max3_f32 v14, v14, v90, v91
v_max3_f32 v14, v14, v92, v93
v_max3_f32 v14, v14, v94, v95
ds_write_b16_d16_hi v150, v147 offset:240
ds_write_b16 v150, v148 offset:256
ds_write_b16_d16_hi v150, v148 offset:272
ds_read_b128 v[48:51], v10 offset:3072
ds_read_b64 v[52:53], v11 offset:1536
s_waitcnt lgkmcnt(2)
v_mfma_f32_32x32x16_bf16 v[80:95], v[56:59], v[40:43], 0
v_max3_f32 v14, v14, v64, v65
v_max3_f32 v14, v14, v66, v67
v_max3_f32 v14, v14, v68, v69
v_max3_f32 v14, v14, v70, v71
ds_write_b16 v150, v149 offset:288
v_add_u32 v161, 512, v0
v_lshrrev_b32 v162, 4, v161
v_mfma_f32_32x32x8_bf16 v[80:95], v[60:61], v[44:45], v[80:95]
v_max3_f32 v14, v14, v72, v73
v_max3_f32 v14, v14, v74, v75
v_max3_f32 v14, v14, v76, v77
v_max3_f32 v14, v14, v78, v79
v_mul_u32_u24 v162, 608, v162
v_bfe_u32 v163, v161, 2, 1
v_mul_u32_u24 v163, 304, v163
ds_read_b128 v[56:59], v10 offset:3584
ds_read_b64 v[60:61], v11 offset:1792
s_waitcnt lgkmcnt(2)
v_mfma_f32_32x32x16_bf16 v[64:79], v[48:51], v[40:43], 0
v_max3_f32 v14, v14, v80, v81
v_max3_f32 v14, v14, v82, v83
v_max3_f32 v14, v14, v84, v85
v_max3_f32 v14, v14, v86, v87
v_add_u32 v162, v162, v163
v_bfe_u32 v163, v161, 3, 1
v_and_b32 v161, 3, v161
v_mfma_f32_32x32x8_bf16 v[64:79], v[52:53], v[44:45], v[64:79]
v_max3_f32 v14, v14, v88, v89
v_max3_f32 v14, v14, v90, v91
v_max3_f32 v14, v14, v92, v93
v_max3_f32 v14, v14, v94, v95
v_lshl_add_u32 v161, v163, 2, v161
v_lshl_add_u32 v162, v161, 1, v162
v_add_u32 v162, 81920, v162
ds_read_b128 v[48:51], v10 offset:4096
ds_read_b64 v[52:53], v11 offset:2048
s_waitcnt lgkmcnt(2)
v_mfma_f32_32x32x16_bf16 v[80:95], v[56:59], v[40:43], 0
v_max3_f32 v14, v14, v64, v65
v_max3_f32 v14, v14, v66, v67
v_max3_f32 v14, v14, v68, v69
v_max3_f32 v14, v14, v70, v71
v_mov_b32 v161, 0x3f80
ds_write_b16 v162, v152 offset:0
ds_write_b16_d16_hi v162, v152 offset:16
v_mfma_f32_32x32x8_bf16 v[80:95], v[60:61], v[44:45], v[80:95]
v_max3_f32 v14, v14, v72, v73
v_max3_f32 v14, v14, v74, v75
v_max3_f32 v14, v14, v76, v77
v_max3_f32 v14, v14, v78, v79
ds_write_b16 v162, v153 offset:32
ds_write_b16_d16_hi v162, v153 offset:48
ds_write_b16 v162, v154 offset:64
ds_read_b128 v[56:59], v10 offset:4608
ds_read_b64 v[60:61], v11 offset:2304
s_waitcnt lgkmcnt(2)
v_mfma_f32_32x32x16_bf16 v[64:79], v[48:51], v[40:43], 0
v_max3_f32 v14, v14, v80, v81
v_max3_f32 v14, v14, v82, v83
v_max3_f32 v14, v14, v84, v85
v_max3_f32 v14, v14, v86, v87
ds_write_b16_d16_hi v162, v154 offset:80
ds_write_b16 v162, v155 offset:96
ds_write_b16_d16_hi v162, v155 offset:112
v_mfma_f32_32x32x8_bf16 v[64:79], v[52:53], v[44:45], v[64:79]
v_max3_f32 v14, v14, v88, v89
v_max3_f32 v14, v14, v90, v91
v_max3_f32 v14, v14, v92, v93
v_max3_f32 v14, v14, v94, v95
ds_write_b16 v162, v156 offset:128
ds_write_b16_d16_hi v162, v156 offset:144
ds_write_b16 v162, v157 offset:160
ds_read_b128 v[48:51], v10 offset:5120
ds_read_b64 v[52:53], v11 offset:2560
s_waitcnt lgkmcnt(2)
v_mfma_f32_32x32x16_bf16 v[80:95], v[56:59], v[40:43], 0
v_max3_f32 v14, v14, v64, v65
v_max3_f32 v14, v14, v66, v67
v_max3_f32 v14, v14, v68, v69
v_max3_f32 v14, v14, v70, v71
ds_write_b16_d16_hi v162, v157 offset:176
ds_write_b16 v162, v158 offset:192
ds_write_b16_d16_hi v162, v158 offset:208
v_mfma_f32_32x32x8_bf16 v[80:95], v[60:61], v[44:45], v[80:95]
v_max3_f32 v14, v14, v72, v73
v_max3_f32 v14, v14, v74, v75
v_max3_f32 v14, v14, v76, v77
v_max3_f32 v14, v14, v78, v79
ds_write_b16 v162, v159 offset:224
ds_write_b16_d16_hi v162, v159 offset:240
ds_write_b16 v162, v160 offset:256
ds_read_b128 v[56:59], v10 offset:5632
ds_read_b64 v[60:61], v11 offset:2816
s_waitcnt lgkmcnt(2)
v_mfma_f32_32x32x16_bf16 v[64:79], v[48:51], v[40:43], 0
v_max3_f32 v14, v14, v80, v81
v_max3_f32 v14, v14, v82, v83
v_max3_f32 v14, v14, v84, v85
v_max3_f32 v14, v14, v86, v87
ds_write_b16_d16_hi v162, v160 offset:272
ds_write_b16 v162, v161 offset:288
v_add_u32 v173, 1024, v0
v_mfma_f32_32x32x8_bf16 v[64:79], v[52:53], v[44:45], v[64:79]
v_max3_f32 v14, v14, v88, v89
v_max3_f32 v14, v14, v90, v91
v_max3_f32 v14, v14, v92, v93
v_max3_f32 v14, v14, v94, v95
v_lshrrev_b32 v174, 4, v173
v_mul_u32_u24 v174, 608, v174
v_bfe_u32 v175, v173, 2, 1
ds_read_b128 v[48:51], v10 offset:6144
ds_read_b64 v[52:53], v11 offset:3072
s_waitcnt lgkmcnt(2)
v_mfma_f32_32x32x16_bf16 v[80:95], v[56:59], v[40:43], 0
v_max3_f32 v14, v14, v64, v65
v_max3_f32 v14, v14, v66, v67
v_max3_f32 v14, v14, v68, v69
v_max3_f32 v14, v14, v70, v71
v_mul_u32_u24 v175, 304, v175
v_add_u32 v174, v174, v175
v_bfe_u32 v175, v173, 3, 1
v_mfma_f32_32x32x8_bf16 v[80:95], v[60:61], v[44:45], v[80:95]
v_max3_f32 v14, v14, v72, v73
v_max3_f32 v14, v14, v74, v75
v_max3_f32 v14, v14, v76, v77
v_max3_f32 v14, v14, v78, v79
v_and_b32 v173, 3, v173
v_lshl_add_u32 v173, v175, 2, v173
v_lshl_add_u32 v174, v173, 1, v174
ds_read_b128 v[56:59], v10 offset:6656
ds_read_b64 v[60:61], v11 offset:3328
s_waitcnt lgkmcnt(2)
v_mfma_f32_32x32x16_bf16 v[64:79], v[48:51], v[40:43], 0
v_max3_f32 v14, v14, v80, v81
v_max3_f32 v14, v14, v82, v83
v_max3_f32 v14, v14, v84, v85
v_max3_f32 v14, v14, v86, v87
v_add_u32 v174, 81920, v174
v_mov_b32 v173, 0x3f80
ds_write_b16 v174, v164 offset:0
v_mfma_f32_32x32x8_bf16 v[64:79], v[52:53], v[44:45], v[64:79]
v_max3_f32 v14, v14, v88, v89
v_max3_f32 v14, v14, v90, v91
v_max3_f32 v14, v14, v92, v93
v_max3_f32 v14, v14, v94, v95
ds_write_b16_d16_hi v174, v164 offset:16
ds_write_b16 v174, v165 offset:32
ds_write_b16_d16_hi v174, v165 offset:48
ds_read_b128 v[48:51], v10 offset:7168
ds_read_b64 v[52:53], v11 offset:3584
s_waitcnt lgkmcnt(2)
v_mfma_f32_32x32x16_bf16 v[80:95], v[56:59], v[40:43], 0
v_max3_f32 v14, v14, v64, v65
v_max3_f32 v14, v14, v66, v67
v_max3_f32 v14, v14, v68, v69
v_max3_f32 v14, v14, v70, v71
ds_write_b16 v174, v166 offset:64
ds_write_b16_d16_hi v174, v166 offset:80
ds_write_b16 v174, v167 offset:96
v_mfma_f32_32x32x8_bf16 v[80:95], v[60:61], v[44:45], v[80:95]
v_max3_f32 v14, v14, v72, v73
v_max3_f32 v14, v14, v74, v75
v_max3_f32 v14, v14, v76, v77
v_max3_f32 v14, v14, v78, v79
ds_write_b16_d16_hi v174, v167 offset:112
ds_write_b16 v174, v168 offset:128
ds_write_b16_d16_hi v174, v168 offset:144
ds_read_b128 v[56:59], v10 offset:7680
ds_read_b64 v[60:61], v11 offset:3840
s_waitcnt lgkmcnt(2)
v_mfma_f32_32x32x16_bf16 v[64:79], v[48:51], v[40:43], 0
v_max3_f32 v14, v14, v80, v81
v_max3_f32 v14, v14, v82, v83
v_max3_f32 v14, v14, v84, v85
v_max3_f32 v14, v14, v86, v87
ds_write_b16 v174, v169 offset:160
ds_write_b16_d16_hi v174, v169 offset:176
ds_write_b16 v174, v170 offset:192
v_mfma_f32_32x32x8_bf16 v[64:79], v[52:53], v[44:45], v[64:79]
v_max3_f32 v14, v14, v88, v89
v_max3_f32 v14, v14, v90, v91
v_max3_f32 v14, v14, v92, v93
v_max3_f32 v14, v14, v94, v95
ds_write_b16_d16_hi v174, v170 offset:208
ds_write_b16 v174, v171 offset:224
ds_write_b16_d16_hi v174, v171 offset:240
ds_read_b128 v[48:51], v10 offset:8192
ds_read_b64 v[52:53], v11 offset:4096
s_waitcnt lgkmcnt(2)
v_mfma_f32_32x32x16_bf16 v[80:95], v[56:59], v[40:43], 0
v_max3_f32 v14, v14, v64, v65
v_max3_f32 v14, v14, v66, v67
v_max3_f32 v14, v14, v68, v69
v_max3_f32 v14, v14, v70, v71
ds_write_b16 v174, v172 offset:256
ds_write_b16_d16_hi v174, v172 offset:272
ds_write_b16 v174, v173 offset:288
v_mfma_f32_32x32x8_bf16 v[80:95], v[60:61], v[44:45], v[80:95]
v_max3_f32 v14, v14, v72, v73
v_max3_f32 v14, v14, v74, v75
v_max3_f32 v14, v14, v76, v77
v_max3_f32 v14, v14, v78, v79
v_add_u32 v185, 1536, v0
v_lshrrev_b32 v186, 4, v185
v_mul_u32_u24 v186, 608, v186
ds_read_b128 v[56:59], v10 offset:8704
ds_read_b64 v[60:61], v11 offset:4352
s_waitcnt lgkmcnt(2)
v_mfma_f32_32x32x16_bf16 v[64:79], v[48:51], v[40:43], 0
v_max3_f32 v14, v14, v80, v81
v_max3_f32 v14, v14, v82, v83
v_max3_f32 v14, v14, v84, v85
v_max3_f32 v14, v14, v86, v87
v_bfe_u32 v187, v185, 2, 1
v_mul_u32_u24 v187, 304, v187
v_add_u32 v186, v186, v187
v_mfma_f32_32x32x8_bf16 v[64:79], v[52:53], v[44:45], v[64:79]
v_max3_f32 v14, v14, v88, v89
v_max3_f32 v14, v14, v90, v91
v_max3_f32 v14, v14, v92, v93
v_max3_f32 v14, v14, v94, v95
v_bfe_u32 v187, v185, 3, 1
v_and_b32 v185, 3, v185
v_lshl_add_u32 v185, v187, 2, v185
ds_read_b128 v[48:51], v10 offset:9216
ds_read_b64 v[52:53], v11 offset:4608
s_waitcnt lgkmcnt(2)
v_mfma_f32_32x32x16_bf16 v[80:95], v[56:59], v[40:43], 0
v_max3_f32 v14, v14, v64, v65
v_max3_f32 v14, v14, v66, v67
v_max3_f32 v14, v14, v68, v69
v_max3_f32 v14, v14, v70, v71
v_lshl_add_u32 v186, v185, 1, v186
v_add_u32 v186, 81920, v186
v_mov_b32 v185, 0x3f80
v_mfma_f32_32x32x8_bf16 v[80:95], v[60:61], v[44:45], v[80:95]
v_max3_f32 v14, v14, v72, v73
v_max3_f32 v14, v14, v74, v75
v_max3_f32 v14, v14, v76, v77
v_max3_f32 v14, v14, v78, v79
ds_write_b16 v186, v176 offset:0
ds_write_b16_d16_hi v186, v176 offset:16
ds_write_b16 v186, v177 offset:32
ds_read_b128 v[56:59], v10 offset:9728
ds_read_b64 v[60:61], v11 offset:4864
s_waitcnt lgkmcnt(2)
v_mfma_f32_32x32x16_bf16 v[64:79], v[48:51], v[40:43], 0
v_max3_f32 v14, v14, v80, v81
v_max3_f32 v14, v14, v82, v83
v_max3_f32 v14, v14, v84, v85
v_max3_f32 v14, v14, v86, v87
ds_write_b16_d16_hi v186, v177 offset:48
ds_write_b16 v186, v178 offset:64
ds_write_b16_d16_hi v186, v178 offset:80
v_mfma_f32_32x32x8_bf16 v[64:79], v[52:53], v[44:45], v[64:79]
v_max3_f32 v14, v14, v88, v89
v_max3_f32 v14, v14, v90, v91
v_max3_f32 v14, v14, v92, v93
v_max3_f32 v14, v14, v94, v95
ds_write_b16 v186, v179 offset:96
ds_write_b16_d16_hi v186, v179 offset:112
ds_write_b16 v186, v180 offset:128
ds_read_b128 v[48:51], v10 offset:10240
ds_read_b64 v[52:53], v11 offset:5120
s_waitcnt lgkmcnt(2)
v_mfma_f32_32x32x16_bf16 v[80:95], v[56:59], v[40:43], 0
v_max3_f32 v14, v14, v64, v65
v_max3_f32 v14, v14, v66, v67
v_max3_f32 v14, v14, v68, v69
v_max3_f32 v14, v14, v70, v71
ds_write_b16_d16_hi v186, v180 offset:144
ds_write_b16 v186, v181 offset:160
ds_write_b16_d16_hi v186, v181 offset:176
v_mfma_f32_32x32x8_bf16 v[80:95], v[60:61], v[44:45], v[80:95]
v_max3_f32 v14, v14, v72, v73
v_max3_f32 v14, v14, v74, v75
v_max3_f32 v14, v14, v76, v77
v_max3_f32 v14, v14, v78, v79
ds_write_b16 v186, v182 offset:192
ds_write_b16_d16_hi v186, v182 offset:208
ds_write_b16 v186, v183 offset:224
ds_read_b128 v[56:59], v10 offset:10752
ds_read_b64 v[60:61], v11 offset:5376
s_waitcnt lgkmcnt(2)
v_mfma_f32_32x32x16_bf16 v[64:79], v[48:51], v[40:43], 0
v_max3_f32 v14, v14, v80, v81
v_max3_f32 v14, v14, v82, v83
v_max3_f32 v14, v14, v84, v85
v_max3_f32 v14, v14, v86, v87
ds_write_b16_d16_hi v186, v183 offset:240
ds_write_b16 v186, v184 offset:256
ds_write_b16_d16_hi v186, v184 offset:272
v_mfma_f32_32x32x8_bf16 v[64:79], v[52:53], v[44:45], v[64:79]
v_max3_f32 v14, v14, v88, v89
v_max3_f32 v14, v14, v90, v91
v_max3_f32 v14, v14, v92, v93
v_max3_f32 v14, v14, v94, v95
ds_write_b16 v186, v185 offset:288
ds_read_b128 v[48:51], v10 offset:11264
ds_read_b64 v[52:53], v11 offset:5632
s_waitcnt lgkmcnt(2)
v_mfma_f32_32x32x16_bf16 v[80:95], v[56:59], v[40:43], 0
v_max3_f32 v14, v14, v64, v65
v_max3_f32 v14, v14, v66, v67
v_max3_f32 v14, v14, v68, v69
v_max3_f32 v14, v14, v70, v71
v_mfma_f32_32x32x8_bf16 v[80:95], v[60:61], v[44:45], v[80:95]
v_max3_f32 v14, v14, v72, v73
v_max3_f32 v14, v14, v74, v75
v_max3_f32 v14, v14, v76, v77
v_max3_f32 v14, v14, v78, v79
ds_read_b128 v[56:59], v10 offset:11776
ds_read_b64 v[60:61], v11 offset:5888
s_waitcnt lgkmcnt(2)
v_mfma_f32_32x32x16_bf16 v[64:79], v[48:51], v[40:43], 0
v_max3_f32 v14, v14, v80, v81
v_max3_f32 v14, v14, v82, v83
v_max3_f32 v14, v14, v84, v85
v_max3_f32 v14, v14, v86, v87
v_mfma_f32_32x32x8_bf16 v[64:79], v[52:53], v[44:45], v[64:79]
v_max3_f32 v14, v14, v88, v89
v_max3_f32 v14, v14, v90, v91
v_max3_f32 v14, v14, v92, v93
v_max3_f32 v14, v14, v94, v95
ds_read_b128 v[48:51], v10 offset:12288
ds_read_b64 v[52:53], v11 offset:6144
s_waitcnt lgkmcnt(2)
v_mfma_f32_32x32x16_bf16 v[80:95], v[56:59], v[40:43], 0
v_max3_f32 v14, v14, v64, v65
v_max3_f32 v14, v14, v66, v67
v_max3_f32 v14, v14, v68, v69
v_max3_f32 v14, v14, v70, v71
v_mfma_f32_32x32x8_bf16 v[80:95], v[60:61], v[44:45], v[80:95]
v_max3_f32 v14, v14, v72, v73
v_max3_f32 v14, v14, v74, v75
v_max3_f32 v14, v14, v76, v77
v_max3_f32 v14, v14, v78, v79
ds_read_b128 v[56:59], v10 offset:12800
ds_read_b64 v[60:61], v11 offset:6400
s_waitcnt lgkmcnt(2)
v_mfma_f32_32x32x16_bf16 v[64:79], v[48:51], v[40:43], 0
v_max3_f32 v14, v14, v80, v81
v_max3_f32 v14, v14, v82, v83
v_max3_f32 v14, v14, v84, v85
v_max3_f32 v14, v14, v86, v87
v_mfma_f32_32x32x8_bf16 v[64:79], v[52:53], v[44:45], v[64:79]
v_max3_f32 v14, v14, v88, v89
v_max3_f32 v14, v14, v90, v91
v_max3_f32 v14, v14, v92, v93
v_max3_f32 v14, v14, v94, v95
ds_read_b128 v[48:51], v10 offset:13312
ds_read_b64 v[52:53], v11 offset:6656
s_waitcnt lgkmcnt(2)
v_mfma_f32_32x32x16_bf16 v[80:95], v[56:59], v[40:43], 0
v_max3_f32 v14, v14, v64, v65
v_max3_f32 v14, v14, v66, v67
v_max3_f32 v14, v14, v68, v69
v_max3_f32 v14, v14, v70, v71
v_mfma_f32_32x32x8_bf16 v[80:95], v[60:61], v[44:45], v[80:95]
v_max3_f32 v14, v14, v72, v73
v_max3_f32 v14, v14, v74, v75
v_max3_f32 v14, v14, v76, v77
v_max3_f32 v14, v14, v78, v79
ds_read_b128 v[56:59], v10 offset:13824
ds_read_b64 v[60:61], v11 offset:6912
s_waitcnt lgkmcnt(2)
v_mfma_f32_32x32x16_bf16 v[64:79], v[48:51], v[40:43], 0
v_max3_f32 v14, v14, v80, v81
v_max3_f32 v14, v14, v82, v83
v_max3_f32 v14, v14, v84, v85
v_max3_f32 v14, v14, v86, v87
v_mfma_f32_32x32x8_bf16 v[64:79], v[52:53], v[44:45], v[64:79]
v_max3_f32 v14, v14, v88, v89
v_max3_f32 v14, v14, v90, v91
v_max3_f32 v14, v14, v92, v93
v_max3_f32 v14, v14, v94, v95
ds_read_b128 v[48:51], v10 offset:14336
ds_read_b64 v[52:53], v11 offset:7168
s_waitcnt lgkmcnt(2)
v_mfma_f32_32x32x16_bf16 v[80:95], v[56:59], v[40:43], 0
v_max3_f32 v14, v14, v64, v65
v_max3_f32 v14, v14, v66, v67
v_max3_f32 v14, v14, v68, v69
v_max3_f32 v14, v14, v70, v71
v_mfma_f32_32x32x8_bf16 v[80:95], v[60:61], v[44:45], v[80:95]
v_max3_f32 v14, v14, v72, v73
v_max3_f32 v14, v14, v74, v75
v_max3_f32 v14, v14, v76, v77
v_max3_f32 v14, v14, v78, v79
ds_read_b128 v[56:59], v10 offset:14848
ds_read_b64 v[60:61], v11 offset:7424
s_waitcnt lgkmcnt(2)
v_mfma_f32_32x32x16_bf16 v[64:79], v[48:51], v[40:43], 0
v_max3_f32 v14, v14, v80, v81
v_max3_f32 v14, v14, v82, v83
v_max3_f32 v14, v14, v84, v85
v_max3_f32 v14, v14, v86, v87
v_mfma_f32_32x32x8_bf16 v[64:79], v[52:53], v[44:45], v[64:79]
v_max3_f32 v14, v14, v88, v89
v_max3_f32 v14, v14, v90, v91
v_max3_f32 v14, v14, v92, v93
v_max3_f32 v14, v14, v94, v95
ds_read_b128 v[48:51], v10 offset:15360
ds_read_b64 v[52:53], v11 offset:7680
s_waitcnt lgkmcnt(2)
v_mfma_f32_32x32x16_bf16 v[80:95], v[56:59], v[40:43], 0
v_max3_f32 v14, v14, v64, v65
v_max3_f32 v14, v14, v66, v67
v_max3_f32 v14, v14, v68, v69
v_max3_f32 v14, v14, v70, v71
v_mfma_f32_32x32x8_bf16 v[80:95], v[60:61], v[44:45], v[80:95]
v_max3_f32 v14, v14, v72, v73
v_max3_f32 v14, v14, v74, v75
v_max3_f32 v14, v14, v76, v77
v_max3_f32 v14, v14, v78, v79
ds_read_b128 v[56:59], v10 offset:15872
ds_read_b64 v[60:61], v11 offset:7936
s_waitcnt lgkmcnt(2)
v_mfma_f32_32x32x16_bf16 v[64:79], v[48:51], v[40:43], 0
v_max3_f32 v14, v14, v80, v81
v_max3_f32 v14, v14, v82, v83
v_max3_f32 v14, v14, v84, v85
v_max3_f32 v14, v14, v86, v87
v_mfma_f32_32x32x8_bf16 v[64:79], v[52:53], v[44:45], v[64:79]
v_max3_f32 v14, v14, v88, v89
v_max3_f32 v14, v14, v90, v91
v_max3_f32 v14, v14, v92, v93
v_max3_f32 v14, v14, v94, v95
ds_read_b128 v[48:51], v10 offset:16384
ds_read_b64 v[52:53], v11 offset:8192
s_waitcnt lgkmcnt(2)
v_mfma_f32_32x32x16_bf16 v[80:95], v[56:59], v[40:43], 0
v_max3_f32 v14, v14, v64, v65
v_max3_f32 v14, v14, v66, v67
v_max3_f32 v14, v14, v68, v69
v_max3_f32 v14, v14, v70, v71
v_mfma_f32_32x32x8_bf16 v[80:95], v[60:61], v[44:45], v[80:95]
v_max3_f32 v14, v14, v72, v73
v_max3_f32 v14, v14, v74, v75
v_max3_f32 v14, v14, v76, v77
v_max3_f32 v14, v14, v78, v79
s_waitcnt lgkmcnt(0)
s_barrier
ds_read_b128 v[56:59], v10 offset:16896
ds_read_b64 v[60:61], v11 offset:8448
s_waitcnt lgkmcnt(2)
v_mfma_f32_32x32x16_bf16 v[64:79], v[48:51], v[40:43], 0
v_max3_f32 v14, v14, v80, v81
v_max3_f32 v14, v14, v82, v83
v_max3_f32 v14, v14, v84, v85
v_max3_f32 v14, v14, v86, v87
v_mfma_f32_32x32x8_bf16 v[64:79], v[52:53], v[44:45], v[64:79]
v_max3_f32 v14, v14, v88, v89
v_max3_f32 v14, v14, v90, v91
v_max3_f32 v14, v14, v92, v93
v_max3_f32 v14, v14, v94, v95
ds_read_b128 v[48:51], v10 offset:17408
ds_read_b64 v[52:53], v11 offset:8704
s_waitcnt lgkmcnt(2)
v_mfma_f32_32x32x16_bf16 v[80:95], v[56:59], v[40:43], 0
v_max3_f32 v14, v14, v64, v65
v_max3_f32 v14, v14, v66, v67
v_max3_f32 v14, v14, v68, v69
v_max3_f32 v14, v14, v70, v71
v_mfma_f32_32x32x8_bf16 v[80:95], v[60:61], v[44:45], v[80:95]
v_max3_f32 v14, v14, v72, v73
v_max3_f32 v14, v14, v74, v75
v_max3_f32 v14, v14, v76, v77
v_max3_f32 v14, v14, v78, v79
ds_read_b128 v[56:59], v10 offset:17920
ds_read_b64 v[60:61], v11 offset:8960
s_waitcnt lgkmcnt(2)
v_mfma_f32_32x32x16_bf16 v[64:79], v[48:51], v[40:43], 0
v_max3_f32 v14, v14, v80, v81
v_max3_f32 v14, v14, v82, v83
v_max3_f32 v14, v14, v84, v85
v_max3_f32 v14, v14, v86, v87
v_mfma_f32_32x32x8_bf16 v[64:79], v[52:53], v[44:45], v[64:79]
v_max3_f32 v14, v14, v88, v89
v_max3_f32 v14, v14, v90, v91
v_max3_f32 v14, v14, v92, v93
v_max3_f32 v14, v14, v94, v95
ds_read_b128 v[48:51], v10 offset:18432
ds_read_b64 v[52:53], v11 offset:9216
s_waitcnt lgkmcnt(2)
v_mfma_f32_32x32x16_bf16 v[80:95], v[56:59], v[40:43], 0
v_max3_f32 v14, v14, v64, v65
v_max3_f32 v14, v14, v66, v67
v_max3_f32 v14, v14, v68, v69
v_max3_f32 v14, v14, v70, v71
v_mfma_f32_32x32x8_bf16 v[80:95], v[60:61], v[44:45], v[80:95]
v_max3_f32 v14, v14, v72, v73
v_max3_f32 v14, v14, v74, v75
v_max3_f32 v14, v14, v76, v77
v_max3_f32 v14, v14, v78, v79
ds_read_b128 v[56:59], v10 offset:18944
ds_read_b64 v[60:61], v11 offset:9472
s_waitcnt lgkmcnt(2)
v_mfma_f32_32x32x16_bf16 v[64:79], v[48:51], v[40:43], 0
v_max3_f32 v14, v14, v80, v81
v_max3_f32 v14, v14, v82, v83
v_max3_f32 v14, v14, v84, v85
v_max3_f32 v14, v14, v86, v87
v_mfma_f32_32x32x8_bf16 v[64:79], v[52:53], v[44:45], v[64:79]
v_max3_f32 v14, v14, v88, v89
v_max3_f32 v14, v14, v90, v91
v_max3_f32 v14, v14, v92, v93
v_max3_f32 v14, v14, v94, v95
ds_read_b128 v[48:51], v10 offset:19456
ds_read_b64 v[52:53], v11 offset:9728
s_waitcnt lgkmcnt(2)
v_mfma_f32_32x32x16_bf16 v[80:95], v[56:59], v[40:43], 0
v_max3_f32 v14, v14, v64, v65
v_max3_f32 v14, v14, v66, v67
v_max3_f32 v14, v14, v68, v69
v_max3_f32 v14, v14, v70, v71
v_mfma_f32_32x32x8_bf16 v[80:95], v[60:61], v[44:45], v[80:95]
v_max3_f32 v14, v14, v72, v73
v_max3_f32 v14, v14, v74, v75
v_max3_f32 v14, v14, v76, v77
v_max3_f32 v14, v14, v78, v79
ds_read_b128 v[56:59], v10 offset:19968
ds_read_b64 v[60:61], v11 offset:9984
s_waitcnt lgkmcnt(2)
v_mfma_f32_32x32x16_bf16 v[64:79], v[48:51], v[40:43], 0
v_max3_f32 v14, v14, v80, v81
v_max3_f32 v14, v14, v82, v83
v_max3_f32 v14, v14, v84, v85
v_max3_f32 v14, v14, v86, v87
v_mfma_f32_32x32x8_bf16 v[64:79], v[52:53], v[44:45], v[64:79]
v_max3_f32 v14, v14, v88, v89
v_max3_f32 v14, v14, v90, v91
v_max3_f32 v14, v14, v92, v93
v_max3_f32 v14, v14, v94, v95
ds_read_b128 v[48:51], v10 offset:20480
ds_read_b64 v[52:53], v11 offset:10240
s_waitcnt lgkmcnt(2)
v_mfma_f32_32x32x16_bf16 v[80:95], v[56:59], v[40:43], 0
v_max3_f32 v14, v14, v64, v65
v_max3_f32 v14, v14, v66, v67
v_max3_f32 v14, v14, v68, v69
v_max3_f32 v14, v14, v70, v71
v_mfma_f32_32x32x8_bf16 v[80:95], v[60:61], v[44:45], v[80:95]
v_max3_f32 v14, v14, v72, v73
v_max3_f32 v14, v14, v74, v75
v_max3_f32 v14, v14, v76, v77
v_max3_f32 v14, v14, v78, v79
ds_read_b128 v[56:59], v10 offset:20992
ds_read_b64 v[60:61], v11 offset:10496
s_waitcnt lgkmcnt(2)
v_mfma_f32_32x32x16_bf16 v[64:79], v[48:51], v[40:43], 0
v_max3_f32 v14, v14, v80, v81
v_max3_f32 v14, v14, v82, v83
v_max3_f32 v14, v14, v84, v85
v_max3_f32 v14, v14, v86, v87
v_mfma_f32_32x32x8_bf16 v[64:79], v[52:53], v[44:45], v[64:79]
v_max3_f32 v14, v14, v88, v89
v_max3_f32 v14, v14, v90, v91
v_max3_f32 v14, v14, v92, v93
v_max3_f32 v14, v14, v94, v95
ds_read_b128 v[48:51], v10 offset:21504
ds_read_b64 v[52:53], v11 offset:10752
s_waitcnt lgkmcnt(2)
v_mfma_f32_32x32x16_bf16 v[80:95], v[56:59], v[40:43], 0
v_max3_f32 v14, v14, v64, v65
v_max3_f32 v14, v14, v66, v67
v_max3_f32 v14, v14, v68, v69
v_max3_f32 v14, v14, v70, v71
v_mfma_f32_32x32x8_bf16 v[80:95], v[60:61], v[44:45], v[80:95]
v_max3_f32 v14, v14, v72, v73
v_max3_f32 v14, v14, v74, v75
v_max3_f32 v14, v14, v76, v77
v_max3_f32 v14, v14, v78, v79
ds_read_b128 v[56:59], v10 offset:22016
ds_read_b64 v[60:61], v11 offset:11008
s_waitcnt lgkmcnt(2)
v_mfma_f32_32x32x16_bf16 v[64:79], v[48:51], v[40:43], 0
v_max3_f32 v14, v14, v80, v81
v_max3_f32 v14, v14, v82, v83
v_max3_f32 v14, v14, v84, v85
v_max3_f32 v14, v14, v86, v87
v_mfma_f32_32x32x8_bf16 v[64:79], v[52:53], v[44:45], v[64:79]
v_max3_f32 v14, v14, v88, v89
v_max3_f32 v14, v14, v90, v91
v_max3_f32 v14, v14, v92, v93
v_max3_f32 v14, v14, v94, v95
ds_read_b128 v[48:51], v10 offset:22528
ds_read_b64 v[52:53], v11 offset:11264
s_waitcnt lgkmcnt(2)
v_mfma_f32_32x32x16_bf16 v[80:95], v[56:59], v[40:43], 0
v_max3_f32 v14, v14, v64, v65
v_max3_f32 v14, v14, v66, v67
v_max3_f32 v14, v14, v68, v69
v_max3_f32 v14, v14, v70, v71
v_mfma_f32_32x32x8_bf16 v[80:95], v[60:61], v[44:45], v[80:95]
v_max3_f32 v14, v14, v72, v73
v_max3_f32 v14, v14, v74, v75
v_max3_f32 v14, v14, v76, v77
v_max3_f32 v14, v14, v78, v79
ds_read_b128 v[56:59], v10 offset:23040
ds_read_b64 v[60:61], v11 offset:11520
s_waitcnt lgkmcnt(2)
v_mfma_f32_32x32x16_bf16 v[64:79], v[48:51], v[40:43], 0
v_max3_f32 v14, v14, v80, v81
v_max3_f32 v14, v14, v82, v83
v_max3_f32 v14, v14, v84, v85
v_max3_f32 v14, v14, v86, v87
v_mfma_f32_32x32x8_bf16 v[64:79], v[52:53], v[44:45], v[64:79]
v_max3_f32 v14, v14, v88, v89
v_max3_f32 v14, v14, v90, v91
v_max3_f32 v14, v14, v92, v93
v_max3_f32 v14, v14, v94, v95
ds_read_b128 v[48:51], v10 offset:23552
ds_read_b64 v[52:53], v11 offset:11776
s_waitcnt lgkmcnt(2)
v_mfma_f32_32x32x16_bf16 v[80:95], v[56:59], v[40:43], 0
v_max3_f32 v14, v14, v64, v65
v_max3_f32 v14, v14, v66, v67
v_max3_f32 v14, v14, v68, v69
v_max3_f32 v14, v14, v70, v71
v_mfma_f32_32x32x8_bf16 v[80:95], v[60:61], v[44:45], v[80:95]
v_max3_f32 v14, v14, v72, v73
v_max3_f32 v14, v14, v74, v75
v_max3_f32 v14, v14, v76, v77
v_max3_f32 v14, v14, v78, v79
ds_read_b128 v[56:59], v10 offset:24064
ds_read_b64 v[60:61], v11 offset:12032
s_waitcnt lgkmcnt(2)
v_mfma_f32_32x32x16_bf16 v[64:79], v[48:51], v[40:43], 0
v_max3_f32 v14, v14, v80, v81
v_max3_f32 v14, v14, v82, v83
v_max3_f32 v14, v14, v84, v85
v_max3_f32 v14, v14, v86, v87
v_mfma_f32_32x32x8_bf16 v[64:79], v[52:53], v[44:45], v[64:79]
v_max3_f32 v14, v14, v88, v89
v_max3_f32 v14, v14, v90, v91
v_max3_f32 v14, v14, v92, v93
v_max3_f32 v14, v14, v94, v95
ds_read_b128 v[48:51], v10 offset:24576
ds_read_b64 v[52:53], v11 offset:12288
s_waitcnt lgkmcnt(2)
v_mfma_f32_32x32x16_bf16 v[80:95], v[56:59], v[40:43], 0
v_max3_f32 v14, v14, v64, v65
v_max3_f32 v14, v14, v66, v67
v_max3_f32 v14, v14, v68, v69
v_max3_f32 v14, v14, v70, v71
v_mfma_f32_32x32x8_bf16 v[80:95], v[60:61], v[44:45], v[80:95]
v_max3_f32 v14, v14, v72, v73
v_max3_f32 v14, v14, v74, v75
v_max3_f32 v14, v14, v76, v77
v_max3_f32 v14, v14, v78, v79
ds_read_b128 v[56:59], v10 offset:25088
ds_read_b64 v[60:61], v11 offset:12544
s_waitcnt lgkmcnt(2)
v_mfma_f32_32x32x16_bf16 v[64:79], v[48:51], v[40:43], 0
v_max3_f32 v14, v14, v80, v81
v_max3_f32 v14, v14, v82, v83
v_max3_f32 v14, v14, v84, v85
v_max3_f32 v14, v14, v86, v87
v_mfma_f32_32x32x8_bf16 v[64:79], v[52:53], v[44:45], v[64:79]
v_max3_f32 v14, v14, v88, v89
v_max3_f32 v14, v14, v90, v91
v_max3_f32 v14, v14, v92, v93
v_max3_f32 v14, v14, v94, v95
ds_read_b128 v[48:51], v10 offset:25600
ds_read_b64 v[52:53], v11 offset:12800
s_waitcnt lgkmcnt(2)
v_mfma_f32_32x32x16_bf16 v[80:95], v[56:59], v[40:43], 0
v_max3_f32 v14, v14, v64, v65
v_max3_f32 v14, v14, v66, v67
v_max3_f32 v14, v14, v68, v69
v_max3_f32 v14, v14, v70, v71
v_mfma_f32_32x32x8_bf16 v[80:95], v[60:61], v[44:45], v[80:95]
v_max3_f32 v14, v14, v72, v73
v_max3_f32 v14, v14, v74, v75
v_max3_f32 v14, v14, v76, v77
v_max3_f32 v14, v14, v78, v79
ds_read_b128 v[56:59], v10 offset:26112
ds_read_b64 v[60:61], v11 offset:13056
s_waitcnt lgkmcnt(2)
v_mfma_f32_32x32x16_bf16 v[64:79], v[48:51], v[40:43], 0
v_max3_f32 v14, v14, v80, v81
v_max3_f32 v14, v14, v82, v83
v_max3_f32 v14, v14, v84, v85
v_max3_f32 v14, v14, v86, v87
v_mfma_f32_32x32x8_bf16 v[64:79], v[52:53], v[44:45], v[64:79]
v_max3_f32 v14, v14, v88, v89
v_max3_f32 v14, v14, v90, v91
v_max3_f32 v14, v14, v92, v93
v_max3_f32 v14, v14, v94, v95
ds_read_b128 v[48:51], v10 offset:26624
ds_read_b64 v[52:53], v11 offset:13312
s_waitcnt lgkmcnt(2)
v_mfma_f32_32x32x16_bf16 v[80:95], v[56:59], v[40:43], 0
v_max3_f32 v14, v14, v64, v65
v_max3_f32 v14, v14, v66, v67
v_max3_f32 v14, v14, v68, v69
v_max3_f32 v14, v14, v70, v71
v_mfma_f32_32x32x8_bf16 v[80:95], v[60:61], v[44:45], v[80:95]
v_max3_f32 v14, v14, v72, v73
v_max3_f32 v14, v14, v74, v75
v_max3_f32 v14, v14, v76, v77
v_max3_f32 v14, v14, v78, v79
ds_read_b128 v[56:59], v10 offset:27136
ds_read_b64 v[60:61], v11 offset:13568
s_waitcnt lgkmcnt(2)
v_mfma_f32_32x32x16_bf16 v[64:79], v[48:51], v[40:43], 0
v_max3_f32 v14, v14, v80, v81
v_max3_f32 v14, v14, v82, v83
v_max3_f32 v14, v14, v84, v85
v_max3_f32 v14, v14, v86, v87
v_mfma_f32_32x32x8_bf16 v[64:79], v[52:53], v[44:45], v[64:79]
v_max3_f32 v14, v14, v88, v89
v_max3_f32 v14, v14, v90, v91
v_max3_f32 v14, v14, v92, v93
v_max3_f32 v14, v14, v94, v95
ds_read_b128 v[48:51], v10 offset:27648
ds_read_b64 v[52:53], v11 offset:13824
s_waitcnt lgkmcnt(2)
v_mfma_f32_32x32x16_bf16 v[80:95], v[56:59], v[40:43], 0
v_max3_f32 v14, v14, v64, v65
v_max3_f32 v14, v14, v66, v67
v_max3_f32 v14, v14, v68, v69
v_max3_f32 v14, v14, v70, v71
v_mfma_f32_32x32x8_bf16 v[80:95], v[60:61], v[44:45], v[80:95]
v_max3_f32 v14, v14, v72, v73
v_max3_f32 v14, v14, v74, v75
v_max3_f32 v14, v14, v76, v77
v_max3_f32 v14, v14, v78, v79
ds_read_b128 v[56:59], v10 offset:28160
ds_read_b64 v[60:61], v11 offset:14080
s_waitcnt lgkmcnt(2)
v_mfma_f32_32x32x16_bf16 v[64:79], v[48:51], v[40:43], 0
v_max3_f32 v14, v14, v80, v81
v_max3_f32 v14, v14, v82, v83
v_max3_f32 v14, v14, v84, v85
v_max3_f32 v14, v14, v86, v87
v_mfma_f32_32x32x8_bf16 v[64:79], v[52:53], v[44:45], v[64:79]
v_max3_f32 v14, v14, v88, v89
v_max3_f32 v14, v14, v90, v91
v_max3_f32 v14, v14, v92, v93
v_max3_f32 v14, v14, v94, v95
ds_read_b128 v[48:51], v10 offset:28672
ds_read_b64 v[52:53], v11 offset:14336
s_waitcnt lgkmcnt(2)
v_mfma_f32_32x32x16_bf16 v[80:95], v[56:59], v[40:43], 0
v_max3_f32 v14, v14, v64, v65
v_max3_f32 v14, v14, v66, v67
v_max3_f32 v14, v14, v68, v69
v_max3_f32 v14, v14, v70, v71
v_mfma_f32_32x32x8_bf16 v[80:95], v[60:61], v[44:45], v[80:95]
v_max3_f32 v14, v14, v72, v73
v_max3_f32 v14, v14, v74, v75
v_max3_f32 v14, v14, v76, v77
v_max3_f32 v14, v14, v78, v79
ds_read_b128 v[56:59], v10 offset:29184
ds_read_b64 v[60:61], v11 offset:14592
s_waitcnt lgkmcnt(2)
v_mfma_f32_32x32x16_bf16 v[64:79], v[48:51], v[40:43], 0
v_max3_f32 v14, v14, v80, v81
v_max3_f32 v14, v14, v82, v83
v_max3_f32 v14, v14, v84, v85
v_max3_f32 v14, v14, v86, v87
v_mfma_f32_32x32x8_bf16 v[64:79], v[52:53], v[44:45], v[64:79]
v_max3_f32 v14, v14, v88, v89
v_max3_f32 v14, v14, v90, v91
v_max3_f32 v14, v14, v92, v93
v_max3_f32 v14, v14, v94, v95
ds_read_b128 v[48:51], v10 offset:29696
ds_read_b64 v[52:53], v11 offset:14848
s_waitcnt lgkmcnt(2)
v_mfma_f32_32x32x16_bf16 v[80:95], v[56:59], v[40:43], 0
v_max3_f32 v14, v14, v64, v65
v_max3_f32 v14, v14, v66, v67
v_max3_f32 v14, v14, v68, v69
v_max3_f32 v14, v14, v70, v71
v_mfma_f32_32x32x8_bf16 v[80:95], v[60:61], v[44:45], v[80:95]
v_max3_f32 v14, v14, v72, v73
v_max3_f32 v14, v14, v74, v75
v_max3_f32 v14, v14, v76, v77
v_max3_f32 v14, v14, v78, v79
ds_read_b128 v[56:59], v10 offset:30208
ds_read_b64 v[60:61], v11 offset:15104
s_waitcnt lgkmcnt(2)
v_mfma_f32_32x32x16_bf16 v[64:79], v[48:51], v[40:43], 0
v_max3_f32 v14, v14, v80, v81
v_max3_f32 v14, v14, v82, v83
v_max3_f32 v14, v14, v84, v85
v_max3_f32 v14, v14, v86, v87
v_mfma_f32_32x32x8_bf16 v[64:79], v[52:53], v[44:45], v[64:79]
v_max3_f32 v14, v14, v88, v89
v_max3_f32 v14, v14, v90, v91
v_max3_f32 v14, v14, v92, v93
v_max3_f32 v14, v14, v94, v95
ds_read_b128 v[48:51], v10 offset:30720
ds_read_b64 v[52:53], v11 offset:15360
s_waitcnt lgkmcnt(2)
v_mfma_f32_32x32x16_bf16 v[80:95], v[56:59], v[40:43], 0
v_max3_f32 v14, v14, v64, v65
v_max3_f32 v14, v14, v66, v67
v_max3_f32 v14, v14, v68, v69
v_max3_f32 v14, v14, v70, v71
v_mfma_f32_32x32x8_bf16 v[80:95], v[60:61], v[44:45], v[80:95]
v_max3_f32 v14, v14, v72, v73
v_max3_f32 v14, v14, v74, v75
v_max3_f32 v14, v14, v76, v77
v_max3_f32 v14, v14, v78, v79
ds_read_b128 v[56:59], v10 offset:31232
ds_read_b64 v[60:61], v11 offset:15616
s_waitcnt lgkmcnt(2)
v_mfma_f32_32x32x16_bf16 v[64:79], v[48:51], v[40:43], 0
v_max3_f32 v14, v14, v80, v81
v_max3_f32 v14, v14, v82, v83
v_max3_f32 v14, v14, v84, v85
v_max3_f32 v14, v14, v86, v87
v_mfma_f32_32x32x8_bf16 v[64:79], v[52:53], v[44:45], v[64:79]
v_max3_f32 v14, v14, v88, v89
v_max3_f32 v14, v14, v90, v91
v_max3_f32 v14, v14, v92, v93
v_max3_f32 v14, v14, v94, v95
ds_read_b128 v[48:51], v10 offset:31744
ds_read_b64 v[52:53], v11 offset:15872
s_waitcnt lgkmcnt(2)
v_mfma_f32_32x32x16_bf16 v[80:95], v[56:59], v[40:43], 0
v_max3_f32 v14, v14, v64, v65
v_max3_f32 v14, v14, v66, v67
v_max3_f32 v14, v14, v68, v69
v_max3_f32 v14, v14, v70, v71
v_mfma_f32_32x32x8_bf16 v[80:95], v[60:61], v[44:45], v[80:95]
v_max3_f32 v14, v14, v72, v73
v_max3_f32 v14, v14, v74, v75
v_max3_f32 v14, v14, v76, v77
v_max3_f32 v14, v14, v78, v79
ds_read_b128 v[56:59], v10 offset:32256
ds_read_b64 v[60:61], v11 offset:16128
s_waitcnt lgkmcnt(2)
v_mfma_f32_32x32x16_bf16 v[64:79], v[48:51], v[40:43], 0
v_max3_f32 v14, v14, v80, v81
v_max3_f32 v14, v14, v82, v83
v_max3_f32 v14, v14, v84, v85
v_max3_f32 v14, v14, v86, v87
v_mfma_f32_32x32x8_bf16 v[64:79], v[52:53], v[44:45], v[64:79]
v_max3_f32 v14, v14, v88, v89
v_max3_f32 v14, v14, v90, v91
v_max3_f32 v14, v14, v92, v93
v_max3_f32 v14, v14, v94, v95
s_waitcnt lgkmcnt(0)
v_mfma_f32_32x32x16_bf16 v[80:95], v[56:59], v[40:43], 0
v_max3_f32 v14, v14, v64, v65
v_max3_f32 v14, v14, v66, v67
v_max3_f32 v14, v14, v68, v69
v_max3_f32 v14, v14, v70, v71
v_mfma_f32_32x32x8_bf16 v[80:95], v[60:61], v[44:45], v[80:95]
v_max3_f32 v14, v14, v72, v73
v_max3_f32 v14, v14, v74, v75
v_max3_f32 v14, v14, v76, v77
v_max3_f32 v14, v14, v78, v79
s_nop 15
v_max3_f32 v14, v14, v80, v81
v_max3_f32 v14, v14, v82, v83
v_max3_f32 v14, v14, v84, v85
v_max3_f32 v14, v14, v86, v87
v_max3_f32 v14, v14, v88, v89
v_max3_f32 v14, v14, v90, v91
v_max3_f32 v14, v14, v92, v93
v_max3_f32 v14, v14, v94, v95
v_mov_b32 v15, v14
s_nop 1
v_permlane32_swap_b32 v14, v15
s_nop 1
v_max_f32 v14, v14, v15
v_sub_f32 v15, 0, v14
v_cvt_pk_bf16_f32 v16, v15, v15
v_lshlrev_b32 v17, 16, v16
v_sub_f32 v17, v15, v17
v_cvt_pk_bf16_f32 v17, v17, v17
v_and_b32 v16, 0xffff, v16
v_lshl_or_b32 v16, v17, 16, v16
v_cndmask_b32 v45, 0, v16, vcc
v_mov_b32 v120, 0
v_mov_b32 v121, 0
v_mov_b32 v122, 0
v_mov_b32 v123, 0
v_mov_b32 v124, 0
v_mov_b32 v125, 0
v_mov_b32 v126, 0
v_mov_b32 v127, 0
v_mov_b32 v128, 0
v_mov_b32 v129, 0
v_mov_b32 v130, 0
v_mov_b32 v131, 0
v_mov_b32 v132, 0
v_mov_b32 v133, 0
v_mov_b32 v134, 0
v_mov_b32 v135, 0
ds_read_b128 v[48:51], v10 offset:0
ds_read_b64 v[52:53], v11 offset:0
ds_read_b128 v[56:59], v10 offset:512
ds_read_b64 v[60:61], v11 offset:256
s_waitcnt lgkmcnt(2)
v_mfma_f32_32x32x16_bf16 v[64:79], v[48:51], v[40:43], 0
v_mfma_f32_32x32x8_bf16 v[64:79], v[52:53], v[44:45], v[64:79]
s_waitcnt lgkmcnt(0)
s_nop 7
v_mfma_f32_32x32x16_bf16 v[80:95], v[56:59], v[40:43], 0
v_exp_f32 v64, v64
v_exp_f32 v65, v65
v_exp_f32 v66, v66
v_exp_f32 v67, v67
v_mfma_f32_32x32x8_bf16 v[80:95], v[60:61], v[44:45], v[80:95]
v_exp_f32 v68, v68
v_exp_f32 v69, v69
ds_read_b128 v[48:51], v10 offset:1024
ds_read_b64 v[52:53], v11 offset:512
v_exp_f32 v70, v70
v_exp_f32 v71, v71
v_exp_f32 v72, v72
v_exp_f32 v73, v73
ds_read_b128 v[104:107], v12 offset:0
ds_read_b128 v[108:111], v12 offset:608
v_exp_f32 v74, v74
v_exp_f32 v75, v75
v_exp_f32 v76, v76
v_exp_f32 v77, v77
v_exp_f32 v78, v78
v_exp_f32 v79, v79
v_cvt_pk_bf16_f32 v96, v64, v65
v_cvt_pk_bf16_f32 v97, v66, v67
v_cvt_pk_bf16_f32 v98, v68, v69
v_cvt_pk_bf16_f32 v99, v70, v71
v_cvt_pk_bf16_f32 v100, v72, v73
v_cvt_pk_bf16_f32 v101, v74, v75
v_cvt_pk_bf16_f32 v102, v76, v77
v_cvt_pk_bf16_f32 v103, v78, v79
s_waitcnt lgkmcnt(0)
v_mfma_f32_32x32x16_bf16 v[64:79], v[48:51], v[40:43], 0
v_exp_f32 v80, v80
v_exp_f32 v81, v81
v_exp_f32 v82, v82
v_exp_f32 v83, v83
v_mfma_f32_32x32x8_bf16 v[64:79], v[52:53], v[44:45], v[64:79]
v_exp_f32 v84, v84
v_exp_f32 v85, v85
ds_read_b128 v[56:59], v10 offset:1536
ds_read_b64 v[60:61], v11 offset:768
v_exp_f32 v86, v86
v_exp_f32 v87, v87
v_mfma_f32_32x32x16_bf16 v[120:135], v[104:107], v[96:99], v[120:135]
v_exp_f32 v88, v88
v_exp_f32 v89, v89
ds_read_b128 v[112:115], v12 offset:1216
ds_read_b128 v[116:119], v12 offset:1824
v_exp_f32 v90, v90
v_exp_f32 v91, v91
v_mfma_f32_32x32x16_bf16 v[120:135], v[108:111], v[100:103], v[120:135]
v_exp_f32 v92, v92
v_exp_f32 v93, v93
v_exp_f32 v94, v94
v_exp_f32 v95, v95
v_cvt_pk_bf16_f32 v140, v80, v81
v_cvt_pk_bf16_f32 v141, v82, v83
v_cvt_pk_bf16_f32 v142, v84, v85
v_cvt_pk_bf16_f32 v143, v86, v87
v_cvt_pk_bf16_f32 v144, v88, v89
v_cvt_pk_bf16_f32 v145, v90, v91
v_cvt_pk_bf16_f32 v146, v92, v93
v_cvt_pk_bf16_f32 v147, v94, v95
s_waitcnt lgkmcnt(0)
v_mfma_f32_32x32x16_bf16 v[80:95], v[56:59], v[40:43], 0
v_exp_f32 v64, v64
v_exp_f32 v65, v65
v_exp_f32 v66, v66
v_exp_f32 v67, v67
v_mfma_f32_32x32x8_bf16 v[80:95], v[60:61], v[44:45], v[80:95]
v_exp_f32 v68, v68
v_exp_f32 v69, v69
ds_read_b128 v[48:51], v10 offset:2048
ds_read_b64 v[52:53], v11 offset:1024
v_exp_f32 v70, v70
v_exp_f32 v71, v71
v_mfma_f32_32x32x16_bf16 v[120:135], v[112:115], v[140:143], v[120:135]
v_exp_f32 v72, v72
v_exp_f32 v73, v73
ds_read_b128 v[104:107], v12 offset:2432
ds_read_b128 v[108:111], v12 offset:3040
v_exp_f32 v74, v74
v_exp_f32 v75, v75
v_mfma_f32_32x32x16_bf16 v[120:135], v[116:119], v[144:147], v[120:135]
v_exp_f32 v76, v76
v_exp_f32 v77, v77
v_exp_f32 v78, v78
v_exp_f32 v79, v79
v_cvt_pk_bf16_f32 v96, v64, v65
v_cvt_pk_bf16_f32 v97, v66, v67
v_cvt_pk_bf16_f32 v98, v68, v69
v_cvt_pk_bf16_f32 v99, v70, v71
v_cvt_pk_bf16_f32 v100, v72, v73
v_cvt_pk_bf16_f32 v101, v74, v75
v_cvt_pk_bf16_f32 v102, v76, v77
v_cvt_pk_bf16_f32 v103, v78, v79
s_waitcnt lgkmcnt(0)
v_mfma_f32_32x32x16_bf16 v[64:79], v[48:51], v[40:43], 0
v_exp_f32 v80, v80
v_exp_f32 v81, v81
v_exp_f32 v82, v82
v_exp_f32 v83, v83
v_mfma_f32_32x32x8_bf16 v[64:79], v[52:53], v[44:45], v[64:79]
v_exp_f32 v84, v84
v_exp_f32 v85, v85
ds_read_b128 v[56:59], v10 offset:2560
ds_read_b64 v[60:61], v11 offset:1280
v_exp_f32 v86, v86
v_exp_f32 v87, v87
v_mfma_f32_32x32x16_bf16 v[120:135], v[104:107], v[96:99], v[120:135]
v_exp_f32 v88, v88
v_exp_f32 v89, v89
ds_read_b128 v[112:115], v12 offset:3648
ds_read_b128 v[116:119], v12 offset:4256
v_exp_f32 v90, v90
v_exp_f32 v91, v91
v_mfma_f32_32x32x16_bf16 v[120:135], v[108:111], v[100:103], v[120:135]
v_exp_f32 v92, v92
v_exp_f32 v93, v93
v_exp_f32 v94, v94
v_exp_f32 v95, v95
v_cvt_pk_bf16_f32 v140, v80, v81
v_cvt_pk_bf16_f32 v141, v82, v83
v_cvt_pk_bf16_f32 v142, v84, v85
v_cvt_pk_bf16_f32 v143, v86, v87
v_cvt_pk_bf16_f32 v144, v88, v89
v_cvt_pk_bf16_f32 v145, v90, v91
v_cvt_pk_bf16_f32 v146, v92, v93
v_cvt_pk_bf16_f32 v147, v94, v95
s_waitcnt lgkmcnt(0)
v_mfma_f32_32x32x16_bf16 v[80:95], v[56:59], v[40:43], 0
v_exp_f32 v64, v64
v_exp_f32 v65, v65
v_exp_f32 v66, v66
v_exp_f32 v67, v67
v_mfma_f32_32x32x8_bf16 v[80:95], v[60:61], v[44:45], v[80:95]
v_exp_f32 v68, v68
v_exp_f32 v69, v69
ds_read_b128 v[48:51], v10 offset:3072
ds_read_b64 v[52:53], v11 offset:1536
v_exp_f32 v70, v70
v_exp_f32 v71, v71
v_mfma_f32_32x32x16_bf16 v[120:135], v[112:115], v[140:143], v[120:135]
v_exp_f32 v72, v72
v_exp_f32 v73, v73
ds_read_b128 v[104:107], v12 offset:4864
ds_read_b128 v[108:111], v12 offset:5472
v_exp_f32 v74, v74
v_exp_f32 v75, v75
v_mfma_f32_32x32x16_bf16 v[120:135], v[116:119], v[144:147], v[120:135]
v_exp_f32 v76, v76
v_exp_f32 v77, v77
v_exp_f32 v78, v78
v_exp_f32 v79, v79
v_cvt_pk_bf16_f32 v96, v64, v65
v_cvt_pk_bf16_f32 v97, v66, v67
v_cvt_pk_bf16_f32 v98, v68, v69
v_cvt_pk_bf16_f32 v99, v70, v71
v_cvt_pk_bf16_f32 v100, v72, v73
v_cvt_pk_bf16_f32 v101, v74, v75
v_cvt_pk_bf16_f32 v102, v76, v77
v_cvt_pk_bf16_f32 v103, v78, v79
s_waitcnt lgkmcnt(0)
v_mfma_f32_32x32x16_bf16 v[64:79], v[48:51], v[40:43], 0
v_exp_f32 v80, v80
v_exp_f32 v81, v81
v_exp_f32 v82, v82
v_exp_f32 v83, v83
v_mfma_f32_32x32x8_bf16 v[64:79], v[52:53], v[44:45], v[64:79]
v_exp_f32 v84, v84
v_exp_f32 v85, v85
ds_read_b128 v[56:59], v10 offset:3584
ds_read_b64 v[60:61], v11 offset:1792
v_exp_f32 v86, v86
v_exp_f32 v87, v87
v_mfma_f32_32x32x16_bf16 v[120:135], v[104:107], v[96:99], v[120:135]
v_exp_f32 v88, v88
v_exp_f32 v89, v89
ds_read_b128 v[112:115], v12 offset:6080
ds_read_b128 v[116:119], v12 offset:6688
v_exp_f32 v90, v90
v_exp_f32 v91, v91
v_mfma_f32_32x32x16_bf16 v[120:135], v[108:111], v[100:103], v[120:135]
v_exp_f32 v92, v92
v_exp_f32 v93, v93
v_exp_f32 v94, v94
v_exp_f32 v95, v95
v_cvt_pk_bf16_f32 v140, v80, v81
v_cvt_pk_bf16_f32 v141, v82, v83
v_cvt_pk_bf16_f32 v142, v84, v85
v_cvt_pk_bf16_f32 v143, v86, v87
v_cvt_pk_bf16_f32 v144, v88, v89
v_cvt_pk_bf16_f32 v145, v90, v91
v_cvt_pk_bf16_f32 v146, v92, v93
v_cvt_pk_bf16_f32 v147, v94, v95
s_waitcnt lgkmcnt(0)
v_mfma_f32_32x32x16_bf16 v[80:95], v[56:59], v[40:43], 0
v_exp_f32 v64, v64
v_exp_f32 v65, v65
v_exp_f32 v66, v66
v_exp_f32 v67, v67
v_mfma_f32_32x32x8_bf16 v[80:95], v[60:61], v[44:45], v[80:95]
v_exp_f32 v68, v68
v_exp_f32 v69, v69
ds_read_b128 v[48:51], v10 offset:4096
ds_read_b64 v[52:53], v11 offset:2048
v_exp_f32 v70, v70
v_exp_f32 v71, v71
v_mfma_f32_32x32x16_bf16 v[120:135], v[112:115], v[140:143], v[120:135]
v_exp_f32 v72, v72
v_exp_f32 v73, v73
ds_read_b128 v[104:107], v12 offset:7296
ds_read_b128 v[108:111], v12 offset:7904
v_exp_f32 v74, v74
v_exp_f32 v75, v75
v_mfma_f32_32x32x16_bf16 v[120:135], v[116:119], v[144:147], v[120:135]
v_exp_f32 v76, v76
v_exp_f32 v77, v77
v_exp_f32 v78, v78
v_exp_f32 v79, v79
v_cvt_pk_bf16_f32 v96, v64, v65
v_cvt_pk_bf16_f32 v97, v66, v67
v_cvt_pk_bf16_f32 v98, v68, v69
v_cvt_pk_bf16_f32 v99, v70, v71
v_cvt_pk_bf16_f32 v100, v72, v73
v_cvt_pk_bf16_f32 v101, v74, v75
v_cvt_pk_bf16_f32 v102, v76, v77
v_cvt_pk_bf16_f32 v103, v78, v79
s_waitcnt lgkmcnt(0)
v_mfma_f32_32x32x16_bf16 v[64:79], v[48:51], v[40:43], 0
v_exp_f32 v80, v80
v_exp_f32 v81, v81
v_exp_f32 v82, v82
v_exp_f32 v83, v83
v_mfma_f32_32x32x8_bf16 v[64:79], v[52:53], v[44:45], v[64:79]
v_exp_f32 v84, v84
v_exp_f32 v85, v85
ds_read_b128 v[56:59], v10 offset:4608
ds_read_b64 v[60:61], v11 offset:2304
v_exp_f32 v86, v86
v_exp_f32 v87, v87
v_mfma_f32_32x32x16_bf16 v[120:135], v[104:107], v[96:99], v[120:135]
v_exp_f32 v88, v88
v_exp_f32 v89, v89
ds_read_b128 v[112:115], v12 offset:8512
ds_read_b128 v[116:119], v12 offset:9120
v_exp_f32 v90, v90
v_exp_f32 v91, v91
v_mfma_f32_32x32x16_bf16 v[120:135], v[108:111], v[100:103], v[120:135]
v_exp_f32 v92, v92
v_exp_f32 v93, v93
v_exp_f32 v94, v94
v_exp_f32 v95, v95
v_cvt_pk_bf16_f32 v140, v80, v81
v_cvt_pk_bf16_f32 v141, v82, v83
v_cvt_pk_bf16_f32 v142, v84, v85
v_cvt_pk_bf16_f32 v143, v86, v87
v_cvt_pk_bf16_f32 v144, v88, v89
v_cvt_pk_bf16_f32 v145, v90, v91
v_cvt_pk_bf16_f32 v146, v92, v93
v_cvt_pk_bf16_f32 v147, v94, v95
s_waitcnt lgkmcnt(0)
v_mfma_f32_32x32x16_bf16 v[80:95], v[56:59], v[40:43], 0
v_exp_f32 v64, v64
v_exp_f32 v65, v65
v_exp_f32 v66, v66
v_exp_f32 v67, v67
v_mfma_f32_32x32x8_bf16 v[80:95], v[60:61], v[44:45], v[80:95]
v_exp_f32 v68, v68
v_exp_f32 v69, v69
ds_read_b128 v[48:51], v10 offset:5120
ds_read_b64 v[52:53], v11 offset:2560
v_exp_f32 v70, v70
v_exp_f32 v71, v71
v_mfma_f32_32x32x16_bf16 v[120:135], v[112:115], v[140:143], v[120:135]
v_exp_f32 v72, v72
v_exp_f32 v73, v73
ds_read_b128 v[104:107], v12 offset:9728
ds_read_b128 v[108:111], v12 offset:10336
v_exp_f32 v74, v74
v_exp_f32 v75, v75
v_mfma_f32_32x32x16_bf16 v[120:135], v[116:119], v[144:147], v[120:135]
v_exp_f32 v76, v76
v_exp_f32 v77, v77
v_exp_f32 v78, v78
v_exp_f32 v79, v79
v_cvt_pk_bf16_f32 v96, v64, v65
v_cvt_pk_bf16_f32 v97, v66, v67
v_cvt_pk_bf16_f32 v98, v68, v69
v_cvt_pk_bf16_f32 v99, v70, v71
v_cvt_pk_bf16_f32 v100, v72, v73
v_cvt_pk_bf16_f32 v101, v74, v75
v_cvt_pk_bf16_f32 v102, v76, v77
v_cvt_pk_bf16_f32 v103, v78, v79
s_waitcnt lgkmcnt(0)
v_mfma_f32_32x32x16_bf16 v[64:79], v[48:51], v[40:43], 0
v_exp_f32 v80, v80
v_exp_f32 v81, v81
v_exp_f32 v82, v82
v_exp_f32 v83, v83
v_mfma_f32_32x32x8_bf16 v[64:79], v[52:53], v[44:45], v[64:79]
v_exp_f32 v84, v84
v_exp_f32 v85, v85
ds_read_b128 v[56:59], v10 offset:5632
ds_read_b64 v[60:61], v11 offset:2816
v_exp_f32 v86, v86
v_exp_f32 v87, v87
v_mfma_f32_32x32x16_bf16 v[120:135], v[104:107], v[96:99], v[120:135]
v_exp_f32 v88, v88
v_exp_f32 v89, v89
ds_read_b128 v[112:115], v12 offset:10944
ds_read_b128 v[116:119], v12 offset:11552
v_exp_f32 v90, v90
v_exp_f32 v91, v91
v_mfma_f32_32x32x16_bf16 v[120:135], v[108:111], v[100:103], v[120:135]
v_exp_f32 v92, v92
v_exp_f32 v93, v93
v_exp_f32 v94, v94
v_exp_f32 v95, v95
v_cvt_pk_bf16_f32 v140, v80, v81
v_cvt_pk_bf16_f32 v141, v82, v83
v_cvt_pk_bf16_f32 v142, v84, v85
v_cvt_pk_bf16_f32 v143, v86, v87
v_cvt_pk_bf16_f32 v144, v88, v89
v_cvt_pk_bf16_f32 v145, v90, v91
v_cvt_pk_bf16_f32 v146, v92, v93
v_cvt_pk_bf16_f32 v147, v94, v95
s_waitcnt lgkmcnt(0)
v_mfma_f32_32x32x16_bf16 v[80:95], v[56:59], v[40:43], 0
v_exp_f32 v64, v64
v_exp_f32 v65, v65
v_exp_f32 v66, v66
v_exp_f32 v67, v67
v_mfma_f32_32x32x8_bf16 v[80:95], v[60:61], v[44:45], v[80:95]
v_exp_f32 v68, v68
v_exp_f32 v69, v69
ds_read_b128 v[48:51], v10 offset:6144
ds_read_b64 v[52:53], v11 offset:3072
v_exp_f32 v70, v70
v_exp_f32 v71, v71
v_mfma_f32_32x32x16_bf16 v[120:135], v[112:115], v[140:143], v[120:135]
v_exp_f32 v72, v72
v_exp_f32 v73, v73
ds_read_b128 v[104:107], v12 offset:12160
ds_read_b128 v[108:111], v12 offset:12768
v_exp_f32 v74, v74
v_exp_f32 v75, v75
v_mfma_f32_32x32x16_bf16 v[120:135], v[116:119], v[144:147], v[120:135]
v_exp_f32 v76, v76
v_exp_f32 v77, v77
v_exp_f32 v78, v78
v_exp_f32 v79, v79
v_cvt_pk_bf16_f32 v96, v64, v65
v_cvt_pk_bf16_f32 v97, v66, v67
v_cvt_pk_bf16_f32 v98, v68, v69
v_cvt_pk_bf16_f32 v99, v70, v71
v_cvt_pk_bf16_f32 v100, v72, v73
v_cvt_pk_bf16_f32 v101, v74, v75
v_cvt_pk_bf16_f32 v102, v76, v77
v_cvt_pk_bf16_f32 v103, v78, v79
s_waitcnt lgkmcnt(0)
v_mfma_f32_32x32x16_bf16 v[64:79], v[48:51], v[40:43], 0
v_exp_f32 v80, v80
v_exp_f32 v81, v81
v_exp_f32 v82, v82
v_exp_f32 v83, v83
v_mfma_f32_32x32x8_bf16 v[64:79], v[52:53], v[44:45], v[64:79]
v_exp_f32 v84, v84
v_exp_f32 v85, v85
ds_read_b128 v[56:59], v10 offset:6656
ds_read_b64 v[60:61], v11 offset:3328
v_exp_f32 v86, v86
v_exp_f32 v87, v87
v_mfma_f32_32x32x16_bf16 v[120:135], v[104:107], v[96:99], v[120:135]
v_exp_f32 v88, v88
v_exp_f32 v89, v89
ds_read_b128 v[112:115], v12 offset:13376
ds_read_b128 v[116:119], v12 offset:13984
v_exp_f32 v90, v90
v_exp_f32 v91, v91
v_mfma_f32_32x32x16_bf16 v[120:135], v[108:111], v[100:103], v[120:135]
v_exp_f32 v92, v92
v_exp_f32 v93, v93
v_exp_f32 v94, v94
v_exp_f32 v95, v95
v_cvt_pk_bf16_f32 v140, v80, v81
v_cvt_pk_bf16_f32 v141, v82, v83
v_cvt_pk_bf16_f32 v142, v84, v85
v_cvt_pk_bf16_f32 v143, v86, v87
v_cvt_pk_bf16_f32 v144, v88, v89
v_cvt_pk_bf16_f32 v145, v90, v91
v_cvt_pk_bf16_f32 v146, v92, v93
v_cvt_pk_bf16_f32 v147, v94, v95
s_waitcnt lgkmcnt(0)
v_mfma_f32_32x32x16_bf16 v[80:95], v[56:59], v[40:43], 0
v_exp_f32 v64, v64
v_exp_f32 v65, v65
v_exp_f32 v66, v66
v_exp_f32 v67, v67
v_mfma_f32_32x32x8_bf16 v[80:95], v[60:61], v[44:45], v[80:95]
v_exp_f32 v68, v68
v_exp_f32 v69, v69
ds_read_b128 v[48:51], v10 offset:7168
ds_read_b64 v[52:53], v11 offset:3584
v_exp_f32 v70, v70
v_exp_f32 v71, v71
v_mfma_f32_32x32x16_bf16 v[120:135], v[112:115], v[140:143], v[120:135]
v_exp_f32 v72, v72
v_exp_f32 v73, v73
ds_read_b128 v[104:107], v12 offset:14592
ds_read_b128 v[108:111], v12 offset:15200
v_exp_f32 v74, v74
v_exp_f32 v75, v75
v_mfma_f32_32x32x16_bf16 v[120:135], v[116:119], v[144:147], v[120:135]
v_exp_f32 v76, v76
v_exp_f32 v77, v77
v_exp_f32 v78, v78
v_exp_f32 v79, v79
v_cvt_pk_bf16_f32 v96, v64, v65
v_cvt_pk_bf16_f32 v97, v66, v67
v_cvt_pk_bf16_f32 v98, v68, v69
v_cvt_pk_bf16_f32 v99, v70, v71
v_cvt_pk_bf16_f32 v100, v72, v73
v_cvt_pk_bf16_f32 v101, v74, v75
v_cvt_pk_bf16_f32 v102, v76, v77
v_cvt_pk_bf16_f32 v103, v78, v79
s_waitcnt lgkmcnt(0)
v_mfma_f32_32x32x16_bf16 v[64:79], v[48:51], v[40:43], 0
v_exp_f32 v80, v80
v_exp_f32 v81, v81
v_exp_f32 v82, v82
v_exp_f32 v83, v83
v_mfma_f32_32x32x8_bf16 v[64:79], v[52:53], v[44:45], v[64:79]
v_exp_f32 v84, v84
v_exp_f32 v85, v85
ds_read_b128 v[56:59], v10 offset:7680
ds_read_b64 v[60:61], v11 offset:3840
v_exp_f32 v86, v86
v_exp_f32 v87, v87
v_mfma_f32_32x32x16_bf16 v[120:135], v[104:107], v[96:99], v[120:135]
v_exp_f32 v88, v88
v_exp_f32 v89, v89
ds_read_b128 v[112:115], v12 offset:15808
ds_read_b128 v[116:119], v12 offset:16416
v_exp_f32 v90, v90
v_exp_f32 v91, v91
v_mfma_f32_32x32x16_bf16 v[120:135], v[108:111], v[100:103], v[120:135]
v_exp_f32 v92, v92
v_exp_f32 v93, v93
v_exp_f32 v94, v94
v_exp_f32 v95, v95
v_cvt_pk_bf16_f32 v140, v80, v81
v_cvt_pk_bf16_f32 v141, v82, v83
v_cvt_pk_bf16_f32 v142, v84, v85
v_cvt_pk_bf16_f32 v143, v86, v87
v_cvt_pk_bf16_f32 v144, v88, v89
v_cvt_pk_bf16_f32 v145, v90, v91
v_cvt_pk_bf16_f32 v146, v92, v93
v_cvt_pk_bf16_f32 v147, v94, v95
s_waitcnt lgkmcnt(0)
v_mfma_f32_32x32x16_bf16 v[80:95], v[56:59], v[40:43], 0
v_exp_f32 v64, v64
v_exp_f32 v65, v65
v_exp_f32 v66, v66
v_exp_f32 v67, v67
v_mfma_f32_32x32x8_bf16 v[80:95], v[60:61], v[44:45], v[80:95]
v_exp_f32 v68, v68
v_exp_f32 v69, v69
ds_read_b128 v[48:51], v10 offset:8192
ds_read_b64 v[52:53], v11 offset:4096
v_exp_f32 v70, v70
v_exp_f32 v71, v71
v_mfma_f32_32x32x16_bf16 v[120:135], v[112:115], v[140:143], v[120:135]
v_exp_f32 v72, v72
v_exp_f32 v73, v73
ds_read_b128 v[104:107], v12 offset:17024
ds_read_b128 v[108:111], v12 offset:17632
v_exp_f32 v74, v74
v_exp_f32 v75, v75
v_mfma_f32_32x32x16_bf16 v[120:135], v[116:119], v[144:147], v[120:135]
v_exp_f32 v76, v76
v_exp_f32 v77, v77
v_exp_f32 v78, v78
v_exp_f32 v79, v79
v_cvt_pk_bf16_f32 v96, v64, v65
v_cvt_pk_bf16_f32 v97, v66, v67
v_cvt_pk_bf16_f32 v98, v68, v69
v_cvt_pk_bf16_f32 v99, v70, v71
v_cvt_pk_bf16_f32 v100, v72, v73
v_cvt_pk_bf16_f32 v101, v74, v75
v_cvt_pk_bf16_f32 v102, v76, v77
v_cvt_pk_bf16_f32 v103, v78, v79
s_waitcnt lgkmcnt(0)
v_mfma_f32_32x32x16_bf16 v[64:79], v[48:51], v[40:43], 0
v_exp_f32 v80, v80
v_exp_f32 v81, v81
v_exp_f32 v82, v82
v_exp_f32 v83, v83
v_mfma_f32_32x32x8_bf16 v[64:79], v[52:53], v[44:45], v[64:79]
v_exp_f32 v84, v84
v_exp_f32 v85, v85
ds_read_b128 v[56:59], v10 offset:8704
ds_read_b64 v[60:61], v11 offset:4352
v_exp_f32 v86, v86
v_exp_f32 v87, v87
v_mfma_f32_32x32x16_bf16 v[120:135], v[104:107], v[96:99], v[120:135]
v_exp_f32 v88, v88
v_exp_f32 v89, v89
ds_read_b128 v[112:115], v12 offset:18240
ds_read_b128 v[116:119], v12 offset:18848
v_exp_f32 v90, v90
v_exp_f32 v91, v91
v_mfma_f32_32x32x16_bf16 v[120:135], v[108:111], v[100:103], v[120:135]
v_exp_f32 v92, v92
v_exp_f32 v93, v93
v_exp_f32 v94, v94
v_exp_f32 v95, v95
v_cvt_pk_bf16_f32 v140, v80, v81
v_cvt_pk_bf16_f32 v141, v82, v83
v_cvt_pk_bf16_f32 v142, v84, v85
v_cvt_pk_bf16_f32 v143, v86, v87
v_cvt_pk_bf16_f32 v144, v88, v89
v_cvt_pk_bf16_f32 v145, v90, v91
v_cvt_pk_bf16_f32 v146, v92, v93
v_cvt_pk_bf16_f32 v147, v94, v95
s_waitcnt lgkmcnt(0)
v_mfma_f32_32x32x16_bf16 v[80:95], v[56:59], v[40:43], 0
v_exp_f32 v64, v64
v_exp_f32 v65, v65
v_exp_f32 v66, v66
v_exp_f32 v67, v67
v_mfma_f32_32x32x8_bf16 v[80:95], v[60:61], v[44:45], v[80:95]
v_exp_f32 v68, v68
v_exp_f32 v69, v69
ds_read_b128 v[48:51], v10 offset:9216
ds_read_b64 v[52:53], v11 offset:4608
v_exp_f32 v70, v70
v_exp_f32 v71, v71
v_mfma_f32_32x32x16_bf16 v[120:135], v[112:115], v[140:143], v[120:135]
v_exp_f32 v72, v72
v_exp_f32 v73, v73
ds_read_b128 v[104:107], v12 offset:19456
ds_read_b128 v[108:111], v12 offset:20064
v_exp_f32 v74, v74
v_exp_f32 v75, v75
v_mfma_f32_32x32x16_bf16 v[120:135], v[116:119], v[144:147], v[120:135]
v_exp_f32 v76, v76
v_exp_f32 v77, v77
v_exp_f32 v78, v78
v_exp_f32 v79, v79
v_cvt_pk_bf16_f32 v96, v64, v65
v_cvt_pk_bf16_f32 v97, v66, v67
v_cvt_pk_bf16_f32 v98, v68, v69
v_cvt_pk_bf16_f32 v99, v70, v71
v_cvt_pk_bf16_f32 v100, v72, v73
v_cvt_pk_bf16_f32 v101, v74, v75
v_cvt_pk_bf16_f32 v102, v76, v77
v_cvt_pk_bf16_f32 v103, v78, v79
s_waitcnt lgkmcnt(0)
v_mfma_f32_32x32x16_bf16 v[64:79], v[48:51], v[40:43], 0
v_exp_f32 v80, v80
v_exp_f32 v81, v81
v_exp_f32 v82, v82
v_exp_f32 v83, v83
v_mfma_f32_32x32x8_bf16 v[64:79], v[52:53], v[44:45], v[64:79]
v_exp_f32 v84, v84
v_exp_f32 v85, v85
ds_read_b128 v[56:59], v10 offset:9728
ds_read_b64 v[60:61], v11 offset:4864
v_exp_f32 v86, v86
v_exp_f32 v87, v87
v_mfma_f32_32x32x16_bf16 v[120:135], v[104:107], v[96:99], v[120:135]
v_exp_f32 v88, v88
v_exp_f32 v89, v89
ds_read_b128 v[112:115], v12 offset:20672
ds_read_b128 v[116:119], v12 offset:21280
v_exp_f32 v90, v90
v_exp_f32 v91, v91
v_mfma_f32_32x32x16_bf16 v[120:135], v[108:111], v[100:103], v[120:135]
v_exp_f32 v92, v92
v_exp_f32 v93, v93
v_exp_f32 v94, v94
v_exp_f32 v95, v95
v_cvt_pk_bf16_f32 v140, v80, v81
v_cvt_pk_bf16_f32 v141, v82, v83
v_cvt_pk_bf16_f32 v142, v84, v85
v_cvt_pk_bf16_f32 v143, v86, v87
v_cvt_pk_bf16_f32 v144, v88, v89
v_cvt_pk_bf16_f32 v145, v90, v91
v_cvt_pk_bf16_f32 v146, v92, v93
v_cvt_pk_bf16_f32 v147, v94, v95
s_waitcnt lgkmcnt(0)
v_mfma_f32_32x32x16_bf16 v[80:95], v[56:59], v[40:43], 0
v_exp_f32 v64, v64
v_exp_f32 v65, v65
v_exp_f32 v66, v66
v_exp_f32 v67, v67
v_mfma_f32_32x32x8_bf16 v[80:95], v[60:61], v[44:45], v[80:95]
v_exp_f32 v68, v68
v_exp_f32 v69, v69
ds_read_b128 v[48:51], v10 offset:10240
ds_read_b64 v[52:53], v11 offset:5120
v_exp_f32 v70, v70
v_exp_f32 v71, v71
v_mfma_f32_32x32x16_bf16 v[120:135], v[112:115], v[140:143], v[120:135]
v_exp_f32 v72, v72
v_exp_f32 v73, v73
ds_read_b128 v[104:107], v12 offset:21888
ds_read_b128 v[108:111], v12 offset:22496
v_exp_f32 v74, v74
v_exp_f32 v75, v75
v_mfma_f32_32x32x16_bf16 v[120:135], v[116:119], v[144:147], v[120:135]
v_exp_f32 v76, v76
v_exp_f32 v77, v77
v_exp_f32 v78, v78
v_exp_f32 v79, v79
v_cvt_pk_bf16_f32 v96, v64, v65
v_cvt_pk_bf16_f32 v97, v66, v67
v_cvt_pk_bf16_f32 v98, v68, v69
v_cvt_pk_bf16_f32 v99, v70, v71
v_cvt_pk_bf16_f32 v100, v72, v73
v_cvt_pk_bf16_f32 v101, v74, v75
v_cvt_pk_bf16_f32 v102, v76, v77
v_cvt_pk_bf16_f32 v103, v78, v79
s_waitcnt lgkmcnt(0)
v_mfma_f32_32x32x16_bf16 v[64:79], v[48:51], v[40:43], 0
v_exp_f32 v80, v80
v_exp_f32 v81, v81
v_exp_f32 v82, v82
v_exp_f32 v83, v83
v_mfma_f32_32x32x8_bf16 v[64:79], v[52:53], v[44:45], v[64:79]
v_exp_f32 v84, v84
v_exp_f32 v85, v85
ds_read_b128 v[56:59], v10 offset:10752
ds_read_b64 v[60:61], v11 offset:5376
v_exp_f32 v86, v86
v_exp_f32 v87, v87
v_mfma_f32_32x32x16_bf16 v[120:135], v[104:107], v[96:99], v[120:135]
v_exp_f32 v88, v88
v_exp_f32 v89, v89
ds_read_b128 v[112:115], v12 offset:23104
ds_read_b128 v[116:119], v12 offset:23712
v_exp_f32 v90, v90
v_exp_f32 v91, v91
v_mfma_f32_32x32x16_bf16 v[120:135], v[108:111], v[100:103], v[120:135]
v_exp_f32 v92, v92
v_exp_f32 v93, v93
v_exp_f32 v94, v94
v_exp_f32 v95, v95
v_cvt_pk_bf16_f32 v140, v80, v81
v_cvt_pk_bf16_f32 v141, v82, v83
v_cvt_pk_bf16_f32 v142, v84, v85
v_cvt_pk_bf16_f32 v143, v86, v87
v_cvt_pk_bf16_f32 v144, v88, v89
v_cvt_pk_bf16_f32 v145, v90, v91
v_cvt_pk_bf16_f32 v146, v92, v93
v_cvt_pk_bf16_f32 v147, v94, v95
s_waitcnt lgkmcnt(0)
v_mfma_f32_32x32x16_bf16 v[80:95], v[56:59], v[40:43], 0
v_exp_f32 v64, v64
v_exp_f32 v65, v65
v_exp_f32 v66, v66
v_exp_f32 v67, v67
v_mfma_f32_32x32x8_bf16 v[80:95], v[60:61], v[44:45], v[80:95]
v_exp_f32 v68, v68
v_exp_f32 v69, v69
ds_read_b128 v[48:51], v10 offset:11264
ds_read_b64 v[52:53], v11 offset:5632
v_exp_f32 v70, v70
v_exp_f32 v71, v71
v_mfma_f32_32x32x16_bf16 v[120:135], v[112:115], v[140:143], v[120:135]
v_exp_f32 v72, v72
v_exp_f32 v73, v73
ds_read_b128 v[104:107], v12 offset:24320
ds_read_b128 v[108:111], v12 offset:24928
v_exp_f32 v74, v74
v_exp_f32 v75, v75
v_mfma_f32_32x32x16_bf16 v[120:135], v[116:119], v[144:147], v[120:135]
v_exp_f32 v76, v76
v_exp_f32 v77, v77
v_exp_f32 v78, v78
v_exp_f32 v79, v79
v_cvt_pk_bf16_f32 v96, v64, v65
v_cvt_pk_bf16_f32 v97, v66, v67
v_cvt_pk_bf16_f32 v98, v68, v69
v_cvt_pk_bf16_f32 v99, v70, v71
v_cvt_pk_bf16_f32 v100, v72, v73
v_cvt_pk_bf16_f32 v101, v74, v75
v_cvt_pk_bf16_f32 v102, v76, v77
v_cvt_pk_bf16_f32 v103, v78, v79
s_waitcnt lgkmcnt(0)
v_mfma_f32_32x32x16_bf16 v[64:79], v[48:51], v[40:43], 0
v_exp_f32 v80, v80
v_exp_f32 v81, v81
v_exp_f32 v82, v82
v_exp_f32 v83, v83
v_mfma_f32_32x32x8_bf16 v[64:79], v[52:53], v[44:45], v[64:79]
v_exp_f32 v84, v84
v_exp_f32 v85, v85
ds_read_b128 v[56:59], v10 offset:11776
ds_read_b64 v[60:61], v11 offset:5888
v_exp_f32 v86, v86
v_exp_f32 v87, v87
v_mfma_f32_32x32x16_bf16 v[120:135], v[104:107], v[96:99], v[120:135]
v_exp_f32 v88, v88
v_exp_f32 v89, v89
ds_read_b128 v[112:115], v12 offset:25536
ds_read_b128 v[116:119], v12 offset:26144
v_exp_f32 v90, v90
v_exp_f32 v91, v91
v_mfma_f32_32x32x16_bf16 v[120:135], v[108:111], v[100:103], v[120:135]
v_exp_f32 v92, v92
v_exp_f32 v93, v93
v_exp_f32 v94, v94
v_exp_f32 v95, v95
v_cvt_pk_bf16_f32 v140, v80, v81
v_cvt_pk_bf16_f32 v141, v82, v83
v_cvt_pk_bf16_f32 v142, v84, v85
v_cvt_pk_bf16_f32 v143, v86, v87
v_cvt_pk_bf16_f32 v144, v88, v89
v_cvt_pk_bf16_f32 v145, v90, v91
v_cvt_pk_bf16_f32 v146, v92, v93
v_cvt_pk_bf16_f32 v147, v94, v95
s_waitcnt lgkmcnt(0)
v_mfma_f32_32x32x16_bf16 v[80:95], v[56:59], v[40:43], 0
v_exp_f32 v64, v64
v_exp_f32 v65, v65
v_exp_f32 v66, v66
v_exp_f32 v67, v67
v_mfma_f32_32x32x8_bf16 v[80:95], v[60:61], v[44:45], v[80:95]
v_exp_f32 v68, v68
v_exp_f32 v69, v69
ds_read_b128 v[48:51], v10 offset:12288
ds_read_b64 v[52:53], v11 offset:6144
v_exp_f32 v70, v70
v_exp_f32 v71, v71
v_mfma_f32_32x32x16_bf16 v[120:135], v[112:115], v[140:143], v[120:135]
v_exp_f32 v72, v72
v_exp_f32 v73, v73
ds_read_b128 v[104:107], v12 offset:26752
ds_read_b128 v[108:111], v12 offset:27360
v_exp_f32 v74, v74
v_exp_f32 v75, v75
v_mfma_f32_32x32x16_bf16 v[120:135], v[116:119], v[144:147], v[120:135]
v_exp_f32 v76, v76
v_exp_f32 v77, v77
v_exp_f32 v78, v78
v_exp_f32 v79, v79
v_cvt_pk_bf16_f32 v96, v64, v65
v_cvt_pk_bf16_f32 v97, v66, v67
v_cvt_pk_bf16_f32 v98, v68, v69
v_cvt_pk_bf16_f32 v99, v70, v71
v_cvt_pk_bf16_f32 v100, v72, v73
v_cvt_pk_bf16_f32 v101, v74, v75
v_cvt_pk_bf16_f32 v102, v76, v77
v_cvt_pk_bf16_f32 v103, v78, v79
s_waitcnt lgkmcnt(0)
v_mfma_f32_32x32x16_bf16 v[64:79], v[48:51], v[40:43], 0
v_exp_f32 v80, v80
v_exp_f32 v81, v81
v_exp_f32 v82, v82
v_exp_f32 v83, v83
v_mfma_f32_32x32x8_bf16 v[64:79], v[52:53], v[44:45], v[64:79]
v_exp_f32 v84, v84
v_exp_f32 v85, v85
ds_read_b128 v[56:59], v10 offset:12800
ds_read_b64 v[60:61], v11 offset:6400
v_exp_f32 v86, v86
v_exp_f32 v87, v87
v_mfma_f32_32x32x16_bf16 v[120:135], v[104:107], v[96:99], v[120:135]
v_exp_f32 v88, v88
v_exp_f32 v89, v89
ds_read_b128 v[112:115], v12 offset:27968
ds_read_b128 v[116:119], v12 offset:28576
v_exp_f32 v90, v90
v_exp_f32 v91, v91
v_mfma_f32_32x32x16_bf16 v[120:135], v[108:111], v[100:103], v[120:135]
v_exp_f32 v92, v92
v_exp_f32 v93, v93
v_exp_f32 v94, v94
v_exp_f32 v95, v95
v_cvt_pk_bf16_f32 v140, v80, v81
v_cvt_pk_bf16_f32 v141, v82, v83
v_cvt_pk_bf16_f32 v142, v84, v85
v_cvt_pk_bf16_f32 v143, v86, v87
v_cvt_pk_bf16_f32 v144, v88, v89
v_cvt_pk_bf16_f32 v145, v90, v91
v_cvt_pk_bf16_f32 v146, v92, v93
v_cvt_pk_bf16_f32 v147, v94, v95
s_waitcnt lgkmcnt(0)
v_mfma_f32_32x32x16_bf16 v[80:95], v[56:59], v[40:43], 0
v_exp_f32 v64, v64
v_exp_f32 v65, v65
v_exp_f32 v66, v66
v_exp_f32 v67, v67
v_mfma_f32_32x32x8_bf16 v[80:95], v[60:61], v[44:45], v[80:95]
v_exp_f32 v68, v68
v_exp_f32 v69, v69
ds_read_b128 v[48:51], v10 offset:13312
ds_read_b64 v[52:53], v11 offset:6656
v_exp_f32 v70, v70
v_exp_f32 v71, v71
v_mfma_f32_32x32x16_bf16 v[120:135], v[112:115], v[140:143], v[120:135]
v_exp_f32 v72, v72
v_exp_f32 v73, v73
ds_read_b128 v[104:107], v12 offset:29184
ds_read_b128 v[108:111], v12 offset:29792
v_exp_f32 v74, v74
v_exp_f32 v75, v75
v_mfma_f32_32x32x16_bf16 v[120:135], v[116:119], v[144:147], v[120:135]
v_exp_f32 v76, v76
v_exp_f32 v77, v77
v_exp_f32 v78, v78
v_exp_f32 v79, v79
v_cvt_pk_bf16_f32 v96, v64, v65
v_cvt_pk_bf16_f32 v97, v66, v67
v_cvt_pk_bf16_f32 v98, v68, v69
v_cvt_pk_bf16_f32 v99, v70, v71
v_cvt_pk_bf16_f32 v100, v72, v73
v_cvt_pk_bf16_f32 v101, v74, v75
v_cvt_pk_bf16_f32 v102, v76, v77
v_cvt_pk_bf16_f32 v103, v78, v79
s_waitcnt lgkmcnt(0)
v_mfma_f32_32x32x16_bf16 v[64:79], v[48:51], v[40:43], 0
v_exp_f32 v80, v80
v_exp_f32 v81, v81
v_exp_f32 v82, v82
v_exp_f32 v83, v83
v_mfma_f32_32x32x8_bf16 v[64:79], v[52:53], v[44:45], v[64:79]
v_exp_f32 v84, v84
v_exp_f32 v85, v85
ds_read_b128 v[56:59], v10 offset:13824
ds_read_b64 v[60:61], v11 offset:6912
v_exp_f32 v86, v86
v_exp_f32 v87, v87
v_mfma_f32_32x32x16_bf16 v[120:135], v[104:107], v[96:99], v[120:135]
v_exp_f32 v88, v88
v_exp_f32 v89, v89
ds_read_b128 v[112:115], v12 offset:30400
ds_read_b128 v[116:119], v12 offset:31008
v_exp_f32 v90, v90
v_exp_f32 v91, v91
v_mfma_f32_32x32x16_bf16 v[120:135], v[108:111], v[100:103], v[120:135]
v_exp_f32 v92, v92
v_exp_f32 v93, v93
v_exp_f32 v94, v94
v_exp_f32 v95, v95
v_cvt_pk_bf16_f32 v140, v80, v81
v_cvt_pk_bf16_f32 v141, v82, v83
v_cvt_pk_bf16_f32 v142, v84, v85
v_cvt_pk_bf16_f32 v143, v86, v87
v_cvt_pk_bf16_f32 v144, v88, v89
v_cvt_pk_bf16_f32 v145, v90, v91
v_cvt_pk_bf16_f32 v146, v92, v93
v_cvt_pk_bf16_f32 v147, v94, v95
s_waitcnt lgkmcnt(0)
v_mfma_f32_32x32x16_bf16 v[80:95], v[56:59], v[40:43], 0
v_exp_f32 v64, v64
v_exp_f32 v65, v65
v_exp_f32 v66, v66
v_exp_f32 v67, v67
v_mfma_f32_32x32x8_bf16 v[80:95], v[60:61], v[44:45], v[80:95]
v_exp_f32 v68, v68
v_exp_f32 v69, v69
ds_read_b128 v[48:51], v10 offset:14336
ds_read_b64 v[52:53], v11 offset:7168
v_exp_f32 v70, v70
v_exp_f32 v71, v71
v_mfma_f32_32x32x16_bf16 v[120:135], v[112:115], v[140:143], v[120:135]
v_exp_f32 v72, v72
v_exp_f32 v73, v73
ds_read_b128 v[104:107], v12 offset:31616
ds_read_b128 v[108:111], v12 offset:32224
v_exp_f32 v74, v74
v_exp_f32 v75, v75
v_mfma_f32_32x32x16_bf16 v[120:135], v[116:119], v[144:147], v[120:135]
v_exp_f32 v76, v76
v_exp_f32 v77, v77
v_exp_f32 v78, v78
v_exp_f32 v79, v79
v_cvt_pk_bf16_f32 v96, v64, v65
v_cvt_pk_bf16_f32 v97, v66, v67
v_cvt_pk_bf16_f32 v98, v68, v69
v_cvt_pk_bf16_f32 v99, v70, v71
v_cvt_pk_bf16_f32 v100, v72, v73
v_cvt_pk_bf16_f32 v101, v74, v75
v_cvt_pk_bf16_f32 v102, v76, v77
v_cvt_pk_bf16_f32 v103, v78, v79
s_waitcnt lgkmcnt(0)
v_mfma_f32_32x32x16_bf16 v[64:79], v[48:51], v[40:43], 0
v_exp_f32 v80, v80
v_exp_f32 v81, v81
v_exp_f32 v82, v82
v_exp_f32 v83, v83
v_mfma_f32_32x32x8_bf16 v[64:79], v[52:53], v[44:45], v[64:79]
v_exp_f32 v84, v84
v_exp_f32 v85, v85
ds_read_b128 v[56:59], v10 offset:14848
ds_read_b64 v[60:61], v11 offset:7424
v_exp_f32 v86, v86
v_exp_f32 v87, v87
v_mfma_f32_32x32x16_bf16 v[120:135], v[104:107], v[96:99], v[120:135]
v_exp_f32 v88, v88
v_exp_f32 v89, v89
ds_read_b128 v[112:115], v12 offset:32832
ds_read_b128 v[116:119], v12 offset:33440
v_exp_f32 v90, v90
v_exp_f32 v91, v91
v_mfma_f32_32x32x16_bf16 v[120:135], v[108:111], v[100:103], v[120:135]
v_exp_f32 v92, v92
v_exp_f32 v93, v93
v_exp_f32 v94, v94
v_exp_f32 v95, v95
v_cvt_pk_bf16_f32 v140, v80, v81
v_cvt_pk_bf16_f32 v141, v82, v83
v_cvt_pk_bf16_f32 v142, v84, v85
v_cvt_pk_bf16_f32 v143, v86, v87
v_cvt_pk_bf16_f32 v144, v88, v89
v_cvt_pk_bf16_f32 v145, v90, v91
v_cvt_pk_bf16_f32 v146, v92, v93
v_cvt_pk_bf16_f32 v147, v94, v95
s_waitcnt lgkmcnt(0)
v_mfma_f32_32x32x16_bf16 v[80:95], v[56:59], v[40:43], 0
v_exp_f32 v64, v64
v_exp_f32 v65, v65
v_exp_f32 v66, v66
v_exp_f32 v67, v67
v_mfma_f32_32x32x8_bf16 v[80:95], v[60:61], v[44:45], v[80:95]
v_exp_f32 v68, v68
v_exp_f32 v69, v69
ds_read_b128 v[48:51], v10 offset:15360
ds_read_b64 v[52:53], v11 offset:7680
v_exp_f32 v70, v70
v_exp_f32 v71, v71
v_mfma_f32_32x32x16_bf16 v[120:135], v[112:115], v[140:143], v[120:135]
v_exp_f32 v72, v72
v_exp_f32 v73, v73
ds_read_b128 v[104:107], v12 offset:34048
ds_read_b128 v[108:111], v12 offset:34656
v_exp_f32 v74, v74
v_exp_f32 v75, v75
v_mfma_f32_32x32x16_bf16 v[120:135], v[116:119], v[144:147], v[120:135]
v_exp_f32 v76, v76
v_exp_f32 v77, v77
v_exp_f32 v78, v78
v_exp_f32 v79, v79
v_cvt_pk_bf16_f32 v96, v64, v65
v_cvt_pk_bf16_f32 v97, v66, v67
v_cvt_pk_bf16_f32 v98, v68, v69
v_cvt_pk_bf16_f32 v99, v70, v71
v_cvt_pk_bf16_f32 v100, v72, v73
v_cvt_pk_bf16_f32 v101, v74, v75
v_cvt_pk_bf16_f32 v102, v76, v77
v_cvt_pk_bf16_f32 v103, v78, v79
s_waitcnt lgkmcnt(0)
v_mfma_f32_32x32x16_bf16 v[64:79], v[48:51], v[40:43], 0
v_exp_f32 v80, v80
v_exp_f32 v81, v81
v_exp_f32 v82, v82
v_exp_f32 v83, v83
v_mfma_f32_32x32x8_bf16 v[64:79], v[52:53], v[44:45], v[64:79]
v_exp_f32 v84, v84
v_exp_f32 v85, v85
ds_read_b128 v[56:59], v10 offset:15872
ds_read_b64 v[60:61], v11 offset:7936
v_exp_f32 v86, v86
v_exp_f32 v87, v87
v_mfma_f32_32x32x16_bf16 v[120:135], v[104:107], v[96:99], v[120:135]
v_exp_f32 v88, v88
v_exp_f32 v89, v89
ds_read_b128 v[112:115], v12 offset:35264
ds_read_b128 v[116:119], v12 offset:35872
v_exp_f32 v90, v90
v_exp_f32 v91, v91
v_mfma_f32_32x32x16_bf16 v[120:135], v[108:111], v[100:103], v[120:135]
v_exp_f32 v92, v92
v_exp_f32 v93, v93
v_exp_f32 v94, v94
v_exp_f32 v95, v95
v_cvt_pk_bf16_f32 v140, v80, v81
v_cvt_pk_bf16_f32 v141, v82, v83
v_cvt_pk_bf16_f32 v142, v84, v85
v_cvt_pk_bf16_f32 v143, v86, v87
v_cvt_pk_bf16_f32 v144, v88, v89
v_cvt_pk_bf16_f32 v145, v90, v91
v_cvt_pk_bf16_f32 v146, v92, v93
v_cvt_pk_bf16_f32 v147, v94, v95
s_waitcnt lgkmcnt(0)
v_mfma_f32_32x32x16_bf16 v[80:95], v[56:59], v[40:43], 0
v_exp_f32 v64, v64
v_exp_f32 v65, v65
v_exp_f32 v66, v66
v_exp_f32 v67, v67
v_mfma_f32_32x32x8_bf16 v[80:95], v[60:61], v[44:45], v[80:95]
v_exp_f32 v68, v68
v_exp_f32 v69, v69
ds_read_b128 v[48:51], v10 offset:16384
ds_read_b64 v[52:53], v11 offset:8192
v_exp_f32 v70, v70
v_exp_f32 v71, v71
v_mfma_f32_32x32x16_bf16 v[120:135], v[112:115], v[140:143], v[120:135]
v_exp_f32 v72, v72
v_exp_f32 v73, v73
ds_read_b128 v[104:107], v12 offset:36480
ds_read_b128 v[108:111], v12 offset:37088
v_exp_f32 v74, v74
v_exp_f32 v75, v75
v_mfma_f32_32x32x16_bf16 v[120:135], v[116:119], v[144:147], v[120:135]
v_exp_f32 v76, v76
v_exp_f32 v77, v77
v_exp_f32 v78, v78
v_exp_f32 v79, v79
v_cvt_pk_bf16_f32 v96, v64, v65
v_cvt_pk_bf16_f32 v97, v66, v67
v_cvt_pk_bf16_f32 v98, v68, v69
v_cvt_pk_bf16_f32 v99, v70, v71
v_cvt_pk_bf16_f32 v100, v72, v73
v_cvt_pk_bf16_f32 v101, v74, v75
v_cvt_pk_bf16_f32 v102, v76, v77
v_cvt_pk_bf16_f32 v103, v78, v79
s_waitcnt lgkmcnt(0)
v_mfma_f32_32x32x16_bf16 v[64:79], v[48:51], v[40:43], 0
v_exp_f32 v80, v80
v_exp_f32 v81, v81
v_exp_f32 v82, v82
v_exp_f32 v83, v83
v_mfma_f32_32x32x8_bf16 v[64:79], v[52:53], v[44:45], v[64:79]
v_exp_f32 v84, v84
v_exp_f32 v85, v85
ds_read_b128 v[56:59], v10 offset:16896
ds_read_b64 v[60:61], v11 offset:8448
v_exp_f32 v86, v86
v_exp_f32 v87, v87
v_mfma_f32_32x32x16_bf16 v[120:135], v[104:107], v[96:99], v[120:135]
v_exp_f32 v88, v88
v_exp_f32 v89, v89
ds_read_b128 v[112:115], v12 offset:37696
ds_read_b128 v[116:119], v12 offset:38304
v_exp_f32 v90, v90
v_exp_f32 v91, v91
v_mfma_f32_32x32x16_bf16 v[120:135], v[108:111], v[100:103], v[120:135]
v_exp_f32 v92, v92
v_exp_f32 v93, v93
v_exp_f32 v94, v94
v_exp_f32 v95, v95
v_cvt_pk_bf16_f32 v140, v80, v81
v_cvt_pk_bf16_f32 v141, v82, v83
v_cvt_pk_bf16_f32 v142, v84, v85
v_cvt_pk_bf16_f32 v143, v86, v87
v_cvt_pk_bf16_f32 v144, v88, v89
v_cvt_pk_bf16_f32 v145, v90, v91
v_cvt_pk_bf16_f32 v146, v92, v93
v_cvt_pk_bf16_f32 v147, v94, v95
s_waitcnt lgkmcnt(0)
v_mfma_f32_32x32x16_bf16 v[80:95], v[56:59], v[40:43], 0
v_exp_f32 v64, v64
v_exp_f32 v65, v65
v_exp_f32 v66, v66
v_exp_f32 v67, v67
v_mfma_f32_32x32x8_bf16 v[80:95], v[60:61], v[44:45], v[80:95]
v_exp_f32 v68, v68
v_exp_f32 v69, v69
ds_read_b128 v[48:51], v10 offset:17408
ds_read_b64 v[52:53], v11 offset:8704
v_exp_f32 v70, v70
v_exp_f32 v71, v71
v_mfma_f32_32x32x16_bf16 v[120:135], v[112:115], v[140:143], v[120:135]
v_exp_f32 v72, v72
v_exp_f32 v73, v73
ds_read_b128 v[104:107], v13 offset:0
ds_read_b128 v[108:111], v13 offset:608
v_exp_f32 v74, v74
v_exp_f32 v75, v75
v_mfma_f32_32x32x16_bf16 v[120:135], v[116:119], v[144:147], v[120:135]
v_exp_f32 v76, v76
v_exp_f32 v77, v77
v_exp_f32 v78, v78
v_exp_f32 v79, v79
v_cvt_pk_bf16_f32 v96, v64, v65
v_cvt_pk_bf16_f32 v97, v66, v67
v_cvt_pk_bf16_f32 v98, v68, v69
v_cvt_pk_bf16_f32 v99, v70, v71
v_cvt_pk_bf16_f32 v100, v72, v73
v_cvt_pk_bf16_f32 v101, v74, v75
v_cvt_pk_bf16_f32 v102, v76, v77
v_cvt_pk_bf16_f32 v103, v78, v79
s_waitcnt lgkmcnt(0)
v_mfma_f32_32x32x16_bf16 v[64:79], v[48:51], v[40:43], 0
v_exp_f32 v80, v80
v_exp_f32 v81, v81
v_exp_f32 v82, v82
v_exp_f32 v83, v83
v_mfma_f32_32x32x8_bf16 v[64:79], v[52:53], v[44:45], v[64:79]
v_exp_f32 v84, v84
v_exp_f32 v85, v85
ds_read_b128 v[56:59], v10 offset:17920
ds_read_b64 v[60:61], v11 offset:8960
v_exp_f32 v86, v86
v_exp_f32 v87, v87
v_mfma_f32_32x32x16_bf16 v[120:135], v[104:107], v[96:99], v[120:135]
v_exp_f32 v88, v88
v_exp_f32 v89, v89
ds_read_b128 v[112:115], v13 offset:1216
ds_read_b128 v[116:119], v13 offset:1824
v_exp_f32 v90, v90
v_exp_f32 v91, v91
v_mfma_f32_32x32x16_bf16 v[120:135], v[108:111], v[100:103], v[120:135]
v_exp_f32 v92, v92
v_exp_f32 v93, v93
v_exp_f32 v94, v94
v_exp_f32 v95, v95
v_cvt_pk_bf16_f32 v140, v80, v81
v_cvt_pk_bf16_f32 v141, v82, v83
v_cvt_pk_bf16_f32 v142, v84, v85
v_cvt_pk_bf16_f32 v143, v86, v87
v_cvt_pk_bf16_f32 v144, v88, v89
v_cvt_pk_bf16_f32 v145, v90, v91
v_cvt_pk_bf16_f32 v146, v92, v93
v_cvt_pk_bf16_f32 v147, v94, v95
s_waitcnt lgkmcnt(0)
v_mfma_f32_32x32x16_bf16 v[80:95], v[56:59], v[40:43], 0
v_exp_f32 v64, v64
v_exp_f32 v65, v65
v_exp_f32 v66, v66
v_exp_f32 v67, v67
v_mfma_f32_32x32x8_bf16 v[80:95], v[60:61], v[44:45], v[80:95]
v_exp_f32 v68, v68
v_exp_f32 v69, v69
ds_read_b128 v[48:51], v10 offset:18432
ds_read_b64 v[52:53], v11 offset:9216
v_exp_f32 v70, v70
v_exp_f32 v71, v71
v_mfma_f32_32x32x16_bf16 v[120:135], v[112:115], v[140:143], v[120:135]
v_exp_f32 v72, v72
v_exp_f32 v73, v73
ds_read_b128 v[104:107], v13 offset:2432
ds_read_b128 v[108:111], v13 offset:3040
v_exp_f32 v74, v74
v_exp_f32 v75, v75
v_mfma_f32_32x32x16_bf16 v[120:135], v[116:119], v[144:147], v[120:135]
v_exp_f32 v76, v76
v_exp_f32 v77, v77
v_exp_f32 v78, v78
v_exp_f32 v79, v79
v_cvt_pk_bf16_f32 v96, v64, v65
v_cvt_pk_bf16_f32 v97, v66, v67
v_cvt_pk_bf16_f32 v98, v68, v69
v_cvt_pk_bf16_f32 v99, v70, v71
v_cvt_pk_bf16_f32 v100, v72, v73
v_cvt_pk_bf16_f32 v101, v74, v75
v_cvt_pk_bf16_f32 v102, v76, v77
v_cvt_pk_bf16_f32 v103, v78, v79
s_waitcnt lgkmcnt(0)
v_mfma_f32_32x32x16_bf16 v[64:79], v[48:51], v[40:43], 0
v_exp_f32 v80, v80
v_exp_f32 v81, v81
v_exp_f32 v82, v82
v_exp_f32 v83, v83
v_mfma_f32_32x32x8_bf16 v[64:79], v[52:53], v[44:45], v[64:79]
v_exp_f32 v84, v84
v_exp_f32 v85, v85
ds_read_b128 v[56:59], v10 offset:18944
ds_read_b64 v[60:61], v11 offset:9472
v_exp_f32 v86, v86
v_exp_f32 v87, v87
v_mfma_f32_32x32x16_bf16 v[120:135], v[104:107], v[96:99], v[120:135]
v_exp_f32 v88, v88
v_exp_f32 v89, v89
ds_read_b128 v[112:115], v13 offset:3648
ds_read_b128 v[116:119], v13 offset:4256
v_exp_f32 v90, v90
v_exp_f32 v91, v91
v_mfma_f32_32x32x16_bf16 v[120:135], v[108:111], v[100:103], v[120:135]
v_exp_f32 v92, v92
v_exp_f32 v93, v93
v_exp_f32 v94, v94
v_exp_f32 v95, v95
v_cvt_pk_bf16_f32 v140, v80, v81
v_cvt_pk_bf16_f32 v141, v82, v83
v_cvt_pk_bf16_f32 v142, v84, v85
v_cvt_pk_bf16_f32 v143, v86, v87
v_cvt_pk_bf16_f32 v144, v88, v89
v_cvt_pk_bf16_f32 v145, v90, v91
v_cvt_pk_bf16_f32 v146, v92, v93
v_cvt_pk_bf16_f32 v147, v94, v95
s_waitcnt lgkmcnt(0)
v_mfma_f32_32x32x16_bf16 v[80:95], v[56:59], v[40:43], 0
v_exp_f32 v64, v64
v_exp_f32 v65, v65
v_exp_f32 v66, v66
v_exp_f32 v67, v67
v_mfma_f32_32x32x8_bf16 v[80:95], v[60:61], v[44:45], v[80:95]
v_exp_f32 v68, v68
v_exp_f32 v69, v69
ds_read_b128 v[48:51], v10 offset:19456
ds_read_b64 v[52:53], v11 offset:9728
v_exp_f32 v70, v70
v_exp_f32 v71, v71
v_mfma_f32_32x32x16_bf16 v[120:135], v[112:115], v[140:143], v[120:135]
v_exp_f32 v72, v72
v_exp_f32 v73, v73
ds_read_b128 v[104:107], v13 offset:4864
ds_read_b128 v[108:111], v13 offset:5472
v_exp_f32 v74, v74
v_exp_f32 v75, v75
v_mfma_f32_32x32x16_bf16 v[120:135], v[116:119], v[144:147], v[120:135]
v_exp_f32 v76, v76
v_exp_f32 v77, v77
v_exp_f32 v78, v78
v_exp_f32 v79, v79
v_cvt_pk_bf16_f32 v96, v64, v65
v_cvt_pk_bf16_f32 v97, v66, v67
v_cvt_pk_bf16_f32 v98, v68, v69
v_cvt_pk_bf16_f32 v99, v70, v71
v_cvt_pk_bf16_f32 v100, v72, v73
v_cvt_pk_bf16_f32 v101, v74, v75
v_cvt_pk_bf16_f32 v102, v76, v77
v_cvt_pk_bf16_f32 v103, v78, v79
s_waitcnt lgkmcnt(0)
v_mfma_f32_32x32x16_bf16 v[64:79], v[48:51], v[40:43], 0
v_exp_f32 v80, v80
v_exp_f32 v81, v81
v_exp_f32 v82, v82
v_exp_f32 v83, v83
v_mfma_f32_32x32x8_bf16 v[64:79], v[52:53], v[44:45], v[64:79]
v_exp_f32 v84, v84
v_exp_f32 v85, v85
ds_read_b128 v[56:59], v10 offset:19968
ds_read_b64 v[60:61], v11 offset:9984
v_exp_f32 v86, v86
v_exp_f32 v87, v87
v_mfma_f32_32x32x16_bf16 v[120:135], v[104:107], v[96:99], v[120:135]
v_exp_f32 v88, v88
v_exp_f32 v89, v89
ds_read_b128 v[112:115], v13 offset:6080
ds_read_b128 v[116:119], v13 offset:6688
v_exp_f32 v90, v90
v_exp_f32 v91, v91
v_mfma_f32_32x32x16_bf16 v[120:135], v[108:111], v[100:103], v[120:135]
v_exp_f32 v92, v92
v_exp_f32 v93, v93
v_exp_f32 v94, v94
v_exp_f32 v95, v95
v_cvt_pk_bf16_f32 v140, v80, v81
v_cvt_pk_bf16_f32 v141, v82, v83
v_cvt_pk_bf16_f32 v142, v84, v85
v_cvt_pk_bf16_f32 v143, v86, v87
v_cvt_pk_bf16_f32 v144, v88, v89
v_cvt_pk_bf16_f32 v145, v90, v91
v_cvt_pk_bf16_f32 v146, v92, v93
v_cvt_pk_bf16_f32 v147, v94, v95
s_waitcnt lgkmcnt(0)
v_mfma_f32_32x32x16_bf16 v[80:95], v[56:59], v[40:43], 0
v_exp_f32 v64, v64
v_exp_f32 v65, v65
v_exp_f32 v66, v66
v_exp_f32 v67, v67
v_mfma_f32_32x32x8_bf16 v[80:95], v[60:61], v[44:45], v[80:95]
v_exp_f32 v68, v68
v_exp_f32 v69, v69
ds_read_b128 v[48:51], v10 offset:20480
ds_read_b64 v[52:53], v11 offset:10240
v_exp_f32 v70, v70
v_exp_f32 v71, v71
v_mfma_f32_32x32x16_bf16 v[120:135], v[112:115], v[140:143], v[120:135]
v_exp_f32 v72, v72
v_exp_f32 v73, v73
ds_read_b128 v[104:107], v13 offset:7296
ds_read_b128 v[108:111], v13 offset:7904
v_exp_f32 v74, v74
v_exp_f32 v75, v75
v_mfma_f32_32x32x16_bf16 v[120:135], v[116:119], v[144:147], v[120:135]
v_exp_f32 v76, v76
v_exp_f32 v77, v77
v_exp_f32 v78, v78
v_exp_f32 v79, v79
v_cvt_pk_bf16_f32 v96, v64, v65
v_cvt_pk_bf16_f32 v97, v66, v67
v_cvt_pk_bf16_f32 v98, v68, v69
v_cvt_pk_bf16_f32 v99, v70, v71
v_cvt_pk_bf16_f32 v100, v72, v73
v_cvt_pk_bf16_f32 v101, v74, v75
v_cvt_pk_bf16_f32 v102, v76, v77
v_cvt_pk_bf16_f32 v103, v78, v79
s_waitcnt lgkmcnt(0)
v_mfma_f32_32x32x16_bf16 v[64:79], v[48:51], v[40:43], 0
v_exp_f32 v80, v80
v_exp_f32 v81, v81
v_exp_f32 v82, v82
v_exp_f32 v83, v83
v_mfma_f32_32x32x8_bf16 v[64:79], v[52:53], v[44:45], v[64:79]
v_exp_f32 v84, v84
v_exp_f32 v85, v85
ds_read_b128 v[56:59], v10 offset:20992
ds_read_b64 v[60:61], v11 offset:10496
v_exp_f32 v86, v86
v_exp_f32 v87, v87
v_mfma_f32_32x32x16_bf16 v[120:135], v[104:107], v[96:99], v[120:135]
v_exp_f32 v88, v88
v_exp_f32 v89, v89
ds_read_b128 v[112:115], v13 offset:8512
ds_read_b128 v[116:119], v13 offset:9120
v_exp_f32 v90, v90
v_exp_f32 v91, v91
v_mfma_f32_32x32x16_bf16 v[120:135], v[108:111], v[100:103], v[120:135]
v_exp_f32 v92, v92
v_exp_f32 v93, v93
v_exp_f32 v94, v94
v_exp_f32 v95, v95
v_cvt_pk_bf16_f32 v140, v80, v81
v_cvt_pk_bf16_f32 v141, v82, v83
v_cvt_pk_bf16_f32 v142, v84, v85
v_cvt_pk_bf16_f32 v143, v86, v87
v_cvt_pk_bf16_f32 v144, v88, v89
v_cvt_pk_bf16_f32 v145, v90, v91
v_cvt_pk_bf16_f32 v146, v92, v93
v_cvt_pk_bf16_f32 v147, v94, v95
s_waitcnt lgkmcnt(0)
v_mfma_f32_32x32x16_bf16 v[80:95], v[56:59], v[40:43], 0
v_exp_f32 v64, v64
v_exp_f32 v65, v65
v_exp_f32 v66, v66
v_exp_f32 v67, v67
v_mfma_f32_32x32x8_bf16 v[80:95], v[60:61], v[44:45], v[80:95]
v_exp_f32 v68, v68
v_exp_f32 v69, v69
ds_read_b128 v[48:51], v10 offset:21504
ds_read_b64 v[52:53], v11 offset:10752
v_exp_f32 v70, v70
v_exp_f32 v71, v71
v_mfma_f32_32x32x16_bf16 v[120:135], v[112:115], v[140:143], v[120:135]
v_exp_f32 v72, v72
v_exp_f32 v73, v73
ds_read_b128 v[104:107], v13 offset:9728
ds_read_b128 v[108:111], v13 offset:10336
v_exp_f32 v74, v74
v_exp_f32 v75, v75
v_mfma_f32_32x32x16_bf16 v[120:135], v[116:119], v[144:147], v[120:135]
v_exp_f32 v76, v76
v_exp_f32 v77, v77
v_exp_f32 v78, v78
v_exp_f32 v79, v79
v_cvt_pk_bf16_f32 v96, v64, v65
v_cvt_pk_bf16_f32 v97, v66, v67
v_cvt_pk_bf16_f32 v98, v68, v69
v_cvt_pk_bf16_f32 v99, v70, v71
v_cvt_pk_bf16_f32 v100, v72, v73
v_cvt_pk_bf16_f32 v101, v74, v75
v_cvt_pk_bf16_f32 v102, v76, v77
v_cvt_pk_bf16_f32 v103, v78, v79
s_waitcnt lgkmcnt(0)
v_mfma_f32_32x32x16_bf16 v[64:79], v[48:51], v[40:43], 0
v_exp_f32 v80, v80
v_exp_f32 v81, v81
v_exp_f32 v82, v82
v_exp_f32 v83, v83
v_mfma_f32_32x32x8_bf16 v[64:79], v[52:53], v[44:45], v[64:79]
v_exp_f32 v84, v84
v_exp_f32 v85, v85
ds_read_b128 v[56:59], v10 offset:22016
ds_read_b64 v[60:61], v11 offset:11008
v_exp_f32 v86, v86
v_exp_f32 v87, v87
v_mfma_f32_32x32x16_bf16 v[120:135], v[104:107], v[96:99], v[120:135]
v_exp_f32 v88, v88
v_exp_f32 v89, v89
ds_read_b128 v[112:115], v13 offset:10944
ds_read_b128 v[116:119], v13 offset:11552
v_exp_f32 v90, v90
v_exp_f32 v91, v91
v_mfma_f32_32x32x16_bf16 v[120:135], v[108:111], v[100:103], v[120:135]
v_exp_f32 v92, v92
v_exp_f32 v93, v93
v_exp_f32 v94, v94
v_exp_f32 v95, v95
v_cvt_pk_bf16_f32 v140, v80, v81
v_cvt_pk_bf16_f32 v141, v82, v83
v_cvt_pk_bf16_f32 v142, v84, v85
v_cvt_pk_bf16_f32 v143, v86, v87
v_cvt_pk_bf16_f32 v144, v88, v89
v_cvt_pk_bf16_f32 v145, v90, v91
v_cvt_pk_bf16_f32 v146, v92, v93
v_cvt_pk_bf16_f32 v147, v94, v95
s_waitcnt lgkmcnt(0)
v_mfma_f32_32x32x16_bf16 v[80:95], v[56:59], v[40:43], 0
v_exp_f32 v64, v64
v_exp_f32 v65, v65
v_exp_f32 v66, v66
v_exp_f32 v67, v67
v_mfma_f32_32x32x8_bf16 v[80:95], v[60:61], v[44:45], v[80:95]
v_exp_f32 v68, v68
v_exp_f32 v69, v69
ds_read_b128 v[48:51], v10 offset:22528
ds_read_b64 v[52:53], v11 offset:11264
v_exp_f32 v70, v70
v_exp_f32 v71, v71
v_mfma_f32_32x32x16_bf16 v[120:135], v[112:115], v[140:143], v[120:135]
v_exp_f32 v72, v72
v_exp_f32 v73, v73
ds_read_b128 v[104:107], v13 offset:12160
ds_read_b128 v[108:111], v13 offset:12768
v_exp_f32 v74, v74
v_exp_f32 v75, v75
v_mfma_f32_32x32x16_bf16 v[120:135], v[116:119], v[144:147], v[120:135]
v_exp_f32 v76, v76
v_exp_f32 v77, v77
v_exp_f32 v78, v78
v_exp_f32 v79, v79
v_cvt_pk_bf16_f32 v96, v64, v65
v_cvt_pk_bf16_f32 v97, v66, v67
v_cvt_pk_bf16_f32 v98, v68, v69
v_cvt_pk_bf16_f32 v99, v70, v71
v_cvt_pk_bf16_f32 v100, v72, v73
v_cvt_pk_bf16_f32 v101, v74, v75
v_cvt_pk_bf16_f32 v102, v76, v77
v_cvt_pk_bf16_f32 v103, v78, v79
s_waitcnt lgkmcnt(0)
v_mfma_f32_32x32x16_bf16 v[64:79], v[48:51], v[40:43], 0
v_exp_f32 v80, v80
v_exp_f32 v81, v81
v_exp_f32 v82, v82
v_exp_f32 v83, v83
v_mfma_f32_32x32x8_bf16 v[64:79], v[52:53], v[44:45], v[64:79]
v_exp_f32 v84, v84
v_exp_f32 v85, v85
ds_read_b128 v[56:59], v10 offset:23040
ds_read_b64 v[60:61], v11 offset:11520
v_exp_f32 v86, v86
v_exp_f32 v87, v87
v_mfma_f32_32x32x16_bf16 v[120:135], v[104:107], v[96:99], v[120:135]
v_exp_f32 v88, v88
v_exp_f32 v89, v89
ds_read_b128 v[112:115], v13 offset:13376
ds_read_b128 v[116:119], v13 offset:13984
v_exp_f32 v90, v90
v_exp_f32 v91, v91
v_mfma_f32_32x32x16_bf16 v[120:135], v[108:111], v[100:103], v[120:135]
v_exp_f32 v92, v92
v_exp_f32 v93, v93
v_exp_f32 v94, v94
v_exp_f32 v95, v95
v_cvt_pk_bf16_f32 v140, v80, v81
v_cvt_pk_bf16_f32 v141, v82, v83
v_cvt_pk_bf16_f32 v142, v84, v85
v_cvt_pk_bf16_f32 v143, v86, v87
v_cvt_pk_bf16_f32 v144, v88, v89
v_cvt_pk_bf16_f32 v145, v90, v91
v_cvt_pk_bf16_f32 v146, v92, v93
v_cvt_pk_bf16_f32 v147, v94, v95
s_waitcnt lgkmcnt(0)
v_mfma_f32_32x32x16_bf16 v[80:95], v[56:59], v[40:43], 0
v_exp_f32 v64, v64
v_exp_f32 v65, v65
v_exp_f32 v66, v66
v_exp_f32 v67, v67
v_mfma_f32_32x32x8_bf16 v[80:95], v[60:61], v[44:45], v[80:95]
v_exp_f32 v68, v68
v_exp_f32 v69, v69
ds_read_b128 v[48:51], v10 offset:23552
ds_read_b64 v[52:53], v11 offset:11776
v_exp_f32 v70, v70
v_exp_f32 v71, v71
v_mfma_f32_32x32x16_bf16 v[120:135], v[112:115], v[140:143], v[120:135]
v_exp_f32 v72, v72
v_exp_f32 v73, v73
ds_read_b128 v[104:107], v13 offset:14592
ds_read_b128 v[108:111], v13 offset:15200
v_exp_f32 v74, v74
v_exp_f32 v75, v75
v_mfma_f32_32x32x16_bf16 v[120:135], v[116:119], v[144:147], v[120:135]
v_exp_f32 v76, v76
v_exp_f32 v77, v77
v_exp_f32 v78, v78
v_exp_f32 v79, v79
v_cvt_pk_bf16_f32 v96, v64, v65
v_cvt_pk_bf16_f32 v97, v66, v67
v_cvt_pk_bf16_f32 v98, v68, v69
v_cvt_pk_bf16_f32 v99, v70, v71
v_cvt_pk_bf16_f32 v100, v72, v73
v_cvt_pk_bf16_f32 v101, v74, v75
v_cvt_pk_bf16_f32 v102, v76, v77
v_cvt_pk_bf16_f32 v103, v78, v79
s_waitcnt lgkmcnt(0)
v_mfma_f32_32x32x16_bf16 v[64:79], v[48:51], v[40:43], 0
v_exp_f32 v80, v80
v_exp_f32 v81, v81
v_exp_f32 v82, v82
v_exp_f32 v83, v83
v_mfma_f32_32x32x8_bf16 v[64:79], v[52:53], v[44:45], v[64:79]
v_exp_f32 v84, v84
v_exp_f32 v85, v85
ds_read_b128 v[56:59], v10 offset:24064
ds_read_b64 v[60:61], v11 offset:12032
v_exp_f32 v86, v86
v_exp_f32 v87, v87
v_mfma_f32_32x32x16_bf16 v[120:135], v[104:107], v[96:99], v[120:135]
v_exp_f32 v88, v88
v_exp_f32 v89, v89
ds_read_b128 v[112:115], v13 offset:15808
ds_read_b128 v[116:119], v13 offset:16416
v_exp_f32 v90, v90
v_exp_f32 v91, v91
v_mfma_f32_32x32x16_bf16 v[120:135], v[108:111], v[100:103], v[120:135]
v_exp_f32 v92, v92
v_exp_f32 v93, v93
v_exp_f32 v94, v94
v_exp_f32 v95, v95
v_cvt_pk_bf16_f32 v140, v80, v81
v_cvt_pk_bf16_f32 v141, v82, v83
v_cvt_pk_bf16_f32 v142, v84, v85
v_cvt_pk_bf16_f32 v143, v86, v87
v_cvt_pk_bf16_f32 v144, v88, v89
v_cvt_pk_bf16_f32 v145, v90, v91
v_cvt_pk_bf16_f32 v146, v92, v93
v_cvt_pk_bf16_f32 v147, v94, v95
s_waitcnt lgkmcnt(0)
v_mfma_f32_32x32x16_bf16 v[80:95], v[56:59], v[40:43], 0
v_exp_f32 v64, v64
v_exp_f32 v65, v65
v_exp_f32 v66, v66
v_exp_f32 v67, v67
v_mfma_f32_32x32x8_bf16 v[80:95], v[60:61], v[44:45], v[80:95]
v_exp_f32 v68, v68
v_exp_f32 v69, v69
ds_read_b128 v[48:51], v10 offset:24576
ds_read_b64 v[52:53], v11 offset:12288
v_exp_f32 v70, v70
v_exp_f32 v71, v71
v_mfma_f32_32x32x16_bf16 v[120:135], v[112:115], v[140:143], v[120:135]
v_exp_f32 v72, v72
v_exp_f32 v73, v73
ds_read_b128 v[104:107], v13 offset:17024
ds_read_b128 v[108:111], v13 offset:17632
v_exp_f32 v74, v74
v_exp_f32 v75, v75
v_mfma_f32_32x32x16_bf16 v[120:135], v[116:119], v[144:147], v[120:135]
v_exp_f32 v76, v76
v_exp_f32 v77, v77
v_exp_f32 v78, v78
v_exp_f32 v79, v79
v_cvt_pk_bf16_f32 v96, v64, v65
v_cvt_pk_bf16_f32 v97, v66, v67
v_cvt_pk_bf16_f32 v98, v68, v69
v_cvt_pk_bf16_f32 v99, v70, v71
v_cvt_pk_bf16_f32 v100, v72, v73
v_cvt_pk_bf16_f32 v101, v74, v75
v_cvt_pk_bf16_f32 v102, v76, v77
v_cvt_pk_bf16_f32 v103, v78, v79
s_waitcnt lgkmcnt(0)
v_mfma_f32_32x32x16_bf16 v[64:79], v[48:51], v[40:43], 0
v_exp_f32 v80, v80
v_exp_f32 v81, v81
v_exp_f32 v82, v82
v_exp_f32 v83, v83
v_mfma_f32_32x32x8_bf16 v[64:79], v[52:53], v[44:45], v[64:79]
v_exp_f32 v84, v84
v_exp_f32 v85, v85
ds_read_b128 v[56:59], v10 offset:25088
ds_read_b64 v[60:61], v11 offset:12544
v_exp_f32 v86, v86
v_exp_f32 v87, v87
v_mfma_f32_32x32x16_bf16 v[120:135], v[104:107], v[96:99], v[120:135]
v_exp_f32 v88, v88
v_exp_f32 v89, v89
ds_read_b128 v[112:115], v13 offset:18240
ds_read_b128 v[116:119], v13 offset:18848
v_exp_f32 v90, v90
v_exp_f32 v91, v91
v_mfma_f32_32x32x16_bf16 v[120:135], v[108:111], v[100:103], v[120:135]
v_exp_f32 v92, v92
v_exp_f32 v93, v93
v_exp_f32 v94, v94
v_exp_f32 v95, v95
v_cvt_pk_bf16_f32 v140, v80, v81
v_cvt_pk_bf16_f32 v141, v82, v83
v_cvt_pk_bf16_f32 v142, v84, v85
v_cvt_pk_bf16_f32 v143, v86, v87
v_cvt_pk_bf16_f32 v144, v88, v89
v_cvt_pk_bf16_f32 v145, v90, v91
v_cvt_pk_bf16_f32 v146, v92, v93
v_cvt_pk_bf16_f32 v147, v94, v95
s_waitcnt lgkmcnt(0)
v_mfma_f32_32x32x16_bf16 v[80:95], v[56:59], v[40:43], 0
v_exp_f32 v64, v64
v_exp_f32 v65, v65
v_exp_f32 v66, v66
v_exp_f32 v67, v67
v_mfma_f32_32x32x8_bf16 v[80:95], v[60:61], v[44:45], v[80:95]
v_exp_f32 v68, v68
v_exp_f32 v69, v69
ds_read_b128 v[48:51], v10 offset:25600
ds_read_b64 v[52:53], v11 offset:12800
v_exp_f32 v70, v70
v_exp_f32 v71, v71
v_mfma_f32_32x32x16_bf16 v[120:135], v[112:115], v[140:143], v[120:135]
v_exp_f32 v72, v72
v_exp_f32 v73, v73
ds_read_b128 v[104:107], v13 offset:19456
ds_read_b128 v[108:111], v13 offset:20064
v_exp_f32 v74, v74
v_exp_f32 v75, v75
v_mfma_f32_32x32x16_bf16 v[120:135], v[116:119], v[144:147], v[120:135]
v_exp_f32 v76, v76
v_exp_f32 v77, v77
v_exp_f32 v78, v78
v_exp_f32 v79, v79
v_cvt_pk_bf16_f32 v96, v64, v65
v_cvt_pk_bf16_f32 v97, v66, v67
v_cvt_pk_bf16_f32 v98, v68, v69
v_cvt_pk_bf16_f32 v99, v70, v71
v_cvt_pk_bf16_f32 v100, v72, v73
v_cvt_pk_bf16_f32 v101, v74, v75
v_cvt_pk_bf16_f32 v102, v76, v77
v_cvt_pk_bf16_f32 v103, v78, v79
s_waitcnt lgkmcnt(0)
v_mfma_f32_32x32x16_bf16 v[64:79], v[48:51], v[40:43], 0
v_exp_f32 v80, v80
v_exp_f32 v81, v81
v_exp_f32 v82, v82
v_exp_f32 v83, v83
v_mfma_f32_32x32x8_bf16 v[64:79], v[52:53], v[44:45], v[64:79]
v_exp_f32 v84, v84
v_exp_f32 v85, v85
ds_read_b128 v[56:59], v10 offset:26112
ds_read_b64 v[60:61], v11 offset:13056
v_exp_f32 v86, v86
v_exp_f32 v87, v87
v_mfma_f32_32x32x16_bf16 v[120:135], v[104:107], v[96:99], v[120:135]
v_exp_f32 v88, v88
v_exp_f32 v89, v89
ds_read_b128 v[112:115], v13 offset:20672
ds_read_b128 v[116:119], v13 offset:21280
v_exp_f32 v90, v90
v_exp_f32 v91, v91
v_mfma_f32_32x32x16_bf16 v[120:135], v[108:111], v[100:103], v[120:135]
v_exp_f32 v92, v92
v_exp_f32 v93, v93
v_exp_f32 v94, v94
v_exp_f32 v95, v95
v_cvt_pk_bf16_f32 v140, v80, v81
v_cvt_pk_bf16_f32 v141, v82, v83
v_cvt_pk_bf16_f32 v142, v84, v85
v_cvt_pk_bf16_f32 v143, v86, v87
v_cvt_pk_bf16_f32 v144, v88, v89
v_cvt_pk_bf16_f32 v145, v90, v91
v_cvt_pk_bf16_f32 v146, v92, v93
v_cvt_pk_bf16_f32 v147, v94, v95
s_waitcnt lgkmcnt(0)
v_mfma_f32_32x32x16_bf16 v[80:95], v[56:59], v[40:43], 0
v_exp_f32 v64, v64
v_exp_f32 v65, v65
v_exp_f32 v66, v66
v_exp_f32 v67, v67
v_mfma_f32_32x32x8_bf16 v[80:95], v[60:61], v[44:45], v[80:95]
v_exp_f32 v68, v68
v_exp_f32 v69, v69
ds_read_b128 v[48:51], v10 offset:26624
ds_read_b64 v[52:53], v11 offset:13312
v_exp_f32 v70, v70
v_exp_f32 v71, v71
v_mfma_f32_32x32x16_bf16 v[120:135], v[112:115], v[140:143], v[120:135]
v_exp_f32 v72, v72
v_exp_f32 v73, v73
ds_read_b128 v[104:107], v13 offset:21888
ds_read_b128 v[108:111], v13 offset:22496
v_exp_f32 v74, v74
v_exp_f32 v75, v75
v_mfma_f32_32x32x16_bf16 v[120:135], v[116:119], v[144:147], v[120:135]
v_exp_f32 v76, v76
v_exp_f32 v77, v77
v_exp_f32 v78, v78
v_exp_f32 v79, v79
v_cvt_pk_bf16_f32 v96, v64, v65
v_cvt_pk_bf16_f32 v97, v66, v67
v_cvt_pk_bf16_f32 v98, v68, v69
v_cvt_pk_bf16_f32 v99, v70, v71
v_cvt_pk_bf16_f32 v100, v72, v73
v_cvt_pk_bf16_f32 v101, v74, v75
v_cvt_pk_bf16_f32 v102, v76, v77
v_cvt_pk_bf16_f32 v103, v78, v79
s_waitcnt lgkmcnt(0)
v_mfma_f32_32x32x16_bf16 v[64:79], v[48:51], v[40:43], 0
v_exp_f32 v80, v80
v_exp_f32 v81, v81
v_exp_f32 v82, v82
v_exp_f32 v83, v83
v_mfma_f32_32x32x8_bf16 v[64:79], v[52:53], v[44:45], v[64:79]
v_exp_f32 v84, v84
v_exp_f32 v85, v85
ds_read_b128 v[56:59], v10 offset:27136
ds_read_b64 v[60:61], v11 offset:13568
v_exp_f32 v86, v86
v_exp_f32 v87, v87
v_mfma_f32_32x32x16_bf16 v[120:135], v[104:107], v[96:99], v[120:135]
v_exp_f32 v88, v88
v_exp_f32 v89, v89
ds_read_b128 v[112:115], v13 offset:23104
ds_read_b128 v[116:119], v13 offset:23712
v_exp_f32 v90, v90
v_exp_f32 v91, v91
v_mfma_f32_32x32x16_bf16 v[120:135], v[108:111], v[100:103], v[120:135]
v_exp_f32 v92, v92
v_exp_f32 v93, v93
v_exp_f32 v94, v94
v_exp_f32 v95, v95
v_cvt_pk_bf16_f32 v140, v80, v81
v_cvt_pk_bf16_f32 v141, v82, v83
v_cvt_pk_bf16_f32 v142, v84, v85
v_cvt_pk_bf16_f32 v143, v86, v87
v_cvt_pk_bf16_f32 v144, v88, v89
v_cvt_pk_bf16_f32 v145, v90, v91
v_cvt_pk_bf16_f32 v146, v92, v93
v_cvt_pk_bf16_f32 v147, v94, v95
s_waitcnt lgkmcnt(0)
v_mfma_f32_32x32x16_bf16 v[80:95], v[56:59], v[40:43], 0
v_exp_f32 v64, v64
v_exp_f32 v65, v65
v_exp_f32 v66, v66
v_exp_f32 v67, v67
v_mfma_f32_32x32x8_bf16 v[80:95], v[60:61], v[44:45], v[80:95]
v_exp_f32 v68, v68
v_exp_f32 v69, v69
ds_read_b128 v[48:51], v10 offset:27648
ds_read_b64 v[52:53], v11 offset:13824
v_exp_f32 v70, v70
v_exp_f32 v71, v71
v_mfma_f32_32x32x16_bf16 v[120:135], v[112:115], v[140:143], v[120:135]
v_exp_f32 v72, v72
v_exp_f32 v73, v73
ds_read_b128 v[104:107], v13 offset:24320
ds_read_b128 v[108:111], v13 offset:24928
v_exp_f32 v74, v74
v_exp_f32 v75, v75
v_mfma_f32_32x32x16_bf16 v[120:135], v[116:119], v[144:147], v[120:135]
v_exp_f32 v76, v76
v_exp_f32 v77, v77
v_exp_f32 v78, v78
v_exp_f32 v79, v79
v_cvt_pk_bf16_f32 v96, v64, v65
v_cvt_pk_bf16_f32 v97, v66, v67
v_cvt_pk_bf16_f32 v98, v68, v69
v_cvt_pk_bf16_f32 v99, v70, v71
v_cvt_pk_bf16_f32 v100, v72, v73
v_cvt_pk_bf16_f32 v101, v74, v75
v_cvt_pk_bf16_f32 v102, v76, v77
v_cvt_pk_bf16_f32 v103, v78, v79
s_waitcnt lgkmcnt(0)
v_mfma_f32_32x32x16_bf16 v[64:79], v[48:51], v[40:43], 0
v_exp_f32 v80, v80
v_exp_f32 v81, v81
v_exp_f32 v82, v82
v_exp_f32 v83, v83
v_mfma_f32_32x32x8_bf16 v[64:79], v[52:53], v[44:45], v[64:79]
v_exp_f32 v84, v84
v_exp_f32 v85, v85
ds_read_b128 v[56:59], v10 offset:28160
ds_read_b64 v[60:61], v11 offset:14080
v_exp_f32 v86, v86
v_exp_f32 v87, v87
v_mfma_f32_32x32x16_bf16 v[120:135], v[104:107], v[96:99], v[120:135]
v_exp_f32 v88, v88
v_exp_f32 v89, v89
ds_read_b128 v[112:115], v13 offset:25536
ds_read_b128 v[116:119], v13 offset:26144
v_exp_f32 v90, v90
v_exp_f32 v91, v91
v_mfma_f32_32x32x16_bf16 v[120:135], v[108:111], v[100:103], v[120:135]
v_exp_f32 v92, v92
v_exp_f32 v93, v93
v_exp_f32 v94, v94
v_exp_f32 v95, v95
v_cvt_pk_bf16_f32 v140, v80, v81
v_cvt_pk_bf16_f32 v141, v82, v83
v_cvt_pk_bf16_f32 v142, v84, v85
v_cvt_pk_bf16_f32 v143, v86, v87
v_cvt_pk_bf16_f32 v144, v88, v89
v_cvt_pk_bf16_f32 v145, v90, v91
v_cvt_pk_bf16_f32 v146, v92, v93
v_cvt_pk_bf16_f32 v147, v94, v95
s_waitcnt lgkmcnt(0)
v_mfma_f32_32x32x16_bf16 v[80:95], v[56:59], v[40:43], 0
v_exp_f32 v64, v64
v_exp_f32 v65, v65
v_exp_f32 v66, v66
v_exp_f32 v67, v67
v_mfma_f32_32x32x8_bf16 v[80:95], v[60:61], v[44:45], v[80:95]
v_exp_f32 v68, v68
v_exp_f32 v69, v69
ds_read_b128 v[48:51], v10 offset:28672
ds_read_b64 v[52:53], v11 offset:14336
v_exp_f32 v70, v70
v_exp_f32 v71, v71
v_mfma_f32_32x32x16_bf16 v[120:135], v[112:115], v[140:143], v[120:135]
v_exp_f32 v72, v72
v_exp_f32 v73, v73
ds_read_b128 v[104:107], v13 offset:26752
ds_read_b128 v[108:111], v13 offset:27360
v_exp_f32 v74, v74
v_exp_f32 v75, v75
v_mfma_f32_32x32x16_bf16 v[120:135], v[116:119], v[144:147], v[120:135]
v_exp_f32 v76, v76
v_exp_f32 v77, v77
v_exp_f32 v78, v78
v_exp_f32 v79, v79
v_cvt_pk_bf16_f32 v96, v64, v65
v_cvt_pk_bf16_f32 v97, v66, v67
v_cvt_pk_bf16_f32 v98, v68, v69
v_cvt_pk_bf16_f32 v99, v70, v71
v_cvt_pk_bf16_f32 v100, v72, v73
v_cvt_pk_bf16_f32 v101, v74, v75
v_cvt_pk_bf16_f32 v102, v76, v77
v_cvt_pk_bf16_f32 v103, v78, v79
s_waitcnt lgkmcnt(0)
v_mfma_f32_32x32x16_bf16 v[64:79], v[48:51], v[40:43], 0
v_exp_f32 v80, v80
v_exp_f32 v81, v81
v_exp_f32 v82, v82
v_exp_f32 v83, v83
v_mfma_f32_32x32x8_bf16 v[64:79], v[52:53], v[44:45], v[64:79]
v_exp_f32 v84, v84
v_exp_f32 v85, v85
ds_read_b128 v[56:59], v10 offset:29184
ds_read_b64 v[60:61], v11 offset:14592
v_exp_f32 v86, v86
v_exp_f32 v87, v87
v_mfma_f32_32x32x16_bf16 v[120:135], v[104:107], v[96:99], v[120:135]
v_exp_f32 v88, v88
v_exp_f32 v89, v89
ds_read_b128 v[112:115], v13 offset:27968
ds_read_b128 v[116:119], v13 offset:28576
v_exp_f32 v90, v90
v_exp_f32 v91, v91
v_mfma_f32_32x32x16_bf16 v[120:135], v[108:111], v[100:103], v[120:135]
v_exp_f32 v92, v92
v_exp_f32 v93, v93
v_exp_f32 v94, v94
v_exp_f32 v95, v95
v_cvt_pk_bf16_f32 v140, v80, v81
v_cvt_pk_bf16_f32 v141, v82, v83
v_cvt_pk_bf16_f32 v142, v84, v85
v_cvt_pk_bf16_f32 v143, v86, v87
v_cvt_pk_bf16_f32 v144, v88, v89
v_cvt_pk_bf16_f32 v145, v90, v91
v_cvt_pk_bf16_f32 v146, v92, v93
v_cvt_pk_bf16_f32 v147, v94, v95
s_waitcnt lgkmcnt(0)
v_mfma_f32_32x32x16_bf16 v[80:95], v[56:59], v[40:43], 0
v_exp_f32 v64, v64
v_exp_f32 v65, v65
v_exp_f32 v66, v66
v_exp_f32 v67, v67
v_mfma_f32_32x32x8_bf16 v[80:95], v[60:61], v[44:45], v[80:95]
v_exp_f32 v68, v68
v_exp_f32 v69, v69
ds_read_b128 v[48:51], v10 offset:29696
ds_read_b64 v[52:53], v11 offset:14848
v_exp_f32 v70, v70
v_exp_f32 v71, v71
v_mfma_f32_32x32x16_bf16 v[120:135], v[112:115], v[140:143], v[120:135]
v_exp_f32 v72, v72
v_exp_f32 v73, v73
ds_read_b128 v[104:107], v13 offset:29184
ds_read_b128 v[108:111], v13 offset:29792
v_exp_f32 v74, v74
v_exp_f32 v75, v75
v_mfma_f32_32x32x16_bf16 v[120:135], v[116:119], v[144:147], v[120:135]
v_exp_f32 v76, v76
v_exp_f32 v77, v77
v_exp_f32 v78, v78
v_exp_f32 v79, v79
v_cvt_pk_bf16_f32 v96, v64, v65
v_cvt_pk_bf16_f32 v97, v66, v67
v_cvt_pk_bf16_f32 v98, v68, v69
v_cvt_pk_bf16_f32 v99, v70, v71
v_cvt_pk_bf16_f32 v100, v72, v73
v_cvt_pk_bf16_f32 v101, v74, v75
v_cvt_pk_bf16_f32 v102, v76, v77
v_cvt_pk_bf16_f32 v103, v78, v79
s_waitcnt lgkmcnt(0)
v_mfma_f32_32x32x16_bf16 v[64:79], v[48:51], v[40:43], 0
v_exp_f32 v80, v80
v_exp_f32 v81, v81
v_exp_f32 v82, v82
v_exp_f32 v83, v83
v_mfma_f32_32x32x8_bf16 v[64:79], v[52:53], v[44:45], v[64:79]
v_exp_f32 v84, v84
v_exp_f32 v85, v85
ds_read_b128 v[56:59], v10 offset:30208
ds_read_b64 v[60:61], v11 offset:15104
v_exp_f32 v86, v86
v_exp_f32 v87, v87
v_mfma_f32_32x32x16_bf16 v[120:135], v[104:107], v[96:99], v[120:135]
v_exp_f32 v88, v88
v_exp_f32 v89, v89
ds_read_b128 v[112:115], v13 offset:30400
ds_read_b128 v[116:119], v13 offset:31008
v_exp_f32 v90, v90
v_exp_f32 v91, v91
v_mfma_f32_32x32x16_bf16 v[120:135], v[108:111], v[100:103], v[120:135]
v_exp_f32 v92, v92
v_exp_f32 v93, v93
v_exp_f32 v94, v94
v_exp_f32 v95, v95
v_cvt_pk_bf16_f32 v140, v80, v81
v_cvt_pk_bf16_f32 v141, v82, v83
v_cvt_pk_bf16_f32 v142, v84, v85
v_cvt_pk_bf16_f32 v143, v86, v87
v_cvt_pk_bf16_f32 v144, v88, v89
v_cvt_pk_bf16_f32 v145, v90, v91
v_cvt_pk_bf16_f32 v146, v92, v93
v_cvt_pk_bf16_f32 v147, v94, v95
s_waitcnt lgkmcnt(0)
v_mfma_f32_32x32x16_bf16 v[80:95], v[56:59], v[40:43], 0
v_exp_f32 v64, v64
v_exp_f32 v65, v65
v_exp_f32 v66, v66
v_exp_f32 v67, v67
v_mfma_f32_32x32x8_bf16 v[80:95], v[60:61], v[44:45], v[80:95]
v_exp_f32 v68, v68
v_exp_f32 v69, v69
ds_read_b128 v[48:51], v10 offset:30720
ds_read_b64 v[52:53], v11 offset:15360
v_exp_f32 v70, v70
v_exp_f32 v71, v71
v_mfma_f32_32x32x16_bf16 v[120:135], v[112:115], v[140:143], v[120:135]
v_exp_f32 v72, v72
v_exp_f32 v73, v73
ds_read_b128 v[104:107], v13 offset:31616
ds_read_b128 v[108:111], v13 offset:32224
v_exp_f32 v74, v74
v_exp_f32 v75, v75
v_mfma_f32_32x32x16_bf16 v[120:135], v[116:119], v[144:147], v[120:135]
v_exp_f32 v76, v76
v_exp_f32 v77, v77
v_exp_f32 v78, v78
v_exp_f32 v79, v79
v_cvt_pk_bf16_f32 v96, v64, v65
v_cvt_pk_bf16_f32 v97, v66, v67
v_cvt_pk_bf16_f32 v98, v68, v69
v_cvt_pk_bf16_f32 v99, v70, v71
v_cvt_pk_bf16_f32 v100, v72, v73
v_cvt_pk_bf16_f32 v101, v74, v75
v_cvt_pk_bf16_f32 v102, v76, v77
v_cvt_pk_bf16_f32 v103, v78, v79
s_waitcnt lgkmcnt(0)
v_mfma_f32_32x32x16_bf16 v[64:79], v[48:51], v[40:43], 0
v_exp_f32 v80, v80
v_exp_f32 v81, v81
v_exp_f32 v82, v82
v_exp_f32 v83, v83
v_mfma_f32_32x32x8_bf16 v[64:79], v[52:53], v[44:45], v[64:79]
v_exp_f32 v84, v84
v_exp_f32 v85, v85
ds_read_b128 v[56:59], v10 offset:31232
ds_read_b64 v[60:61], v11 offset:15616
v_exp_f32 v86, v86
v_exp_f32 v87, v87
v_mfma_f32_32x32x16_bf16 v[120:135], v[104:107], v[96:99], v[120:135]
v_exp_f32 v88, v88
v_exp_f32 v89, v89
ds_read_b128 v[112:115], v13 offset:32832
ds_read_b128 v[116:119], v13 offset:33440
v_exp_f32 v90, v90
v_exp_f32 v91, v91
v_mfma_f32_32x32x16_bf16 v[120:135], v[108:111], v[100:103], v[120:135]
v_exp_f32 v92, v92
v_exp_f32 v93, v93
v_exp_f32 v94, v94
v_exp_f32 v95, v95
v_cvt_pk_bf16_f32 v140, v80, v81
v_cvt_pk_bf16_f32 v141, v82, v83
v_cvt_pk_bf16_f32 v142, v84, v85
v_cvt_pk_bf16_f32 v143, v86, v87
v_cvt_pk_bf16_f32 v144, v88, v89
v_cvt_pk_bf16_f32 v145, v90, v91
v_cvt_pk_bf16_f32 v146, v92, v93
v_cvt_pk_bf16_f32 v147, v94, v95
s_waitcnt lgkmcnt(0)
v_mfma_f32_32x32x16_bf16 v[80:95], v[56:59], v[40:43], 0
v_exp_f32 v64, v64
v_exp_f32 v65, v65
v_exp_f32 v66, v66
v_exp_f32 v67, v67
v_mfma_f32_32x32x8_bf16 v[80:95], v[60:61], v[44:45], v[80:95]
v_exp_f32 v68, v68
v_exp_f32 v69, v69
ds_read_b128 v[48:51], v10 offset:31744
ds_read_b64 v[52:53], v11 offset:15872
v_exp_f32 v70, v70
v_exp_f32 v71, v71
v_mfma_f32_32x32x16_bf16 v[120:135], v[112:115], v[140:143], v[120:135]
v_exp_f32 v72, v72
v_exp_f32 v73, v73
ds_read_b128 v[104:107], v13 offset:34048
ds_read_b128 v[108:111], v13 offset:34656
v_exp_f32 v74, v74
v_exp_f32 v75, v75
v_mfma_f32_32x32x16_bf16 v[120:135], v[116:119], v[144:147], v[120:135]
v_exp_f32 v76, v76
v_exp_f32 v77, v77
v_exp_f32 v78, v78
v_exp_f32 v79, v79
v_cvt_pk_bf16_f32 v96, v64, v65
v_cvt_pk_bf16_f32 v97, v66, v67
v_cvt_pk_bf16_f32 v98, v68, v69
v_cvt_pk_bf16_f32 v99, v70, v71
v_cvt_pk_bf16_f32 v100, v72, v73
v_cvt_pk_bf16_f32 v101, v74, v75
v_cvt_pk_bf16_f32 v102, v76, v77
v_cvt_pk_bf16_f32 v103, v78, v79
s_waitcnt lgkmcnt(0)
v_mfma_f32_32x32x16_bf16 v[64:79], v[48:51], v[40:43], 0
v_exp_f32 v80, v80
v_exp_f32 v81, v81
v_exp_f32 v82, v82
v_exp_f32 v83, v83
v_mfma_f32_32x32x8_bf16 v[64:79], v[52:53], v[44:45], v[64:79]
v_exp_f32 v84, v84
v_exp_f32 v85, v85
ds_read_b128 v[56:59], v10 offset:32256
ds_read_b64 v[60:61], v11 offset:16128
v_exp_f32 v86, v86
v_exp_f32 v87, v87
v_mfma_f32_32x32x16_bf16 v[120:135], v[104:107], v[96:99], v[120:135]
v_exp_f32 v88, v88
v_exp_f32 v89, v89
ds_read_b128 v[112:115], v13 offset:35264
ds_read_b128 v[116:119], v13 offset:35872
v_exp_f32 v90, v90
v_exp_f32 v91, v91
v_mfma_f32_32x32x16_bf16 v[120:135], v[108:111], v[100:103], v[120:135]
v_exp_f32 v92, v92
v_exp_f32 v93, v93
v_exp_f32 v94, v94
v_exp_f32 v95, v95
v_cvt_pk_bf16_f32 v140, v80, v81
v_cvt_pk_bf16_f32 v141, v82, v83
v_cvt_pk_bf16_f32 v142, v84, v85
v_cvt_pk_bf16_f32 v143, v86, v87
v_cvt_pk_bf16_f32 v144, v88, v89
v_cvt_pk_bf16_f32 v145, v90, v91
v_cvt_pk_bf16_f32 v146, v92, v93
v_cvt_pk_bf16_f32 v147, v94, v95
s_waitcnt lgkmcnt(0)
v_mfma_f32_32x32x16_bf16 v[80:95], v[56:59], v[40:43], 0
v_exp_f32 v64, v64
v_exp_f32 v65, v65
v_exp_f32 v66, v66
v_exp_f32 v67, v67
v_mfma_f32_32x32x8_bf16 v[80:95], v[60:61], v[44:45], v[80:95]
v_exp_f32 v68, v68
v_exp_f32 v69, v69
v_exp_f32 v70, v70
v_exp_f32 v71, v71
v_mfma_f32_32x32x16_bf16 v[120:135], v[112:115], v[140:143], v[120:135]
v_exp_f32 v72, v72
v_exp_f32 v73, v73
ds_read_b128 v[104:107], v13 offset:36480
ds_read_b128 v[108:111], v13 offset:37088
v_exp_f32 v74, v74
v_exp_f32 v75, v75
v_mfma_f32_32x32x16_bf16 v[120:135], v[116:119], v[144:147], v[120:135]
v_exp_f32 v76, v76
v_exp_f32 v77, v77
v_exp_f32 v78, v78
v_exp_f32 v79, v79
v_cvt_pk_bf16_f32 v96, v64, v65
v_cvt_pk_bf16_f32 v97, v66, v67
v_cvt_pk_bf16_f32 v98, v68, v69
v_cvt_pk_bf16_f32 v99, v70, v71
v_cvt_pk_bf16_f32 v100, v72, v73
v_cvt_pk_bf16_f32 v101, v74, v75
v_cvt_pk_bf16_f32 v102, v76, v77
v_cvt_pk_bf16_f32 v103, v78, v79
s_waitcnt lgkmcnt(0)
v_mfma_f32_32x32x16_bf16 v[120:135], v[104:107], v[96:99], v[120:135]
v_exp_f32 v80, v80
v_exp_f32 v81, v81
v_exp_f32 v82, v82
v_exp_f32 v83, v83
v_mfma_f32_32x32x16_bf16 v[120:135], v[108:111], v[100:103], v[120:135]
v_exp_f32 v84, v84
v_exp_f32 v85, v85
v_exp_f32 v86, v86
v_exp_f32 v87, v87
v_exp_f32 v88, v88
v_exp_f32 v89, v89
ds_read_b128 v[112:115], v13 offset:37696
ds_read_b128 v[116:119], v13 offset:38304
v_exp_f32 v90, v90
v_exp_f32 v91, v91
v_exp_f32 v92, v92
v_exp_f32 v93, v93
v_exp_f32 v94, v94
v_exp_f32 v95, v95
v_cvt_pk_bf16_f32 v140, v80, v81
v_cvt_pk_bf16_f32 v141, v82, v83
v_cvt_pk_bf16_f32 v142, v84, v85
v_cvt_pk_bf16_f32 v143, v86, v87
v_cvt_pk_bf16_f32 v144, v88, v89
v_cvt_pk_bf16_f32 v145, v90, v91
v_cvt_pk_bf16_f32 v146, v92, v93
v_cvt_pk_bf16_f32 v147, v94, v95
s_waitcnt lgkmcnt(0)
v_mfma_f32_32x32x16_bf16 v[120:135], v[112:115], v[140:143], v[120:135]
v_mfma_f32_32x32x16_bf16 v[120:135], v[116:119], v[144:147], v[120:135]
s_nop 15
v_mov_b32 v15, v130
v_mov_b32 v16, v130
s_nop 1
v_permlane32_swap_b32 v15, v16
s_nop 1
v_rcp_f32 v15, v15
s_nop 0
v_mul_f32 v120, v120, v15
v_mul_f32 v121, v121, v15
v_mul_f32 v122, v122, v15
v_mul_f32 v123, v123, v15
v_mul_f32 v124, v124, v15
v_mul_f32 v125, v125, v15
v_mul_f32 v126, v126, v15
v_mul_f32 v127, v127, v15
v_mul_f32 v128, v128, v15
v_mul_f32 v129, v129, v15
v_cvt_pk_bf16_f32 v120, v120, v121
v_cvt_pk_bf16_f32 v121, v122, v123
v_cvt_pk_bf16_f32 v122, v124, v125
v_cvt_pk_bf16_f32 v123, v126, v127
v_cvt_pk_bf16_f32 v124, v128, v129
s_movk_i32 s42, 10368
v_mul_lo_u32 v6, v5, s42
v_add_u32 v6, s22, v6
v_lshl_add_u32 v7, v4, 3, v6
v_lshl_add_u32 v8, v4, 30, v6
buffer_store_dwordx2 v[120:121], v7, s[44:47], 0 offen
buffer_store_dwordx2 v[122:123], v7, s[44:47], 0 offen offset:16
buffer_store_dword v124, v8, s[44:47], 0 offen offset:32
at_end:
s_endpgm
.section .rodata,"a"
.p2align 6
.amdhsa_kernel at_kernel
  .amdhsa_next_free_vgpr 192
  .amdhsa_next_free_sgpr 102
  .amdhsa_accum_offset 192
  .amdhsa_group_segment_fixed_size 0
  .amdhsa_kernarg_size 80
  .amdhsa_user_sgpr_count 2
  .amdhsa_user_sgpr_kernarg_segment_ptr 1
  .amdhsa_system_sgpr_workgroup_id_x 1
.end_amdhsa_kernel
.text

.globl g2_kernel
.p2align 8
.type g2_kernel,@function
g2_kernel:
s_cmp_ge_u32 s2, 256
s_cbranch_scc1 g2_end
s_load_dwordx2 s[4:5], s[0:1], 16
s_load_dwordx2 s[6:7], s[0:1], 48
s_load_dwordx2 s[12:13], s[0:1], 72
s_and_b32 s14, s2, 7
s_lshr_b32 s15, s2, 3
s_cmp_ge_u32 s15, 30
s_cbranch_scc1 g2_end
s_mul_i32 s14, s14, 30
s_add_u32 s15, s14, s15
s_cmp_ge_u32 s15, 240
s_cbranch_scc1 g2_end
s_mul_i32 s14, s15, 1366
s_lshr_b32 s14, s14, 16
s_mul_i32 s17, s14, 48
s_sub_u32 s15, s15, s17
s_mul_i32 s16, s15, 21846
s_lshr_b32 s16, s16, 16
s_mul_i32 s17, s16, 3
s_sub_u32 s17, s15, s17
v_lshrrev_b32 v1, 6, v0
s_nop 0
v_readfirstlane_b32 s18, v1
v_and_b32 v2, 63, v0
v_and_b32 v3, 31, v2
v_lshrrev_b32 v4, 5, v2
s_waitcnt lgkmcnt(0)
s_mov_b32 s20, s4
s_and_b32 s21, s5, 0xffff
s_mov_b32 s22, 663552
s_mov_b32 s23, 0x00020000
s_mov_b32 s24, s6
s_and_b32 s25, s7, 0xffff
s_mov_b32 s26, 5308416
s_mov_b32 s27, 0x00020000
s_add_u32 s40, s12, 8388608
s_addc_u32 s41, s13, 0
s_mov_b32 s44, s40
s_and_b32 s45, s41, 0xffff
s_mov_b32 s46, 21233664
s_mov_b32 s47, 0x00020000
s_add_u32 s40, s12, 33554432
s_addc_u32 s41, s13, 0
s_mov_b32 s36, s40
s_and_b32 s37, s41, 0xffff
s_mov_b32 s38, 23592960
s_mov_b32 s39, 0x00020000
s_lshl_b32 s50, s14, 4
s_min_u32 s51, s14, 1
s_add_u32 s50, s50, s51
s_lshl_b32 s51, s14, 4
s_add_u32 s51, s51, 17
s_and_b32 s71, s18, 3
s_lshr_b32 s72, s18, 2
s_lshl_b32 s19, s16, 7
s_lshl_b32 s40, s71, 5
s_add_u32 s40, s19, s40
v_add_u32 v5, s40, v3
s_movk_i32 s42, 10368
s_mul_i32 s40, s18, 12
s_mul_i32 s41, s17, 384
v_bfe_u32 v7, v2, 2, 2
v_and_b32 v8, 3, v2
v_lshlrev_b32 v8, 4, v8
v_add_u32 v8, s41, v8
v_lshrrev_b32 v9, 4, v2
v_add_u32 v9, 0, v9
v_add_u32 v9, s40, v9
v_mul_u32_u24 v16, 43, v9
v_lshrrev_b32 v16, 8, v16
v_mul_u32_u24 v17, 6, v16
v_sub_u32 v17, v9, v17
v_lshl_add_u32 v16, v16, 2, v7
v_mul_u32_u24 v16, 1152, v16
v_lshl_add_u32 v16, v17, 6, v16
v_add_u32 v10, v16, v8
v_lshrrev_b32 v9, 4, v2
v_add_u32 v9, 4, v9
v_add_u32 v9, s40, v9
v_mul_u32_u24 v16, 43, v9
v_lshrrev_b32 v16, 8, v16
v_mul_u32_u24 v17, 6, v16
v_sub_u32 v17, v9, v17
v_lshl_add_u32 v16, v16, 2, v7
v_mul_u32_u24 v16, 1152, v16
v_lshl_add_u32 v16, v17, 6, v16
v_add_u32 v11, v16, v8
v_lshrrev_b32 v9, 4, v2
v_add_u32 v9, 8, v9
v_add_u32 v9, s40, v9
v_mul_u32_u24 v16, 43, v9
v_lshrrev_b32 v16, 8, v16
v_mul_u32_u24 v17, 6, v16
v_sub_u32 v17, v9, v17
v_lshl_add_u32 v16, v16, 2, v7
v_mul_u32_u24 v16, 1152, v16
v_lshl_add_u32 v16, v17, 6, v16
v_add_u32 v12, v16, v8
v_mul_u32_u24 v16, 3072, v4
v_lshl_add_u32 v16, v7, 6, v16
v_bfe_u32 v17, v2, 4, 1
v_lshl_add_u32 v16, v17, 5, v16
v_and_b32 v17, 3, v2
v_lshl_add_u32 v16, v17, 3, v16
s_mul_i32 s40, s72, 768
v_add_u32 v16, s40, v16
s_mul_i32 s52, s18, 3072
v_mov_b32 v20, 0
v_mov_b32 v21, 0
v_mov_b32 v22, 0
v_mov_b32 v23, 0
v_mov_b32 v24, 0
v_mov_b32 v25, 0
v_mov_b32 v26, 0
v_mov_b32 v27, 0
v_mov_b32 v28, 0
v_mov_b32 v29, 0
v_mov_b32 v30, 0
v_mov_b32 v31, 0
v_mov_b32 v32, 0
v_mov_b32 v33, 0
v_mov_b32 v34, 0
v_mov_b32 v35, 0
v_mov_b32 v36, 0
v_mov_b32 v37, 0
v_mov_b32 v38, 0
v_mov_b32 v39, 0
v_mov_b32 v40, 0
v_mov_b32 v41, 0
v_mov_b32 v42, 0
v_mov_b32 v43, 0
v_mov_b32 v44, 0
v_mov_b32 v45, 0
v_mov_b32 v46, 0
v_mov_b32 v47, 0
v_mov_b32 v48, 0
v_mov_b32 v49, 0
v_mov_b32 v50, 0
v_mov_b32 v51, 0
v_mov_b32 v52, 0
v_mov_b32 v53, 0
v_mov_b32 v54, 0
v_mov_b32 v55, 0
v_mov_b32 v56, 0
v_mov_b32 v57, 0
v_mov_b32 v58, 0
v_mov_b32 v59, 0
v_mov_b32 v60, 0
v_mov_b32 v61, 0
v_mov_b32 v62, 0
v_mov_b32 v63, 0
v_mov_b32 v64, 0
v_mov_b32 v65, 0
v_mov_b32 v66, 0
v_mov_b32 v67, 0
s_sub_u32 s69, s51, 1
s_lshl_b32 s40, s18, 4
s_add_u32 s40, s19, s40
v_lshrrev_b32 v7, 3, v2
v_add_u32 v9, s40, v7
v_mul_lo_u32 v6, v9, s42
v_and_b32 v9, 7, v2
v_xor_b32 v9, v9, v7
v_lshl_add_u32 v6, v9, 4, v6
s_lshl_b32 s70, s18, 11
s_add_u32 s70, s70, 24576
s_lshl_b32 s73, s71, 12
s_add_u32 s73, s73, 24576
v_and_b32 v9, 7, v3
v_lshlrev_b32 v7, 7, v3
v_add_u32 v7, s73, v7
v_add_u32 v8, 0, v4
v_xor_b32 v8, v8, v9
v_lshl_add_u32 v196, v8, 4, v7
v_add_u32 v8, 2, v4
v_xor_b32 v8, v8, v9
v_lshl_add_u32 v197, v8, 4, v7
v_add_u32 v8, 4, v4
v_xor_b32 v8, v8, v9
v_lshl_add_u32 v198, v8, 4, v7
v_add_u32 v8, 6, v4
v_xor_b32 v8, v8, v9
v_lshl_add_u32 v199, v8, 4, v7
v_add_u32 v200, 0, v196
v_add_u32 v201, 0, v197
v_add_u32 v202, 0, v198
v_add_u32 v203, 0, v199
v_add_u32 v216, 0, v16
v_add_u32 v204, 40960, v196
v_add_u32 v205, 40960, v197
v_add_u32 v206, 40960, v198
v_add_u32 v207, 40960, v199
v_add_u32 v217, 40960, v16
v_add_u32 v208, 81920, v196
v_add_u32 v209, 81920, v197
v_add_u32 v210, 81920, v198
v_add_u32 v211, 81920, v199
v_add_u32 v218, 81920, v16
v_add_u32 v212, 122880, v196
v_add_u32 v213, 122880, v197
v_add_u32 v214, 122880, v198
v_add_u32 v215, 122880, v199
v_add_u32 v219, 122880, v16
s_mov_b32 s53, s50
s_add_u32 s54, s53, 0
s_min_u32 s62, s54, s69
s_cmp_lt_u32 s62, 9
s_cselect_b32 s56, s20, s24
s_cselect_b32 s57, s21, s25
s_cselect_b32 s58, s22, s26
s_mov_b32 s59, s23
s_cselect_b32 s60, 0, 9
s_sub_u32 s60, s62, s60
s_mul_i32 s60, s60, 73728
s_lshl_b32 s63, s62, 7
s_add_u32 s61, s63, 82944
s_cmp_gt_u32 s54, s69
s_cselect_b32 s58, 0, s58
s_cselect_b32 s46, 0, s46
s_add_u32 m0, s52, 0
s_nop 0
buffer_load_dwordx4 v10, s[56:59], s60 offen lds
s_add_u32 m0, s52, 1024
s_nop 0
buffer_load_dwordx4 v11, s[56:59], s60 offen lds
s_add_u32 m0, s52, 2048
s_nop 0
buffer_load_dwordx4 v12, s[56:59], s60 offen lds
s_add_u32 m0, s70, 0
s_nop 0
buffer_load_dwordx4 v6, s[44:47], s63 offen lds
s_add_u32 m0, s70, 1024
s_nop 0
buffer_load_dwordx4 v6, s[44:47], s61 offen lds
s_add_u32 s54, s53, 1
s_min_u32 s62, s54, s69
s_cmp_lt_u32 s62, 9
s_cselect_b32 s56, s20, s24
s_cselect_b32 s57, s21, s25
s_cselect_b32 s58, s22, s26
s_mov_b32 s59, s23
s_cselect_b32 s60, 0, 9
s_sub_u32 s60, s62, s60
s_mul_i32 s60, s60, 73728
s_lshl_b32 s63, s62, 7
s_add_u32 s61, s63, 82944
s_cmp_gt_u32 s54, s69
s_cselect_b32 s58, 0, s58
s_cselect_b32 s46, 0, s46
s_add_u32 m0, s52, 40960
s_nop 0
buffer_load_dwordx4 v10, s[56:59], s60 offen lds
s_add_u32 m0, s52, 41984
s_nop 0
buffer_load_dwordx4 v11, s[56:59], s60 offen lds
s_add_u32 m0, s52, 43008
s_nop 0
buffer_load_dwordx4 v12, s[56:59], s60 offen lds
s_add_u32 m0, s70, 40960
s_nop 0
buffer_load_dwordx4 v6, s[44:47], s63 offen lds
s_add_u32 m0, s70, 41984
s_nop 0
buffer_load_dwordx4 v6, s[44:47], s61 offen lds
s_add_u32 s54, s53, 2
s_min_u32 s62, s54, s69
s_cmp_lt_u32 s62, 9
s_cselect_b32 s56, s20, s24
s_cselect_b32 s57, s21, s25
s_cselect_b32 s58, s22, s26
s_mov_b32 s59, s23
s_cselect_b32 s60, 0, 9
s_sub_u32 s60, s62, s60
s_mul_i32 s60, s60, 73728
s_lshl_b32 s63, s62, 7
s_add_u32 s61, s63, 82944
s_cmp_gt_u32 s54, s69
s_cselect_b32 s58, 0, s58
s_cselect_b32 s46, 0, s46
s_add_u32 m0, s52, 81920
s_nop 0
buffer_load_dwordx4 v10, s[56:59], s60 offen lds
s_add_u32 m0, s52, 82944
s_nop 0
buffer_load_dwordx4 v11, s[56:59], s60 offen lds
s_add_u32 m0, s52, 83968
s_nop 0
buffer_load_dwordx4 v12, s[56:59], s60 offen lds
s_add_u32 m0, s70, 81920
s_nop 0
buffer_load_dwordx4 v6, s[44:47], s63 offen lds
s_add_u32 m0, s70, 82944
s_nop 0
buffer_load_dwordx4 v6, s[44:47], s61 offen lds
s_add_u32 s54, s53, 3
s_min_u32 s62, s54, s69
s_cmp_lt_u32 s62, 9
s_cselect_b32 s56, s20, s24
s_cselect_b32 s57, s21, s25
s_cselect_b32 s58, s22, s26
s_mov_b32 s59, s23
s_cselect_b32 s60, 0, 9
s_sub_u32 s60, s62, s60
s_mul_i32 s60, s60, 73728
s_lshl_b32 s63, s62, 7
s_add_u32 s61, s63, 82944
s_cmp_gt_u32 s54, s69
s_cselect_b32 s58, 0, s58
s_cselect_b32 s46, 0, s46
s_add_u32 m0, s52, 122880
s_nop 0
buffer_load_dwordx4 v10, s[56:59], s60 offen lds
s_add_u32 m0, s52, 123904
s_nop 0
buffer_load_dwordx4 v11, s[56:59], s60 offen lds
s_add_u32 m0, s52, 124928
s_nop 0
buffer_load_dwordx4 v12, s[56:59], s60 offen lds
s_add_u32 m0, s70, 122880
s_nop 0
buffer_load_dwordx4 v6, s[44:47], s63 offen lds
s_add_u32 m0, s70, 123904
s_nop 0
buffer_load_dwordx4 v6, s[44:47], s61 offen lds
s_waitcnt vmcnt(15)
s_barrier
ds_read_b128 v[68:71], v200
ds_read_b64_tr_b16 v[84:85], v216 offset:0
ds_read_b64_tr_b16 v[86:87], v216 offset:1536
ds_read_b64_tr_b16 v[88:89], v216 offset:256
ds_read_b64_tr_b16 v[90:91], v216 offset:1792
ds_read_b64_tr_b16 v[92:93], v216 offset:512
ds_read_b64_tr_b16 v[94:95], v216 offset:2048
ds_read_b128 v[72:75], v201
ds_read_b64_tr_b16 v[96:97], v216 offset:6144
ds_read_b64_tr_b16 v[98:99], v216 offset:7680
ds_read_b64_tr_b16 v[100:101], v216 offset:6400
ds_read_b64_tr_b16 v[102:103], v216 offset:7936
ds_read_b64_tr_b16 v[104:105], v216 offset:6656
ds_read_b64_tr_b16 v[106:107], v216 offset:8192
ds_read_b128 v[76:79], v202
ds_read_b64_tr_b16 v[108:109], v216 offset:12288
ds_read_b64_tr_b16 v[110:111], v216 offset:13824
ds_read_b64_tr_b16 v[112:113], v216 offset:12544
ds_read_b64_tr_b16 v[114:115], v216 offset:14080
ds_read_b64_tr_b16 v[116:117], v216 offset:12800
ds_read_b64_tr_b16 v[118:119], v216 offset:14336
ds_read_b128 v[80:83], v203
ds_read_b64_tr_b16 v[120:121], v216 offset:18432
ds_read_b64_tr_b16 v[122:123], v216 offset:19968
ds_read_b64_tr_b16 v[124:125], v216 offset:18688
ds_read_b64_tr_b16 v[126:127], v216 offset:20224
ds_read_b64_tr_b16 v[128:129], v216 offset:18944
ds_read_b64_tr_b16 v[130:131], v216 offset:20480
g2_loop:
s_add_u32 s54, s53, 4
s_min_u32 s62, s54, s69
s_cmp_lt_u32 s62, 9
s_cselect_b32 s56, s20, s24
s_cselect_b32 s57, s21, s25
s_cselect_b32 s58, s22, s26
s_mov_b32 s59, s23
s_cselect_b32 s60, 0, 9
s_sub_u32 s60, s62, s60
s_mul_i32 s60, s60, 73728
s_lshl_b32 s63, s62, 7
s_add_u32 s61, s63, 82944
s_cmp_gt_u32 s54, s69
s_cselect_b32 s58, 0, s58
s_cselect_b32 s46, 0, s46
s_waitcnt vmcnt(10) lgkmcnt(0)
s_barrier
v_mfma_f32_32x32x16_bf16 v[20:35], v[84:87], v[68:71], v[20:35]
s_add_u32 m0, s52, 0
s_nop 0
buffer_load_dwordx4 v10, s[56:59], s60 offen lds
ds_read_b128 v[132:135], v204
ds_read_b64_tr_b16 v[148:149], v217 offset:0
ds_read_b64_tr_b16 v[150:151], v217 offset:1536
v_mfma_f32_32x32x16_bf16 v[36:51], v[88:91], v[68:71], v[36:51]
ds_read_b64_tr_b16 v[152:153], v217 offset:256
ds_read_b64_tr_b16 v[154:155], v217 offset:1792
ds_read_b64_tr_b16 v[156:157], v217 offset:512
v_mfma_f32_32x32x16_bf16 v[52:67], v[92:95], v[68:71], v[52:67]
s_add_u32 m0, s52, 1024
s_nop 0
buffer_load_dwordx4 v11, s[56:59], s60 offen lds
ds_read_b64_tr_b16 v[158:159], v217 offset:2048
ds_read_b128 v[136:139], v205
ds_read_b64_tr_b16 v[160:161], v217 offset:6144
v_mfma_f32_32x32x16_bf16 v[20:35], v[96:99], v[72:75], v[20:35]
ds_read_b64_tr_b16 v[162:163], v217 offset:7680
ds_read_b64_tr_b16 v[164:165], v217 offset:6400
ds_read_b64_tr_b16 v[166:167], v217 offset:7936
v_mfma_f32_32x32x16_bf16 v[36:51], v[100:103], v[72:75], v[36:51]
s_add_u32 m0, s52, 2048
s_nop 0
buffer_load_dwordx4 v12, s[56:59], s60 offen lds
ds_read_b64_tr_b16 v[168:169], v217 offset:6656
ds_read_b64_tr_b16 v[170:171], v217 offset:8192
ds_read_b128 v[140:143], v206
v_mfma_f32_32x32x16_bf16 v[52:67], v[104:107], v[72:75], v[52:67]
ds_read_b64_tr_b16 v[172:173], v217 offset:12288
ds_read_b64_tr_b16 v[174:175], v217 offset:13824
ds_read_b64_tr_b16 v[176:177], v217 offset:12544
v_mfma_f32_32x32x16_bf16 v[20:35], v[108:111], v[76:79], v[20:35]
s_add_u32 m0, s70, 0
s_nop 0
buffer_load_dwordx4 v6, s[44:47], s63 offen lds
ds_read_b64_tr_b16 v[178:179], v217 offset:14080
ds_read_b64_tr_b16 v[180:181], v217 offset:12800
ds_read_b64_tr_b16 v[182:183], v217 offset:14336
v_mfma_f32_32x32x16_bf16 v[36:51], v[112:115], v[76:79], v[36:51]
ds_read_b128 v[144:147], v207
ds_read_b64_tr_b16 v[184:185], v217 offset:18432
ds_read_b64_tr_b16 v[186:187], v217 offset:19968
v_mfma_f32_32x32x16_bf16 v[52:67], v[116:119], v[76:79], v[52:67]
s_add_u32 m0, s70, 1024
s_nop 0
buffer_load_dwordx4 v6, s[44:47], s61 offen lds
ds_read_b64_tr_b16 v[188:189], v217 offset:18688
ds_read_b64_tr_b16 v[190:191], v217 offset:20224
ds_read_b64_tr_b16 v[192:193], v217 offset:18944
v_mfma_f32_32x32x16_bf16 v[20:35], v[120:123], v[80:83], v[20:35]
ds_read_b64_tr_b16 v[194:195], v217 offset:20480
v_mfma_f32_32x32x16_bf16 v[36:51], v[124:127], v[80:83], v[36:51]
v_mfma_f32_32x32x16_bf16 v[52:67], v[128:131], v[80:83], v[52:67]
s_add_u32 s53, s53, 1
s_cmp_lt_u32 s53, s51
s_cbranch_scc0 g2_fin
s_add_u32 s54, s53, 4
s_min_u32 s62, s54, s69
s_cmp_lt_u32 s62, 9
s_cselect_b32 s56, s20, s24
s_cselect_b32 s57, s21, s25
s_cselect_b32 s58, s22, s26
s_mov_b32 s59, s23
s_cselect_b32 s60, 0, 9
s_sub_u32 s60, s62, s60
s_mul_i32 s60, s60, 73728
s_lshl_b32 s63, s62, 7
s_add_u32 s61, s63, 82944
s_cmp_gt_u32 s54, s69
s_cselect_b32 s58, 0, s58
s_cselect_b32 s46, 0, s46
s_waitcnt vmcnt(10) lgkmcnt(0)
s_barrier
v_mfma_f32_32x32x16_bf16 v[20:35], v[148:151], v[132:135], v[20:35]
s_add_u32 m0, s52, 40960
s_nop 0
buffer_load_dwordx4 v10, s[56:59], s60 offen lds
ds_read_b128 v[68:71], v208
ds_read_b64_tr_b16 v[84:85], v218 offset:0
ds_read_b64_tr_b16 v[86:87], v218 offset:1536
v_mfma_f32_32x32x16_bf16 v[36:51], v[152:155], v[132:135], v[36:51]
ds_read_b64_tr_b16 v[88:89], v218 offset:256
ds_read_b64_tr_b16 v[90:91], v218 offset:1792
ds_read_b64_tr_b16 v[92:93], v218 offset:512
v_mfma_f32_32x32x16_bf16 v[52:67], v[156:159], v[132:135], v[52:67]
s_add_u32 m0, s52, 41984
s_nop 0
buffer_load_dwordx4 v11, s[56:59], s60 offen lds
ds_read_b64_tr_b16 v[94:95], v218 offset:2048
ds_read_b128 v[72:75], v209
ds_read_b64_tr_b16 v[96:97], v218 offset:6144
v_mfma_f32_32x32x16_bf16 v[20:35], v[160:163], v[136:139], v[20:35]
ds_read_b64_tr_b16 v[98:99], v218 offset:7680
ds_read_b64_tr_b16 v[100:101], v218 offset:6400
ds_read_b64_tr_b16 v[102:103], v218 offset:7936
v_mfma_f32_32x32x16_bf16 v[36:51], v[164:167], v[136:139], v[36:51]
s_add_u32 m0, s52, 43008
s_nop 0
buffer_load_dwordx4 v12, s[56:59], s60 offen lds
ds_read_b64_tr_b16 v[104:105], v218 offset:6656
ds_read_b64_tr_b16 v[106:107], v218 offset:8192
ds_read_b128 v[76:79], v210
v_mfma_f32_32x32x16_bf16 v[52:67], v[168:171], v[136:139], v[52:67]
ds_read_b64_tr_b16 v[108:109], v218 offset:12288
ds_read_b64_tr_b16 v[110:111], v218 offset:13824
ds_read_b64_tr_b16 v[112:113], v218 offset:12544
v_mfma_f32_32x32x16_bf16 v[20:35], v[172:175], v[140:143], v[20:35]
s_add_u32 m0, s70, 40960
s_nop 0
buffer_load_dwordx4 v6, s[44:47], s63 offen lds
ds_read_b64_tr_b16 v[114:115], v218 offset:14080
ds_read_b64_tr_b16 v[116:117], v218 offset:12800
ds_read_b64_tr_b16 v[118:119], v218 offset:14336
v_mfma_f32_32x32x16_bf16 v[36:51], v[176:179], v[140:143], v[36:51]
ds_read_b128 v[80:83], v211
ds_read_b64_tr_b16 v[120:121], v218 offset:18432
ds_read_b64_tr_b16 v[122:123], v218 offset:19968
v_mfma_f32_32x32x16_bf16 v[52:67], v[180:183], v[140:143], v[52:67]
s_add_u32 m0, s70, 41984
s_nop 0
buffer_load_dwordx4 v6, s[44:47], s61 offen lds
ds_read_b64_tr_b16 v[124:125], v218 offset:18688
ds_read_b64_tr_b16 v[126:127], v218 offset:20224
ds_read_b64_tr_b16 v[128:129], v218 offset:18944
v_mfma_f32_32x32x16_bf16 v[20:35], v[184:187], v[144:147], v[20:35]
ds_read_b64_tr_b16 v[130:131], v218 offset:20480
v_mfma_f32_32x32x16_bf16 v[36:51], v[188:191], v[144:147], v[36:51]
v_mfma_f32_32x32x16_bf16 v[52:67], v[192:195], v[144:147], v[52:67]
s_add_u32 s53, s53, 1
s_cmp_lt_u32 s53, s51
s_cbranch_scc0 g2_fin
s_add_u32 s54, s53, 4
s_min_u32 s62, s54, s69
s_cmp_lt_u32 s62, 9
s_cselect_b32 s56, s20, s24
s_cselect_b32 s57, s21, s25
s_cselect_b32 s58, s22, s26
s_mov_b32 s59, s23
s_cselect_b32 s60, 0, 9
s_sub_u32 s60, s62, s60
s_mul_i32 s60, s60, 73728
s_lshl_b32 s63, s62, 7
s_add_u32 s61, s63, 82944
s_cmp_gt_u32 s54, s69
s_cselect_b32 s58, 0, s58
s_cselect_b32 s46, 0, s46
s_waitcnt vmcnt(10) lgkmcnt(0)
s_barrier
v_mfma_f32_32x32x16_bf16 v[20:35], v[84:87], v[68:71], v[20:35]
s_add_u32 m0, s52, 81920
s_nop 0
buffer_load_dwordx4 v10, s[56:59], s60 offen lds
ds_read_b128 v[132:135], v212
ds_read_b64_tr_b16 v[148:149], v219 offset:0
ds_read_b64_tr_b16 v[150:151], v219 offset:1536
v_mfma_f32_32x32x16_bf16 v[36:51], v[88:91], v[68:71], v[36:51]
ds_read_b64_tr_b16 v[152:153], v219 offset:256
ds_read_b64_tr_b16 v[154:155], v219 offset:1792
ds_read_b64_tr_b16 v[156:157], v219 offset:512
v_mfma_f32_32x32x16_bf16 v[52:67], v[92:95], v[68:71], v[52:67]
s_add_u32 m0, s52, 82944
s_nop 0
buffer_load_dwordx4 v11, s[56:59], s60 offen lds
ds_read_b64_tr_b16 v[158:159], v219 offset:2048
ds_read_b128 v[136:139], v213
ds_read_b64_tr_b16 v[160:161], v219 offset:6144
v_mfma_f32_32x32x16_bf16 v[20:35], v[96:99], v[72:75], v[20:35]
ds_read_b64_tr_b16 v[162:163], v219 offset:7680
ds_read_b64_tr_b16 v[164:165], v219 offset:6400
ds_read_b64_tr_b16 v[166:167], v219 offset:7936
v_mfma_f32_32x32x16_bf16 v[36:51], v[100:103], v[72:75], v[36:51]
s_add_u32 m0, s52, 83968
s_nop 0
buffer_load_dwordx4 v12, s[56:59], s60 offen lds
ds_read_b64_tr_b16 v[168:169], v219 offset:6656
ds_read_b64_tr_b16 v[170:171], v219 offset:8192
ds_read_b128 v[140:143], v214
v_mfma_f32_32x32x16_bf16 v[52:67], v[104:107], v[72:75], v[52:67]
ds_read_b64_tr_b16 v[172:173], v219 offset:12288
ds_read_b64_tr_b16 v[174:175], v219 offset:13824
ds_read_b64_tr_b16 v[176:177], v219 offset:12544
v_mfma_f32_32x32x16_bf16 v[20:35], v[108:111], v[76:79], v[20:35]
s_add_u32 m0, s70, 81920
s_nop 0
buffer_load_dwordx4 v6, s[44:47], s63 offen lds
ds_read_b64_tr_b16 v[178:179], v219 offset:14080
ds_read_b64_tr_b16 v[180:181], v219 offset:12800
ds_read_b64_tr_b16 v[182:183], v219 offset:14336
v_mfma_f32_32x32x16_bf16 v[36:51], v[112:115], v[76:79], v[36:51]
ds_read_b128 v[144:147], v215
ds_read_b64_tr_b16 v[184:185], v219 offset:18432
ds_read_b64_tr_b16 v[186:187], v219 offset:19968
v_mfma_f32_32x32x16_bf16 v[52:67], v[116:119], v[76:79], v[52:67]
s_add_u32 m0, s70, 82944
s_nop 0
buffer_load_dwordx4 v6, s[44:47], s61 offen lds
ds_read_b64_tr_b16 v[188:189], v219 offset:18688
ds_read_b64_tr_b16 v[190:191], v219 offset:20224
ds_read_b64_tr_b16 v[192:193], v219 offset:18944
v_mfma_f32_32x32x16_bf16 v[20:35], v[120:123], v[80:83], v[20:35]
ds_read_b64_tr_b16 v[194:195], v219 offset:20480
v_mfma_f32_32x32x16_bf16 v[36:51], v[124:127], v[80:83], v[36:51]
v_mfma_f32_32x32x16_bf16 v[52:67], v[128:131], v[80:83], v[52:67]
s_add_u32 s53, s53, 1
s_cmp_lt_u32 s53, s51
s_cbranch_scc0 g2_fin
s_add_u32 s54, s53, 4
s_min_u32 s62, s54, s69
s_cmp_lt_u32 s62, 9
s_cselect_b32 s56, s20, s24
s_cselect_b32 s57, s21, s25
s_cselect_b32 s58, s22, s26
s_mov_b32 s59, s23
s_cselect_b32 s60, 0, 9
s_sub_u32 s60, s62, s60
s_mul_i32 s60, s60, 73728
s_lshl_b32 s63, s62, 7
s_add_u32 s61, s63, 82944
s_cmp_gt_u32 s54, s69
s_cselect_b32 s58, 0, s58
s_cselect_b32 s46, 0, s46
s_waitcnt vmcnt(10) lgkmcnt(0)
s_barrier
v_mfma_f32_32x32x16_bf16 v[20:35], v[148:151], v[132:135], v[20:35]
s_add_u32 m0, s52, 122880
s_nop 0
buffer_load_dwordx4 v10, s[56:59], s60 offen lds
ds_read_b128 v[68:71], v200
ds_read_b64_tr_b16 v[84:85], v216 offset:0
ds_read_b64_tr_b16 v[86:87], v216 offset:1536
v_mfma_f32_32x32x16_bf16 v[36:51], v[152:155], v[132:135], v[36:51]
ds_read_b64_tr_b16 v[88:89], v216 offset:256
ds_read_b64_tr_b16 v[90:91], v216 offset:1792
ds_read_b64_tr_b16 v[92:93], v216 offset:512
v_mfma_f32_32x32x16_bf16 v[52:67], v[156:159], v[132:135], v[52:67]
s_add_u32 m0, s52, 123904
s_nop 0
buffer_load_dwordx4 v11, s[56:59], s60 offen lds
ds_read_b64_tr_b16 v[94:95], v216 offset:2048
ds_read_b128 v[72:75], v201
ds_read_b64_tr_b16 v[96:97], v216 offset:6144
v_mfma_f32_32x32x16_bf16 v[20:35], v[160:163], v[136:139], v[20:35]
ds_read_b64_tr_b16 v[98:99], v216 offset:7680
ds_read_b64_tr_b16 v[100:101], v216 offset:6400
ds_read_b64_tr_b16 v[102:103], v216 offset:7936
v_mfma_f32_32x32x16_bf16 v[36:51], v[164:167], v[136:139], v[36:51]
s_add_u32 m0, s52, 124928
s_nop 0
buffer_load_dwordx4 v12, s[56:59], s60 offen lds
ds_read_b64_tr_b16 v[104:105], v216 offset:6656
ds_read_b64_tr_b16 v[106:107], v216 offset:8192
ds_read_b128 v[76:79], v202
v_mfma_f32_32x32x16_bf16 v[52:67], v[168:171], v[136:139], v[52:67]
ds_read_b64_tr_b16 v[108:109], v216 offset:12288
ds_read_b64_tr_b16 v[110:111], v216 offset:13824
ds_read_b64_tr_b16 v[112:113], v216 offset:12544
v_mfma_f32_32x32x16_bf16 v[20:35], v[172:175], v[140:143], v[20:35]
s_add_u32 m0, s70, 122880
s_nop 0
buffer_load_dwordx4 v6, s[44:47], s63 offen lds
ds_read_b64_tr_b16 v[114:115], v216 offset:14080
ds_read_b64_tr_b16 v[116:117], v216 offset:12800
ds_read_b64_tr_b16 v[118:119], v216 offset:14336
v_mfma_f32_32x32x16_bf16 v[36:51], v[176:179], v[140:143], v[36:51]
ds_read_b128 v[80:83], v203
ds_read_b64_tr_b16 v[120:121], v216 offset:18432
ds_read_b64_tr_b16 v[122:123], v216 offset:19968
v_mfma_f32_32x32x16_bf16 v[52:67], v[180:183], v[140:143], v[52:67]
s_add_u32 m0, s70, 123904
s_nop 0
buffer_load_dwordx4 v6, s[44:47], s61 offen lds
ds_read_b64_tr_b16 v[124:125], v216 offset:18688
ds_read_b64_tr_b16 v[126:127], v216 offset:20224
ds_read_b64_tr_b16 v[128:129], v216 offset:18944
v_mfma_f32_32x32x16_bf16 v[20:35], v[184:187], v[144:147], v[20:35]
ds_read_b64_tr_b16 v[130:131], v216 offset:20480
v_mfma_f32_32x32x16_bf16 v[36:51], v[188:191], v[144:147], v[36:51]
v_mfma_f32_32x32x16_bf16 v[52:67], v[192:195], v[144:147], v[52:67]
s_add_u32 s53, s53, 1
s_cmp_lt_u32 s53, s51
s_cbranch_scc0 g2_fin
s_branch g2_loop
g2_fin:
s_nop 15
s_waitcnt vmcnt(0) lgkmcnt(0)
s_barrier
s_lshl_b32 s40, s71, 5
v_add_u32 v6, s40, v3
v_mul_u32_u24 v6, 400, v6
v_lshl_add_u32 v6, v4, 3, v6
s_mul_i32 s55, s72, 192
v_add_u32 v6, s55, v6
v_cvt_pk_bf16_f32 v20, v20, v21
v_cvt_pk_bf16_f32 v21, v22, v23
ds_write_b64 v6, v[20:21] offset:0
v_cvt_pk_bf16_f32 v24, v24, v25
v_cvt_pk_bf16_f32 v25, v26, v27
ds_write_b64 v6, v[24:25] offset:16
v_cvt_pk_bf16_f32 v28, v28, v29
v_cvt_pk_bf16_f32 v29, v30, v31
ds_write_b64 v6, v[28:29] offset:32
v_cvt_pk_bf16_f32 v32, v32, v33
v_cvt_pk_bf16_f32 v33, v34, v35
ds_write_b64 v6, v[32:33] offset:48
v_cvt_pk_bf16_f32 v36, v36, v37
v_cvt_pk_bf16_f32 v37, v38, v39
ds_write_b64 v6, v[36:37] offset:64
v_cvt_pk_bf16_f32 v40, v40, v41
v_cvt_pk_bf16_f32 v41, v42, v43
ds_write_b64 v6, v[40:41] offset:80
v_cvt_pk_bf16_f32 v44, v44, v45
v_cvt_pk_bf16_f32 v45, v46, v47
ds_write_b64 v6, v[44:45] offset:96
v_cvt_pk_bf16_f32 v48, v48, v49
v_cvt_pk_bf16_f32 v49, v50, v51
ds_write_b64 v6, v[48:49] offset:112
v_cvt_pk_bf16_f32 v52, v52, v53
v_cvt_pk_bf16_f32 v53, v54, v55
ds_write_b64 v6, v[52:53] offset:128
v_cvt_pk_bf16_f32 v56, v56, v57
v_cvt_pk_bf16_f32 v57, v58, v59
ds_write_b64 v6, v[56:57] offset:144
v_cvt_pk_bf16_f32 v60, v60, v61
v_cvt_pk_bf16_f32 v61, v62, v63
ds_write_b64 v6, v[60:61] offset:160
v_cvt_pk_bf16_f32 v64, v64, v65
v_cvt_pk_bf16_f32 v65, v66, v67
ds_write_b64 v6, v[64:65] offset:176
s_mul_i32 s54, s14, 2359296
s_mul_i32 s55, s17, 384
s_add_u32 s54, s54, s55
s_mul_i32 s55, s19, 1152
s_add_u32 s54, s54, s55
v_add_u32 v8, 0, v0
v_mul_u32_u24 v9, 2731, v8
v_lshrrev_b32 v9, 16, v9
v_mul_u32_u24 v10, 24, v9
v_sub_u32 v10, v8, v10
v_lshlrev_b32 v10, 4, v10
v_mul_u32_u24 v70, 400, v9
v_add_u32 v70, v70, v10
v_mul_u32_u24 v80, 1152, v9
v_add_u32 v80, v80, v10
v_add_u32 v8, 512, v0
v_mul_u32_u24 v9, 2731, v8
v_lshrrev_b32 v9, 16, v9
v_mul_u32_u24 v10, 24, v9
v_sub_u32 v10, v8, v10
v_lshlrev_b32 v10, 4, v10
v_mul_u32_u24 v71, 400, v9
v_add_u32 v71, v71, v10
v_mul_u32_u24 v81, 1152, v9
v_add_u32 v81, v81, v10
v_add_u32 v8, 1024, v0
v_mul_u32_u24 v9, 2731, v8
v_lshrrev_b32 v9, 16, v9
v_mul_u32_u24 v10, 24, v9
v_sub_u32 v10, v8, v10
v_lshlrev_b32 v10, 4, v10
v_mul_u32_u24 v72, 400, v9
v_add_u32 v72, v72, v10
v_mul_u32_u24 v82, 1152, v9
v_add_u32 v82, v82, v10
v_add_u32 v8, 1536, v0
v_mul_u32_u24 v9, 2731, v8
v_lshrrev_b32 v9, 16, v9
v_mul_u32_u24 v10, 24, v9
v_sub_u32 v10, v8, v10
v_lshlrev_b32 v10, 4, v10
v_mul_u32_u24 v73, 400, v9
v_add_u32 v73, v73, v10
v_mul_u32_u24 v83, 1152, v9
v_add_u32 v83, v83, v10
v_add_u32 v8, 2048, v0
v_mul_u32_u24 v9, 2731, v8
v_lshrrev_b32 v9, 16, v9
v_mul_u32_u24 v10, 24, v9
v_sub_u32 v10, v8, v10
v_lshlrev_b32 v10, 4, v10
v_mul_u32_u24 v74, 400, v9
v_add_u32 v74, v74, v10
v_mul_u32_u24 v84, 1152, v9
v_add_u32 v84, v84, v10
v_add_u32 v8, 2560, v0
v_mul_u32_u24 v9, 2731, v8
v_lshrrev_b32 v9, 16, v9
v_mul_u32_u24 v10, 24, v9
v_sub_u32 v10, v8, v10
v_lshlrev_b32 v10, 4, v10
v_mul_u32_u24 v75, 400, v9
v_add_u32 v75, v75, v10
v_mul_u32_u24 v85, 1152, v9
v_add_u32 v85, v85, v10
s_waitcnt lgkmcnt(0)
s_barrier
ds_read_b128 v[100:103], v70
ds_read_b128 v[104:107], v71
ds_read_b128 v[108:111], v72
ds_read_b128 v[112:115], v73
ds_read_b128 v[116:119], v74
ds_read_b128 v[120:123], v75
s_waitcnt lgkmcnt(5)
buffer_store_dwordx4 v[100:103], v80, s[36:39], s54 offen
s_waitcnt lgkmcnt(4)
buffer_store_dwordx4 v[104:107], v81, s[36:39], s54 offen
s_waitcnt lgkmcnt(3)
buffer_store_dwordx4 v[108:111], v82, s[36:39], s54 offen
s_waitcnt lgkmcnt(2)
buffer_store_dwordx4 v[112:115], v83, s[36:39], s54 offen
s_waitcnt lgkmcnt(1)
buffer_store_dwordx4 v[116:119], v84, s[36:39], s54 offen
s_waitcnt lgkmcnt(0)
buffer_store_dwordx4 v[120:123], v85, s[36:39], s54 offen
s_waitcnt vmcnt(0)
g2_end:
s_endpgm
.section .rodata,"a"
.p2align 6
.amdhsa_kernel g2_kernel
  .amdhsa_next_free_vgpr 224
  .amdhsa_next_free_sgpr 102
  .amdhsa_accum_offset 224
  .amdhsa_group_segment_fixed_size 0
  .amdhsa_kernarg_size 80
  .amdhsa_user_sgpr_count 2
  .amdhsa_user_sgpr_kernarg_segment_ptr 1
  .amdhsa_system_sgpr_workgroup_id_x 1
.end_amdhsa_kernel
.text

.globl rd_kernel
.p2align 8
.type rd_kernel,@function
rd_kernel:
s_cmp_ge_u32 s2, 576
s_cbranch_scc1 rd_end
s_load_dwordx2 s[4:5], s[0:1], 0
s_load_dwordx2 s[6:7], s[0:1], 56
s_load_dwordx2 s[12:13], s[0:1], 72
s_lshl_b32 s3, s2, 8
v_add_u32 v1, s3, v0
v_lshlrev_b32 v3, 4, v1
s_waitcnt lgkmcnt(0)
s_mov_b32 s20, s4
s_and_b32 s21, s5, 0xffff
s_mov_b32 s22, 2359296
s_mov_b32 s23, 0x00020000
s_mov_b32 s24, s6
s_and_b32 s25, s7, 0xffff
s_mov_b32 s26, 2359296
s_mov_b32 s27, 0x00020000
s_add_u32 s40, s12, 33554432
s_addc_u32 s41, s13, 0
s_mov_b32 s36, s40
s_and_b32 s37, s41, 0xffff
s_mov_b32 s38, 23592960
s_mov_b32 s39, 0x00020000
buffer_load_dwordx4 v[4:7], v3, s[20:23], 0 offen
s_mov_b32 s40, 0
buffer_load_dwordx4 v[8:11], v3, s[36:39], s40 offen
s_mov_b32 s40, 2359296
buffer_load_dwordx4 v[12:15], v3, s[36:39], s40 offen
s_mov_b32 s40, 4718592
buffer_load_dwordx4 v[16:19], v3, s[36:39], s40 offen
s_mov_b32 s40, 7077888
buffer_load_dwordx4 v[20:23], v3, s[36:39], s40 offen
s_mov_b32 s40, 9437184
buffer_load_dwordx4 v[24:27], v3, s[36:39], s40 offen
s_waitcnt vmcnt(5)
v_lshlrev_b32 v32, 16, v4
v_and_b32 v33, 0xffff0000, v4
v_lshlrev_b32 v34, 16, v5
v_and_b32 v35, 0xffff0000, v5
v_lshlrev_b32 v36, 16, v6
v_and_b32 v37, 0xffff0000, v6
v_lshlrev_b32 v38, 16, v7
v_and_b32 v39, 0xffff0000, v7
s_waitcnt vmcnt(4)
v_lshlrev_b32 v28, 16, v8
v_and_b32 v29, 0xffff0000, v8
v_pk_add_f32 v[32:33], v[32:33], v[28:29]
v_lshlrev_b32 v30, 16, v9
v_and_b32 v31, 0xffff0000, v9
v_pk_add_f32 v[34:35], v[34:35], v[30:31]
v_lshlrev_b32 v28, 16, v10
v_and_b32 v29, 0xffff0000, v10
v_pk_add_f32 v[36:37], v[36:37], v[28:29]
v_lshlrev_b32 v30, 16, v11
v_and_b32 v31, 0xffff0000, v11
v_pk_add_f32 v[38:39], v[38:39], v[30:31]
s_waitcnt vmcnt(3)
v_lshlrev_b32 v28, 16, v12
v_and_b32 v29, 0xffff0000, v12
v_pk_add_f32 v[32:33], v[32:33], v[28:29]
v_lshlrev_b32 v30, 16, v13
v_and_b32 v31, 0xffff0000, v13
v_pk_add_f32 v[34:35], v[34:35], v[30:31]
v_lshlrev_b32 v28, 16, v14
v_and_b32 v29, 0xffff0000, v14
v_pk_add_f32 v[36:37], v[36:37], v[28:29]
v_lshlrev_b32 v30, 16, v15
v_and_b32 v31, 0xffff0000, v15
v_pk_add_f32 v[38:39], v[38:39], v[30:31]
s_waitcnt vmcnt(2)
v_lshlrev_b32 v28, 16, v16
v_and_b32 v29, 0xffff0000, v16
v_pk_add_f32 v[32:33], v[32:33], v[28:29]
v_lshlrev_b32 v30, 16, v17
v_and_b32 v31, 0xffff0000, v17
v_pk_add_f32 v[34:35], v[34:35], v[30:31]
v_lshlrev_b32 v28, 16, v18
v_and_b32 v29, 0xffff0000, v18
v_pk_add_f32 v[36:37], v[36:37], v[28:29]
v_lshlrev_b32 v30, 16, v19
v_and_b32 v31, 0xffff0000, v19
v_pk_add_f32 v[38:39], v[38:39], v[30:31]
s_waitcnt vmcnt(1)
v_lshlrev_b32 v28, 16, v20
v_and_b32 v29, 0xffff0000, v20
v_pk_add_f32 v[32:33], v[32:33], v[28:29]
v_lshlrev_b32 v30, 16, v21
v_and_b32 v31, 0xffff0000, v21
v_pk_add_f32 v[34:35], v[34:35], v[30:31]
v_lshlrev_b32 v28, 16, v22
v_and_b32 v29, 0xffff0000, v22
v_pk_add_f32 v[36:37], v[36:37], v[28:29]
v_lshlrev_b32 v30, 16, v23
v_and_b32 v31, 0xffff0000, v23
v_pk_add_f32 v[38:39], v[38:39], v[30:31]
s_waitcnt vmcnt(0)
v_lshlrev_b32 v28, 16, v24
v_and_b32 v29, 0xffff0000, v24
v_pk_add_f32 v[32:33], v[32:33], v[28:29]
v_lshlrev_b32 v30, 16, v25
v_and_b32 v31, 0xffff0000, v25
v_pk_add_f32 v[34:35], v[34:35], v[30:31]
v_lshlrev_b32 v28, 16, v26
v_and_b32 v29, 0xffff0000, v26
v_pk_add_f32 v[36:37], v[36:37], v[28:29]
v_lshlrev_b32 v30, 16, v27
v_and_b32 v31, 0xffff0000, v27
v_pk_add_f32 v[38:39], v[38:39], v[30:31]
v_cvt_pk_bf16_f32 v4, v32, v33
v_cvt_pk_bf16_f32 v5, v34, v35
v_cvt_pk_bf16_f32 v6, v36, v37
v_cvt_pk_bf16_f32 v7, v38, v39
buffer_store_dwordx4 v[4:7], v3, s[24:27], 0 offen
rd_end:
s_endpgm
.section .rodata,"a"
.p2align 6
.amdhsa_kernel rd_kernel
  .amdhsa_next_free_vgpr 40
  .amdhsa_next_free_sgpr 102
  .amdhsa_accum_offset 40
  .amdhsa_group_segment_fixed_size 0
  .amdhsa_kernarg_size 80
  .amdhsa_user_sgpr_count 2
  .amdhsa_user_sgpr_kernarg_segment_ptr 1
  .amdhsa_system_sgpr_workgroup_id_x 1
.end_amdhsa_kernel
.text
```
